```python
import torch

def _softmax(x, axis=-1):
    return torch.softmax(x, dim=axis)
def _gelu(x):
    return torch.nn.functional.gelu(x, approximate="tanh")
def _silu(x):
    return torch.nn.functional.silu(x)
def _sigmoid(x):
    return torch.sigmoid(x)
def _layernorm(x, axis=-1, eps=1e-5):
    m = x.mean(dim=axis, keepdim=True)
    v = x.var(dim=axis, keepdim=True, unbiased=False)
    return (x - m) / torch.sqrt(v + eps)
def _scatter_add(tgt, idx, src, axis=0):
    return tgt.clone().index_add_(axis, idx, src)
def _segment_sum(src, seg, n):
    out = torch.zeros((n,) + src.shape[1:], dtype=src.dtype)
    return out.index_add_(0, seg, src)
def _pad(x, pw):
    flat = tuple(v for pair in reversed(pw) for v in pair)
    return torch.nn.functional.pad(x, flat)

kernel_name = 'concat_heads__grouped_kv_mqa__linear_attn_block__prompt'

def setup_inputs():

    _w = (lambda a: (lambda t: t.to(torch.bfloat16) if t.is_floating_point() else t)(torch.as_tensor(a)))
    def _A_setup():
        B, S, D, H = 1, 2048, 640, 32
        Dh = D // H
        return {
            "x": _w((lambda *s: torch.randn(*s, dtype=torch.bfloat16) * 0.05)(B, S, D)),
            "wq": _w((lambda *s: torch.randn(*s, dtype=torch.bfloat16) * 0.8)(D, H * Dh)),
            "wk": _w((lambda *s: torch.randn(*s, dtype=torch.bfloat16) * 0.8)(D, Dh)),
            "wv": _w((lambda *s: torch.randn(*s, dtype=torch.bfloat16) * 0.05)(D, Dh)),
            "wo": _w((lambda *s: torch.randn(*s, dtype=torch.bfloat16) * 0.05)(H * Dh, D)),
        }
    _A_in = _A_setup()

    def _B_setup():
        B, S, D = 1, 2048, 640
        return {
            "x": _w((lambda *s: torch.randn(*s, dtype=torch.bfloat16) * 0.05)(B, S, D)),
            "wqkv": _w((lambda *s: torch.randn(*s, dtype=torch.bfloat16) * 0.4)(D, 3 * D)),
            "wo": _w((lambda *s: torch.randn(*s, dtype=torch.bfloat16) * 0.05)(D, D)),
        }
    _B_in = _B_setup()

    return {
        "A_x": _A_in["x"],
        "A_wq": _A_in["wq"],
        "A_wk": _A_in["wk"],
        "A_wv": _A_in["wv"],
        "A_wo": _A_in["wo"],
        "B_x": _B_in["x"],
        "B_wqkv": _B_in["wqkv"],
        "B_wo": _B_in["wo"],
    }

def reference(A_x, A_wq, A_wk, A_wv, A_wo, B_x, B_wqkv, B_wo):
    def _A_ref(x, wq, wk, wv, wo):
        B, S, D = x.shape
        H = 32
        Dh = D // H
        q = (lambda x, *d: x.permute(*d))((x @ wq).reshape(B, S, H, Dh), 0, 2, 1, 3)
        k = x @ wk
        v = x @ wv
        scores = torch.einsum("bhqd,bkd->bhqk", q, k) * (Dh ** -0.5)
        p = _softmax(scores, axis=-1)
        o = torch.einsum("bhqk,bkd->bhqd", p, v)
        return (lambda x, *d: x.permute(*d))(o, 0, 2, 1, 3).reshape(B, S, H * Dh) @ wo

    def _B_ref(x, wqkv, wo):
        B, S, D = x.shape
        H = 32; Dh = D // H
        qkv = (lambda x, *d: x.permute(*d))((x @ wqkv).reshape(B, S, 3, H, Dh), 2, 0, 3, 1, 4)
        q, k, v = qkv[0], qkv[1], qkv[2]
        phi = lambda t: torch.where(t > 0, t + 1, torch.exp(t)) + 1e-6
        pq, pk = phi(q), phi(k)
        kv = torch.einsum("bhsd,bhse->bhde", pk, v)
        z = torch.einsum("bhsd->bhd", pk)
        num = torch.einsum("bhqd,bhde->bhqe", pq, kv)
        den = torch.einsum("bhqd,bhd->bhq", pq, z)[..., None] + 1e-6
        o = num / den
        return (lambda x, *d: x.permute(*d))(o, 0, 2, 1, 3).reshape(B, S, D) @ wo

    a = _A_ref(A_x, A_wq, A_wk, A_wv, A_wo)
    b = _B_ref(B_x, B_wqkv, B_wo)
    return torch.concatenate([a, b], axis=-1)
```

```asm
; @launch grid=(256,1,1) block=(512,1,1) lds=163840
.amdgcn_target "amdgcn-amd-amdhsa--gfx950"
.text
.globl concat_heads__grouped_kv_mqa__linear_attn_block__prompt_kernel
.p2align 8
.type concat_heads__grouped_kv_mqa__linear_attn_block__prompt_kernel,@function
.set CODE_BYTES, L_fallback - concat_heads__grouped_kv_mqa__linear_attn_block__prompt_kernel
concat_heads__grouped_kv_mqa__linear_attn_block__prompt_kernel:
    s_cmp_ge_u32 s2, 256
    s_cbranch_scc1 L_end
    s_memrealtime s[38:39]
    s_load_dwordx16 s[16:31], s[0:1], 0
    s_load_dwordx4 s[32:35], s[0:1], 64
    s_load_dwordx2 s[36:37], s[0:1], 80
    s_getpc_b64 s[94:95]
    v_lshrrev_b32 v5, 6, v0
    v_and_b32 v1, 63, v0
    v_readfirstlane_b32 s3, v5
    v_and_b32 v2, 15, v0
    v_bfe_u32 v3, v0, 4, 2
    v_mov_b32 v4, 0
    v_lshlrev_b32 v15, 4, v1
    v_and_b32 v0, 255, v0
    s_lshr_b32 s9, s2, 3
    s_and_b32 s10, s2, 7
    s_xor_b32 s3, s3, 4
    s_cmp_lg_u32 s3, 2
    s_cbranch_scc1 Lw_1
    s_lshl_b32 s12, s9, 11
    v_lshl_add_u32 v6, v1, 5, s12
    v_min_u32 v6, CODE_BYTES-64, v6
    global_load_dword v228, v6, s[94:95]
Lw_1:
    s_and_b32 s84, s3, 3
    s_lshr_b32 s11, s9, 3
    s_and_b32 s5, s9, 7
    s_lshl_b32 s4, s10, 2
    s_add_u32 s4, s4, s11
    s_lshr_b32 s6, s10, 1
    s_lshl_b32 s6, s6, 2
    s_add_u32 s6, s6, s11
    s_and_b32 s7, s10, 1
    s_lshl_b32 s7, s7, 3
    s_add_u32 s7, s7, s5
    s_lshl_b32 s91, s84, 12
    s_mul_i32 s54, s84, 5280
    s_add_u32 s87, s5, s11
    s_sub_u32 s12, s87, 5
    s_cmp_ge_u32 s87, 5
    s_cselect_b32 s87, s12, s87
    s_sub_u32 s12, s87, 5
    s_cmp_ge_u32 s87, 5
    s_cselect_b32 s87, s12, s87
    s_cmp_lt_u32 s3, 4
    s_cbranch_scc1 L_groupA
    s_lshl_b32 s12, s84, 2
    v_add_u32 v5, s12, v3
    v_xor_b32 v7, v5, v2
    v_mul_u32_u24 v5, 1280, v5
    v_lshl_add_u32 v100, v7, 4, v5
    s_mul_i32 s89, s4, 81920
    s_mul_i32 s86, s84, 6400
    s_lshl_b32 s14, s84, 10
    s_waitcnt lgkmcnt(0)
    s_mov_b64 s[40:41], s[16:17]
    s_mov_b32 s42, 2621440
    s_mov_b32 s43, 0x20000
    s_bitcmp1_b32 s5, 2
    s_cselect_b64 s[48:49], s[22:23], s[20:21]
    s_mov_b32 s50, 25600
    s_mov_b32 s51, 0x20000
    s_add_u32 s10, s5, 0
    s_and_b32 s10, s10, 3
    s_mul_i32 s13, s10, 20480
    s_add_u32 s13, s13, s89
    s_lshl_b32 s10, s10, 12
    s_add_u32 s10, s10, s14
    s_lshl_b32 s9, s87, 8
    s_add_u32 s9, s9, s13
    s_lshl_b32 s12, s87, 14
    s_add_u32 s12, s12, s10
    s_add_u32 m0, s12, 14464
    s_nop 0
    buffer_load_dwordx4 v100, s[40:43], s9 offen lds
    s_add_u32 s87, s87, 1
    s_cmp_eq_u32 s87, 5
    s_cselect_b32 s87, 0, s87
    s_lshl_b32 s9, s87, 8
    s_add_u32 s9, s9, s13
    s_lshl_b32 s12, s87, 14
    s_add_u32 s12, s12, s10
    s_add_u32 m0, s12, 14464
    s_nop 0
    buffer_load_dwordx4 v100, s[40:43], s9 offen lds
    s_add_u32 s87, s87, 1
    s_cmp_eq_u32 s87, 5
    s_cselect_b32 s87, 0, s87
    s_lshl_b32 s9, s87, 8
    s_add_u32 s9, s9, s13
    s_lshl_b32 s12, s87, 14
    s_add_u32 s12, s12, s10
    s_add_u32 m0, s12, 14464
    s_nop 0
    buffer_load_dwordx4 v100, s[40:43], s9 offen lds
    s_add_u32 s87, s87, 1
    s_cmp_eq_u32 s87, 5
    s_cselect_b32 s87, 0, s87
    s_lshl_b32 s9, s87, 8
    s_add_u32 s9, s9, s13
    s_lshl_b32 s12, s87, 14
    s_add_u32 s12, s12, s10
    s_add_u32 m0, s12, 14464
    s_nop 0
    buffer_load_dwordx4 v100, s[40:43], s9 offen lds
    s_add_u32 s87, s87, 1
    s_cmp_eq_u32 s87, 5
    s_cselect_b32 s87, 0, s87
    s_lshl_b32 s9, s87, 8
    s_add_u32 s9, s9, s13
    s_lshl_b32 s12, s87, 14
    s_add_u32 s12, s12, s10
    s_add_u32 m0, s12, 14464
    s_nop 0
    buffer_load_dwordx4 v100, s[40:43], s9 offen lds
    s_add_u32 s87, s87, 1
    s_cmp_eq_u32 s87, 5
    s_cselect_b32 s87, 0, s87
    s_add_u32 m0, s86, 96384
    s_nop 0
    buffer_load_dwordx4 v15, s[48:51], s86 offen lds
    buffer_load_dwordx4 v15, s[48:51], s86 offen offset:1024 lds
    buffer_load_dwordx4 v15, s[48:51], s86 offen offset:2048 lds
    buffer_load_dwordx4 v15, s[48:51], s86 offen offset:3072 lds
    s_add_u32 s86, s86, 4096
    s_add_u32 m0, s86, 96384
    s_nop 0
    buffer_load_dwordx4 v15, s[48:51], s86 offen lds
    buffer_load_dwordx4 v15, s[48:51], s86 offen offset:1024 lds
    s_mov_b64 exec, 0xffff
    buffer_load_dwordx4 v15, s[48:51], s86 offen offset:2048 lds
    s_mov_b64 exec, -1
    s_add_u32 s10, s5, 1
    s_and_b32 s10, s10, 3
    s_mul_i32 s13, s10, 20480
    s_add_u32 s13, s13, s89
    s_lshl_b32 s10, s10, 12
    s_add_u32 s10, s10, s14
    s_lshl_b32 s9, s87, 8
    s_add_u32 s9, s9, s13
    s_lshl_b32 s12, s87, 14
    s_add_u32 s12, s12, s10
    s_add_u32 m0, s12, 14464
    s_nop 0
    buffer_load_dwordx4 v100, s[40:43], s9 offen lds
    s_add_u32 s87, s87, 1
    s_cmp_eq_u32 s87, 5
    s_cselect_b32 s87, 0, s87
    v_add_u32 v5, 0, v1
    v_mul_u32_u24 v7, 6554, v5
    v_lshrrev_b32 v7, 16, v7
    v_mul_u32_u24 v8, 10, v7
    v_sub_u32 v5, v5, v8
    v_and_b32 v104, 0xffffffe3, v7
    v_and_b32 v8, 12, v7
    v_lshl_or_b32 v104, v8, 1, v104
    v_bfe_u32 v8, v7, 4, 1
    v_lshl_or_b32 v104, v8, 2, v104
    v_mul_u32_u24 v104, 1280, v104
    v_lshl_add_u32 v104, v5, 4, v104
    s_lshl_b32 s9, s87, 8
    s_add_u32 s9, s9, s13
    s_lshl_b32 s12, s87, 14
    s_add_u32 s12, s12, s10
    s_add_u32 m0, s12, 14464
    s_nop 0
    buffer_load_dwordx4 v100, s[40:43], s9 offen lds
    s_add_u32 s87, s87, 1
    s_cmp_eq_u32 s87, 5
    s_cselect_b32 s87, 0, s87
    v_add_u32 v5, 64, v1
    v_mul_u32_u24 v7, 6554, v5
    v_lshrrev_b32 v7, 16, v7
    v_mul_u32_u24 v8, 10, v7
    v_sub_u32 v5, v5, v8
    v_and_b32 v105, 0xffffffe3, v7
    v_and_b32 v8, 12, v7
    v_lshl_or_b32 v105, v8, 1, v105
    v_bfe_u32 v8, v7, 4, 1
    v_lshl_or_b32 v105, v8, 2, v105
    v_mul_u32_u24 v105, 1280, v105
    v_lshl_add_u32 v105, v5, 4, v105
    s_lshl_b32 s9, s87, 8
    s_add_u32 s9, s9, s13
    s_lshl_b32 s12, s87, 14
    s_add_u32 s12, s12, s10
    s_add_u32 m0, s12, 14464
    s_nop 0
    buffer_load_dwordx4 v100, s[40:43], s9 offen lds
    s_add_u32 s87, s87, 1
    s_cmp_eq_u32 s87, 5
    s_cselect_b32 s87, 0, s87
    v_add_u32 v5, 128, v1
    v_mul_u32_u24 v7, 6554, v5
    v_lshrrev_b32 v7, 16, v7
    v_mul_u32_u24 v8, 10, v7
    v_sub_u32 v5, v5, v8
    v_and_b32 v106, 0xffffffe3, v7
    v_and_b32 v8, 12, v7
    v_lshl_or_b32 v106, v8, 1, v106
    v_bfe_u32 v8, v7, 4, 1
    v_lshl_or_b32 v106, v8, 2, v106
    v_mul_u32_u24 v106, 1280, v106
    v_lshl_add_u32 v106, v5, 4, v106
    s_lshl_b32 s9, s87, 8
    s_add_u32 s9, s9, s13
    s_lshl_b32 s12, s87, 14
    s_add_u32 s12, s12, s10
    s_add_u32 m0, s12, 14464
    s_nop 0
    buffer_load_dwordx4 v100, s[40:43], s9 offen lds
    s_add_u32 s87, s87, 1
    s_cmp_eq_u32 s87, 5
    s_cselect_b32 s87, 0, s87
    v_add_u32 v5, 192, v1
    v_mul_u32_u24 v7, 6554, v5
    v_lshrrev_b32 v7, 16, v7
    v_mul_u32_u24 v8, 10, v7
    v_sub_u32 v5, v5, v8
    v_and_b32 v107, 0xffffffe3, v7
    v_and_b32 v8, 12, v7
    v_lshl_or_b32 v107, v8, 1, v107
    v_bfe_u32 v8, v7, 4, 1
    v_lshl_or_b32 v107, v8, 2, v107
    v_mul_u32_u24 v107, 1280, v107
    v_lshl_add_u32 v107, v5, 4, v107
    s_lshl_b32 s9, s87, 8
    s_add_u32 s9, s9, s13
    s_lshl_b32 s12, s87, 14
    s_add_u32 s12, s12, s10
    s_add_u32 m0, s12, 14464
    s_nop 0
    buffer_load_dwordx4 v100, s[40:43], s9 offen lds
    s_add_u32 s87, s87, 1
    s_cmp_eq_u32 s87, 5
    s_cselect_b32 s87, 0, s87
    v_add_u32 v5, 256, v1
    v_mul_u32_u24 v7, 6554, v5
    v_lshrrev_b32 v7, 16, v7
    v_mul_u32_u24 v8, 10, v7
    v_sub_u32 v5, v5, v8
    v_and_b32 v108, 0xffffffe3, v7
    v_and_b32 v8, 12, v7
    v_lshl_or_b32 v108, v8, 1, v108
    v_bfe_u32 v8, v7, 4, 1
    v_lshl_or_b32 v108, v8, 2, v108
    v_mul_u32_u24 v108, 1280, v108
    v_lshl_add_u32 v108, v5, 4, v108
    s_mov_b64 s[44:45], s[18:19]
    s_mov_b32 s46, 819200
    s_mov_b32 s47, 0x20000
    s_mul_i32 s85, s84, 40960
    s_mul_i32 s12, s5, 160
    s_add_u32 s85, s85, s12
    s_mul_i32 s92, s84, 5120
    s_waitcnt vmcnt(5)
    s_barrier
    s_add_u32 s10, s5, 2
    s_and_b32 s10, s10, 3
    s_mul_i32 s13, s10, 20480
    s_add_u32 s13, s13, s89
    s_lshl_b32 s10, s10, 12
    s_add_u32 s10, s10, s14
    s_lshl_b32 s9, s87, 8
    s_add_u32 s9, s9, s13
    s_lshl_b32 s12, s87, 14
    s_add_u32 s12, s12, s10
    s_add_u32 m0, s12, 14464
    s_nop 0
    buffer_load_dwordx4 v100, s[40:43], s9 offen lds
    s_add_u32 s87, s87, 1
    s_cmp_eq_u32 s87, 5
    s_cselect_b32 s87, 0, s87
    s_lshl_b32 s9, s87, 8
    s_add_u32 s9, s9, s13
    s_lshl_b32 s12, s87, 14
    s_add_u32 s12, s12, s10
    s_add_u32 m0, s12, 14464
    s_nop 0
    buffer_load_dwordx4 v100, s[40:43], s9 offen lds
    s_add_u32 s87, s87, 1
    s_cmp_eq_u32 s87, 5
    s_cselect_b32 s87, 0, s87
    s_lshl_b32 s9, s87, 8
    s_add_u32 s9, s9, s13
    s_lshl_b32 s12, s87, 14
    s_add_u32 s12, s12, s10
    s_add_u32 m0, s12, 14464
    s_nop 0
    buffer_load_dwordx4 v100, s[40:43], s9 offen lds
    s_add_u32 s87, s87, 1
    s_cmp_eq_u32 s87, 5
    s_cselect_b32 s87, 0, s87
    s_lshl_b32 s9, s87, 8
    s_add_u32 s9, s9, s13
    s_lshl_b32 s12, s87, 14
    s_add_u32 s12, s12, s10
    s_add_u32 m0, s12, 14464
    s_nop 0
    buffer_load_dwordx4 v100, s[40:43], s9 offen lds
    s_add_u32 s87, s87, 1
    s_cmp_eq_u32 s87, 5
    s_cselect_b32 s87, 0, s87
    s_lshl_b32 s9, s87, 8
    s_add_u32 s9, s9, s13
    s_lshl_b32 s12, s87, 14
    s_add_u32 s12, s12, s10
    s_add_u32 m0, s12, 14464
    s_nop 0
    buffer_load_dwordx4 v100, s[40:43], s9 offen lds
    s_add_u32 s87, s87, 1
    s_cmp_eq_u32 s87, 5
    s_cselect_b32 s87, 0, s87
    s_add_u32 s10, s5, 3
    s_and_b32 s10, s10, 3
    s_mul_i32 s13, s10, 20480
    s_add_u32 s13, s13, s89
    s_lshl_b32 s10, s10, 12
    s_add_u32 s10, s10, s14
    s_lshl_b32 s9, s87, 8
    s_add_u32 s9, s9, s13
    s_lshl_b32 s12, s87, 14
    s_add_u32 s12, s12, s10
    s_add_u32 m0, s12, 14464
    s_nop 0
    buffer_load_dwordx4 v100, s[40:43], s9 offen lds
    s_add_u32 s87, s87, 1
    s_cmp_eq_u32 s87, 5
    s_cselect_b32 s87, 0, s87
    s_lshl_b32 s9, s87, 8
    s_add_u32 s9, s9, s13
    s_lshl_b32 s12, s87, 14
    s_add_u32 s12, s12, s10
    s_add_u32 m0, s12, 14464
    s_nop 0
    buffer_load_dwordx4 v100, s[40:43], s9 offen lds
    s_add_u32 s87, s87, 1
    s_cmp_eq_u32 s87, 5
    s_cselect_b32 s87, 0, s87
    s_lshl_b32 s9, s87, 8
    s_add_u32 s9, s9, s13
    s_lshl_b32 s12, s87, 14
    s_add_u32 s12, s12, s10
    s_add_u32 m0, s12, 14464
    s_nop 0
    buffer_load_dwordx4 v100, s[40:43], s9 offen lds
    s_add_u32 s87, s87, 1
    s_cmp_eq_u32 s87, 5
    s_cselect_b32 s87, 0, s87
    s_lshl_b32 s9, s87, 8
    s_add_u32 s9, s9, s13
    s_lshl_b32 s12, s87, 14
    s_add_u32 s12, s12, s10
    s_add_u32 m0, s12, 14464
    s_nop 0
    buffer_load_dwordx4 v100, s[40:43], s9 offen lds
    s_add_u32 s87, s87, 1
    s_cmp_eq_u32 s87, 5
    s_cselect_b32 s87, 0, s87
    s_lshl_b32 s9, s87, 8
    s_add_u32 s9, s9, s13
    s_lshl_b32 s12, s87, 14
    s_add_u32 s12, s12, s10
    s_add_u32 m0, s12, 14464
    s_nop 0
    buffer_load_dwordx4 v100, s[40:43], s9 offen lds
    s_add_u32 s87, s87, 1
    s_cmp_eq_u32 s87, 5
    s_cselect_b32 s87, 0, s87
    s_mul_i32 s10, s87, 163840
    s_add_u32 s10, s10, s85
    s_add_u32 m0, s92, 122112
    s_nop 0
    buffer_load_dwordx4 v104, s[44:47], s10 offen lds
    s_add_u32 m0, s92, 123136
    s_nop 0
    buffer_load_dwordx4 v105, s[44:47], s10 offen lds
    s_add_u32 m0, s92, 124160
    s_nop 0
    buffer_load_dwordx4 v106, s[44:47], s10 offen lds
    s_add_u32 m0, s92, 125184
    s_nop 0
    buffer_load_dwordx4 v107, s[44:47], s10 offen lds
    s_add_u32 m0, s92, 126208
    s_nop 0
    buffer_load_dwordx4 v108, s[44:47], s10 offen lds
    s_add_u32 s87, s87, 1
    s_cmp_eq_u32 s87, 5
    s_cselect_b32 s87, 0, s87
    s_waitcnt vmcnt(5)
    s_barrier
    s_mul_i32 s10, s87, 163840
    s_add_u32 s10, s10, s85
    s_add_u32 m0, s92, 142720
    s_nop 0
    buffer_load_dwordx4 v104, s[44:47], s10 offen lds
    s_add_u32 m0, s92, 143744
    s_nop 0
    buffer_load_dwordx4 v105, s[44:47], s10 offen lds
    s_add_u32 m0, s92, 144768
    s_nop 0
    buffer_load_dwordx4 v106, s[44:47], s10 offen lds
    s_add_u32 m0, s92, 145792
    s_nop 0
    buffer_load_dwordx4 v107, s[44:47], s10 offen lds
    s_add_u32 m0, s92, 146816
    s_nop 0
    buffer_load_dwordx4 v108, s[44:47], s10 offen lds
    s_add_u32 s87, s87, 1
    s_cmp_eq_u32 s87, 5
    s_cselect_b32 s87, 0, s87
    s_mov_b64 s[60:61], s[34:35]
    s_mov_b32 s62, 256
    s_mov_b32 s63, 0x20000
    s_mov_b64 s[56:57], s[36:37]
    s_mov_b32 s58, 16777216
    s_mov_b32 s59, 0x20000
    s_mov_b64 s[64:65], s[32:33]
    s_mov_b32 s66, 5242880
    s_mov_b32 s67, 0x20000
    buffer_load_dword v48, v4, s[60:63], 0 offen sc1
    s_waitcnt vmcnt(6)
    s_barrier
    s_mul_i32 s10, s87, 163840
    s_add_u32 s10, s10, s85
    s_add_u32 m0, s92, 100480
    s_nop 0
    buffer_load_dwordx4 v104, s[44:47], s10 offen lds
    s_add_u32 m0, s92, 101504
    s_nop 0
    buffer_load_dwordx4 v105, s[44:47], s10 offen lds
    s_add_u32 m0, s92, 102528
    s_nop 0
    buffer_load_dwordx4 v106, s[44:47], s10 offen lds
    s_add_u32 m0, s92, 103552
    s_nop 0
    buffer_load_dwordx4 v107, s[44:47], s10 offen lds
    s_add_u32 m0, s92, 104576
    s_nop 0
    buffer_load_dwordx4 v108, s[44:47], s10 offen lds
    s_add_u32 s87, s87, 1
    s_cmp_eq_u32 s87, 5
    s_cselect_b32 s87, 0, s87
    s_waitcnt vmcnt(6)
    s_barrier
    s_mul_i32 s10, s87, 163840
    s_add_u32 s10, s10, s85
    s_add_u32 m0, s92, 80000
    s_nop 0
    buffer_load_dwordx4 v104, s[44:47], s10 offen lds
    s_add_u32 m0, s92, 81024
    s_nop 0
    buffer_load_dwordx4 v105, s[44:47], s10 offen lds
    s_add_u32 m0, s92, 82048
    s_nop 0
    buffer_load_dwordx4 v106, s[44:47], s10 offen lds
    s_add_u32 m0, s92, 83072
    s_nop 0
    buffer_load_dwordx4 v107, s[44:47], s10 offen lds
    s_add_u32 m0, s92, 84096
    s_nop 0
    buffer_load_dwordx4 v108, s[44:47], s10 offen lds
    s_add_u32 s87, s87, 1
    s_cmp_eq_u32 s87, 5
    s_cselect_b32 s87, 0, s87
    s_waitcnt vmcnt(10)
    v_cmp_eq_u32 vcc, 0, v48
    s_cbranch_vccz Lok_tok_102
    s_mov_b32 s96, 400000
Lre_tok_103:
    s_sleep 2
    buffer_load_dword v48, v4, s[60:63], 0 offen sc1
    s_waitcnt vmcnt(0)
    v_cmp_eq_u32 vcc, 0, v48
    s_sub_u32 s96, s96, 1
    s_cmp_eq_u32 s96, 0
    s_cbranch_scc1 Lok_tok_102
    s_cbranch_vccnz Lre_tok_103
Lok_tok_102:
    v_readfirstlane_b32 s8, v48
    v_add_u32 v30, 121600, v15
    v_min_u32 v5, 32, v1
    v_lshlrev_b32 v5, 3, v5
    v_add_u32 v31, 121600, v5
    v_and_b32 v5, 31, v1
    v_lshrrev_b32 v7, 5, v1
    v_mul_u32_u24 v7, 336, v7
    v_lshl_add_u32 v5, v5, 4, v7
    v_add_u32 v54, 121600, v5
    s_mov_b32 exec_lo, 0x100000
    s_mov_b32 exec_hi, 0x100000
    v_mov_b32 v54, 121920
    s_mov_b32 exec_lo, 0xffe00000
    s_mov_b32 exec_hi, 0xffe00000
    v_mov_b32 v54, 122256
    s_mov_b64 exec, -1
    s_waitcnt vmcnt(5)
    s_barrier
    s_mul_i32 s10, s87, 163840
    s_add_u32 s10, s10, s85
    s_add_u32 m0, s92, 59520
    s_nop 0
    buffer_load_dwordx4 v104, s[44:47], s10 offen lds
    s_add_u32 m0, s92, 60544
    s_nop 0
    buffer_load_dwordx4 v105, s[44:47], s10 offen lds
    s_add_u32 m0, s92, 61568
    s_nop 0
    buffer_load_dwordx4 v106, s[44:47], s10 offen lds
    s_add_u32 m0, s92, 62592
    s_nop 0
    buffer_load_dwordx4 v107, s[44:47], s10 offen lds
    s_add_u32 m0, s92, 63616
    s_nop 0
    buffer_load_dwordx4 v108, s[44:47], s10 offen lds
    s_add_u32 s87, s87, 1
    s_cmp_eq_u32 s87, 5
    s_cselect_b32 s87, 0, s87
    s_cmp_lg_u32 s3, 4
    s_cbranch_scc1 Lw_104
    s_mov_b32 s97, 159744
    buffer_load_dwordx4 v[168:171], v15, s[56:59], s97 offen offset:0 sc1
    buffer_load_dwordx4 v[172:175], v15, s[56:59], s97 offen offset:1024 sc1
    buffer_load_dwordx4 v[176:179], v15, s[56:59], s97 offen offset:2048 sc1
    buffer_load_dwordx4 v[180:183], v15, s[56:59], s97 offen offset:3072 sc1
Lw_104:
    s_waitcnt vmcnt(5)
    s_barrier
    v_mov_b32 v96, 0
    v_mov_b32 v97, 0
    v_mov_b32 v98, 0
    v_mov_b32 v99, 0
    v_mov_b32 v100, 0
    v_mov_b32 v101, 0
    v_mov_b32 v102, 0
    v_mov_b32 v103, 0
    v_mov_b32 v104, 0
    v_mov_b32 v105, 0
    v_mov_b32 v106, 0
    v_mov_b32 v107, 0
    v_mov_b32 v108, 0
    v_mov_b32 v109, 0
    v_mov_b32 v110, 0
    v_mov_b32 v111, 0
    v_mov_b32 v112, 0
    v_mov_b32 v113, 0
    v_mov_b32 v114, 0
    v_mov_b32 v115, 0
    v_mov_b32 v116, 0
    v_mov_b32 v117, 0
    v_mov_b32 v118, 0
    v_mov_b32 v119, 0
    v_mov_b32 v120, 0
    v_mov_b32 v121, 0
    v_mov_b32 v122, 0
    v_mov_b32 v123, 0
    v_mov_b32 v124, 0
    v_mov_b32 v125, 0
    v_mov_b32 v126, 0
    v_mov_b32 v127, 0
    v_mov_b32 v128, 0
    v_mov_b32 v129, 0
    v_mov_b32 v130, 0
    v_mov_b32 v131, 0
    v_mov_b32 v132, 0
    v_mov_b32 v133, 0
    v_mov_b32 v134, 0
    v_mov_b32 v135, 0
    v_mov_b32 v160, 0
    v_mov_b32 v161, 0
    v_mov_b32 v162, 0
    v_mov_b32 v163, 0
    v_mov_b32 v164, 0
    v_mov_b32 v165, 0
    v_mov_b32 v166, 0
    v_mov_b32 v167, 0
    s_and_b32 s97, s84, 1
    s_mul_i32 s98, s5, 10
    s_lshl_b32 s52, s97, 2
    s_add_u32 s52, s52, s98
    s_add_u32 s51, s52, 2
    s_add_u32 s53, s98, s97
    s_add_u32 s53, s53, 8
    s_mul_i32 s98, s4, 81920
    s_and_b32 s97, s84, 2
    s_lshl_b32 s97, s97, 10
    s_add_u32 s98, s98, s97
    s_add_u32 s98, s98, 2097152
    s_and_b32 s97, s52, 3
    s_lshl_b32 s97, s97, 8
    s_lshr_b32 s52, s52, 2
    s_lshl_b32 s52, s52, 12
    s_add_u32 s52, s52, s97
    s_add_u32 s52, s52, s98
    s_and_b32 s97, s51, 3
    s_lshl_b32 s97, s97, 8
    s_lshr_b32 s51, s51, 2
    s_lshl_b32 s51, s51, 12
    s_add_u32 s51, s51, s97
    s_add_u32 s51, s51, s98
    s_and_b32 s97, s53, 3
    s_lshl_b32 s97, s97, 8
    s_lshr_b32 s53, s53, 2
    s_lshl_b32 s53, s53, 12
    s_add_u32 s53, s53, s97
    s_add_u32 s53, s53, s98
    v_lshrrev_b32 v55, 1, v3
    v_lshlrev_b32 v55, 8, v55
    v_and_b32 v5, 1, v3
    v_lshl_add_u32 v55, v5, 10, v55
    v_lshl_add_u32 v55, v2, 4, v55
    v_mov_b32 v150, 1
    v_lshlrev_b32 v149, 2, v1
    v_add_u32 v149, 103412, v149
    s_mov_b64 exec, 0x1
    v_mov_b32 v149, 0
    s_mov_b64 exec, -1
    s_setprio 2
    s_mov_b32 s9, 4
    v_add_u32 v52, 14464, v15
    v_add_u32 v53, 65664, v15
    s_mov_b64 s[94:95], -1
    s_mul_i32 s13, s4, 81920
    s_lshl_b32 s98, s84, 10
    s_add_u32 s13, s13, s98
    s_add_u32 s13, s13, 5242880
    s_lshl_b32 s12, s84, 11
    v_add_u32 v7, s12, v15
    s_lshl_b32 s12, s84, 10
    v_lshl_add_u32 v8, v1, 3, s12
    v_mov_b32 v20, 0
    v_mov_b32 v21, 0
    v_mov_b32 v26, 0
    v_mov_b32 v27, 0
    s_waitcnt vmcnt(0)
    s_barrier
    s_cmp_lg_u32 s3, 4
    s_cbranch_scc1 Lw_105
    s_waitcnt vmcnt(0)
    v_xor_b32 v9, s8, v168
    v_xor_b32 v10, s8, v170
    v_or_b32 v9, v9, v10
    v_xor_b32 v10, s8, v172
    v_or_b32 v9, v9, v10
    v_xor_b32 v10, s8, v174
    v_or_b32 v9, v9, v10
    v_xor_b32 v10, s8, v176
    v_or_b32 v9, v9, v10
    v_xor_b32 v10, s8, v178
    v_or_b32 v9, v9, v10
    v_xor_b32 v10, s8, v180
    v_or_b32 v9, v9, v10
    v_xor_b32 v10, s8, v182
    v_or_b32 v9, v9, v10
    v_cmp_ne_u32 vcc, 0, v9
    s_cbranch_vccz Lok_s1_106
    s_mov_b32 s96, 400000
Lre_s1_107:
    s_sleep 2
    s_mov_b32 s97, 159744
    buffer_load_dwordx4 v[168:171], v15, s[56:59], s97 offen offset:0 sc1
    buffer_load_dwordx4 v[172:175], v15, s[56:59], s97 offen offset:1024 sc1
    buffer_load_dwordx4 v[176:179], v15, s[56:59], s97 offen offset:2048 sc1
    buffer_load_dwordx4 v[180:183], v15, s[56:59], s97 offen offset:3072 sc1
    s_waitcnt vmcnt(0)
    v_xor_b32 v9, s8, v168
    v_xor_b32 v10, s8, v170
    v_or_b32 v9, v9, v10
    v_xor_b32 v10, s8, v172
    v_or_b32 v9, v9, v10
    v_xor_b32 v10, s8, v174
    v_or_b32 v9, v9, v10
    v_xor_b32 v10, s8, v176
    v_or_b32 v9, v9, v10
    v_xor_b32 v10, s8, v178
    v_or_b32 v9, v9, v10
    v_xor_b32 v10, s8, v180
    v_or_b32 v9, v9, v10
    v_xor_b32 v10, s8, v182
    v_or_b32 v9, v9, v10
    v_cmp_ne_u32 vcc, 0, v9
    s_sub_u32 s96, s96, 1
    s_cmp_eq_u32 s96, 0
    s_cbranch_scc1 Lok_s1_106
    s_cbranch_vccnz Lre_s1_107
Lok_s1_106:
    s_add_u32 s99, s5, 0
    s_and_b32 s99, s99, 7
    s_mul_i32 s99, s99, 21120
    s_add_u32 s99, s99, 1310720
    s_mov_b32 m0, 121600
    s_nop 0
    buffer_load_dwordx4 v15, s[56:59], s99 offen sc1 lds
    buffer_load_dwordx4 v15, s[56:59], s99 offen offset:1024 sc1 lds
    buffer_load_dwordx4 v15, s[56:59], s99 offen offset:2048 sc1 lds
    buffer_load_dwordx4 v15, s[56:59], s99 offen offset:3072 sc1 lds
    s_add_u32 s99, s99, 4096
    s_mov_b32 m0, 125696
    s_nop 0
    buffer_load_dwordx4 v15, s[56:59], s99 offen sc1 lds
    buffer_load_dwordx4 v15, s[56:59], s99 offen offset:1024 sc1 lds
    buffer_load_dwordx4 v15, s[56:59], s99 offen offset:2048 sc1 lds
    buffer_load_dwordx4 v15, s[56:59], s99 offen offset:3072 sc1 lds
    s_add_u32 s99, s99, 4096
    s_mov_b32 m0, 129792
    s_nop 0
    buffer_load_dwordx4 v15, s[56:59], s99 offen sc1 lds
    buffer_load_dwordx4 v15, s[56:59], s99 offen offset:1024 sc1 lds
    buffer_load_dwordx4 v15, s[56:59], s99 offen offset:2048 sc1 lds
    buffer_load_dwordx4 v15, s[56:59], s99 offen offset:3072 sc1 lds
    s_add_u32 s99, s99, 4096
    s_mov_b32 m0, 133888
    s_nop 0
    buffer_load_dwordx4 v15, s[56:59], s99 offen sc1 lds
    buffer_load_dwordx4 v15, s[56:59], s99 offen offset:1024 sc1 lds
    buffer_load_dwordx4 v15, s[56:59], s99 offen offset:2048 sc1 lds
    buffer_load_dwordx4 v15, s[56:59], s99 offen offset:3072 sc1 lds
    s_add_u32 s99, s99, 4096
    s_mov_b32 m0, 137984
    s_nop 0
    buffer_load_dwordx4 v15, s[56:59], s99 offen sc1 lds
    buffer_load_dwordx4 v15, s[56:59], s99 offen offset:1024 sc1 lds
    buffer_load_dwordx4 v15, s[56:59], s99 offen offset:2048 sc1 lds
    buffer_load_dwordx4 v15, s[56:59], s99 offen offset:3072 sc1 lds
    s_add_u32 s99, s99, 4096
    s_mov_b32 m0, 142080
    s_mov_b32 exec_lo, 0xffffffff
    s_mov_b32 exec_hi, 0xff
    buffer_load_dwordx4 v15, s[56:59], s99 offen sc1 lds
    s_mov_b64 exec, -1
    v_max3_u32 v169, v169, v173, v177
    v_max_u32 v169, v169, v181
    v_max3_u32 v171, v171, v175, v179
    v_max_u32 v171, v171, v183
    v_max_u32_dpp v169, v169, v169 row_ror:8 row_mask:0xf bank_mask:0xf
    s_nop 0
    v_max_u32_dpp v171, v171, v171 row_ror:8 row_mask:0xf bank_mask:0xf
    v_max_u32_dpp v169, v169, v169 row_ror:4 row_mask:0xf bank_mask:0xf
    s_nop 0
    v_max_u32_dpp v171, v171, v171 row_ror:4 row_mask:0xf bank_mask:0xf
    v_max_u32_dpp v169, v169, v169 row_ror:2 row_mask:0xf bank_mask:0xf
    s_nop 0
    v_max_u32_dpp v171, v171, v171 row_ror:2 row_mask:0xf bank_mask:0xf
    v_max_u32_dpp v169, v169, v169 row_ror:1 row_mask:0xf bank_mask:0xf
    s_nop 0
    v_max_u32_dpp v171, v171, v171 row_ror:1 row_mask:0xf bank_mask:0xf
    v_mov_b32 v9, v169
    v_mov_b32 v10, v171
    s_nop 0
    v_permlane16_swap_b32 v9, v169
    v_permlane16_swap_b32 v10, v171
    v_max_u32 v169, v169, v9
    v_max_u32 v171, v171, v10
    v_mov_b32 v9, v169
    v_mov_b32 v10, v171
    s_nop 0
    v_permlane32_swap_b32 v9, v169
    v_permlane32_swap_b32 v10, v171
    v_max_u32 v169, v169, v9
    v_max_u32 v171, v171, v10
    v_add_f32 v14, v169, v171
    v_sqrt_f32 v14, v14
    s_nop 0
    v_mul_f32 v14, 0xbf820000, v14
    ds_write_b32 v4, v14 offset:14340
    s_waitcnt vmcnt(0) lgkmcnt(0)
Lw_105:
    s_barrier
    ds_read_b128 v[16:19], v7 offset:0
    ds_read_b128 v[22:25], v7 offset:1024
    s_mov_b32 exec_lo, 0xffffffff
    s_mov_b32 exec_hi, 0x0
    ds_read_b64 v[20:21], v8 offset:10240
    ds_read_b64 v[26:27], v8 offset:10752
    s_mov_b64 exec, -1
    ds_read_b32 v14, v4 offset:14340
    ds_read_b128 v[136:139], v30 offset:0
    ds_read_b64 v[140:141], v31 offset:1024
    ds_read_b128 v[152:155], v54 offset:1296
    ds_read_b128 v[156:159], v54 offset:1968
    ds_read_b128 v[142:145], v30 offset:2640
    ds_read_b64 v[146:147], v31 offset:3664
    s_waitcnt lgkmcnt(7)
    v_dot2_f32_bf16 v28, v16, v16, 0
    v_dot2_f32_bf16 v29, v17, v17, 0
    v_dot2_f32_bf16 v32, v22, v22, 0
    v_dot2_f32_bf16 v33, v23, v23, 0
    v_dot2_f32_bf16 v28, v18, v18, v28
    v_dot2_f32_bf16 v29, v19, v19, v29
    v_dot2_f32_bf16 v32, v24, v24, v32
    v_dot2_f32_bf16 v33, v25, v25, v33
    v_dot2_f32_bf16 v28, v20, v20, v28
    v_dot2_f32_bf16 v29, v21, v21, v29
    v_dot2_f32_bf16 v32, v26, v26, v32
    v_dot2_f32_bf16 v33, v27, v27, v33
    ds_add_u32 v149, v150 offset:14380
    v_add_f32 v28, v28, v29
    s_nop 0
    v_add_f32 v32, v32, v33
    v_mov_b32 v29, v28
    v_mov_b32 v33, v32
    s_nop 0
    v_permlane32_swap_b32 v29, v28
    v_permlane32_swap_b32 v33, v32
    v_add_f32 v28, v28, v29
    v_add_f32 v32, v32, v33
    v_sqrt_f32 v28, v28
    v_sqrt_f32 v32, v32
    s_waitcnt lgkmcnt(5)
    v_mfma_f32_32x32x16_bf16 v[64:79], v[136:139], v[16:19], 0
    s_mov_b32 exec_lo, 0x0
    s_mov_b32 exec_hi, 0xffffffff
    v_mul_f32 v28, v14, v28
    v_mul_f32 v32, v14, v32
    v_cvt_pk_bf16_f32 v20, v28, v4
    v_cvt_pk_bf16_f32 v26, v32, v4
    s_mov_b64 exec, -1
    v_mfma_f32_32x32x8_bf16 v[64:79], v[140:141], v[20:21], v[64:79]
L_attn:
    v_mfma_f32_32x32x16_bf16 v[80:95], v[136:139], v[22:25], 0
    s_nop 10
    v_exp_f32 v64, v64
    v_exp_f32 v65, v65
    v_exp_f32 v66, v66
    v_exp_f32 v67, v67
    v_cvt_pk_bf16_f32 v96, v64, v65
    v_mfma_f32_32x32x8_bf16 v[80:95], v[140:141], v[26:27], v[80:95]
    v_exp_f32 v68, v68
    v_exp_f32 v69, v69
    v_cvt_pk_bf16_f32 v97, v66, v67
    v_exp_f32 v70, v70
    v_exp_f32 v71, v71
    v_mfma_f32_32x32x16_bf16 v[120:135], v[164:167], v[100:103], v[120:135]
    v_cvt_pk_bf16_f32 v98, v68, v69
    v_exp_f32 v72, v72
    v_exp_f32 v73, v73
    v_cvt_pk_bf16_f32 v99, v70, v71
    v_exp_f32 v74, v74
    v_exp_f32 v75, v75
    s_waitcnt lgkmcnt(0)
    v_mfma_f32_32x32x16_bf16 v[104:119], v[152:155], v[96:99], v[104:119]
    v_cvt_pk_bf16_f32 v100, v72, v73
    v_exp_f32 v76, v76
    v_exp_f32 v77, v77
    v_cvt_pk_bf16_f32 v101, v74, v75
    v_exp_f32 v78, v78
    v_exp_f32 v79, v79
    v_cvt_pk_bf16_f32 v102, v76, v77
    v_cvt_pk_bf16_f32 v103, v78, v79
    v_mfma_f32_32x32x16_bf16 v[64:79], v[142:145], v[16:19], 0
    ds_read_b128 v[160:163], v54 offset:3936
    v_exp_f32 v80, v80
    v_exp_f32 v81, v81
    v_exp_f32 v82, v82
    v_exp_f32 v83, v83
    v_cvt_pk_bf16_f32 v96, v80, v81
    v_mfma_f32_32x32x8_bf16 v[64:79], v[146:147], v[20:21], v[64:79]
    ds_read_b128 v[164:167], v54 offset:4608
    v_exp_f32 v84, v84
    v_exp_f32 v85, v85
    v_cvt_pk_bf16_f32 v97, v82, v83
    v_exp_f32 v86, v86
    v_exp_f32 v87, v87
    v_mfma_f32_32x32x16_bf16 v[104:119], v[156:159], v[100:103], v[104:119]
    ds_read_b128 v[136:139], v30 offset:5280
    v_cvt_pk_bf16_f32 v98, v84, v85
    v_exp_f32 v88, v88
    v_exp_f32 v89, v89
    v_cvt_pk_bf16_f32 v99, v86, v87
    v_exp_f32 v90, v90
    v_exp_f32 v91, v91
    v_mfma_f32_32x32x16_bf16 v[120:135], v[152:155], v[96:99], v[120:135]
    ds_read_b64 v[140:141], v31 offset:6304
    v_cvt_pk_bf16_f32 v100, v88, v89
    v_exp_f32 v92, v92
    v_exp_f32 v93, v93
    v_cvt_pk_bf16_f32 v101, v90, v91
    v_exp_f32 v94, v94
    v_exp_f32 v95, v95
    v_cvt_pk_bf16_f32 v102, v92, v93
    v_cvt_pk_bf16_f32 v103, v94, v95
    v_mfma_f32_32x32x16_bf16 v[80:95], v[142:145], v[22:25], 0
    v_exp_f32 v64, v64
    v_exp_f32 v65, v65
    v_exp_f32 v66, v66
    v_exp_f32 v67, v67
    v_cvt_pk_bf16_f32 v96, v64, v65
    v_mfma_f32_32x32x8_bf16 v[80:95], v[146:147], v[26:27], v[80:95]
    v_exp_f32 v68, v68
    v_exp_f32 v69, v69
    v_cvt_pk_bf16_f32 v97, v66, v67
    v_exp_f32 v70, v70
    v_exp_f32 v71, v71
    v_mfma_f32_32x32x16_bf16 v[120:135], v[156:159], v[100:103], v[120:135]
    v_cvt_pk_bf16_f32 v98, v68, v69
    v_exp_f32 v72, v72
    v_exp_f32 v73, v73
    v_cvt_pk_bf16_f32 v99, v70, v71
    v_exp_f32 v74, v74
    v_exp_f32 v75, v75
    s_waitcnt lgkmcnt(0)
    v_mfma_f32_32x32x16_bf16 v[104:119], v[160:163], v[96:99], v[104:119]
    v_cvt_pk_bf16_f32 v100, v72, v73
    v_exp_f32 v76, v76
    v_exp_f32 v77, v77
    v_cvt_pk_bf16_f32 v101, v74, v75
    v_exp_f32 v78, v78
    v_exp_f32 v79, v79
    v_cvt_pk_bf16_f32 v102, v76, v77
    v_cvt_pk_bf16_f32 v103, v78, v79
    v_mfma_f32_32x32x16_bf16 v[64:79], v[136:139], v[16:19], 0
    ds_read_b128 v[152:155], v54 offset:6576
    v_exp_f32 v80, v80
    v_exp_f32 v81, v81
    v_exp_f32 v82, v82
    v_exp_f32 v83, v83
    v_cvt_pk_bf16_f32 v96, v80, v81
    v_mfma_f32_32x32x8_bf16 v[64:79], v[140:141], v[20:21], v[64:79]
    ds_read_b128 v[156:159], v54 offset:7248
    v_exp_f32 v84, v84
    v_exp_f32 v85, v85
    v_cvt_pk_bf16_f32 v97, v82, v83
    v_exp_f32 v86, v86
    v_exp_f32 v87, v87
    v_mfma_f32_32x32x16_bf16 v[104:119], v[164:167], v[100:103], v[104:119]
    ds_read_b128 v[142:145], v30 offset:7920
    v_cvt_pk_bf16_f32 v98, v84, v85
    v_exp_f32 v88, v88
    v_exp_f32 v89, v89
    v_cvt_pk_bf16_f32 v99, v86, v87
    v_exp_f32 v90, v90
    v_exp_f32 v91, v91
    v_mfma_f32_32x32x16_bf16 v[120:135], v[160:163], v[96:99], v[120:135]
    ds_read_b64 v[146:147], v31 offset:8944
    v_cvt_pk_bf16_f32 v100, v88, v89
    v_exp_f32 v92, v92
    v_exp_f32 v93, v93
    v_cvt_pk_bf16_f32 v101, v90, v91
    v_exp_f32 v94, v94
    v_exp_f32 v95, v95
    v_cvt_pk_bf16_f32 v102, v92, v93
    v_cvt_pk_bf16_f32 v103, v94, v95
    v_mfma_f32_32x32x16_bf16 v[80:95], v[136:139], v[22:25], 0
    v_exp_f32 v64, v64
    v_exp_f32 v65, v65
    v_exp_f32 v66, v66
    v_exp_f32 v67, v67
    v_cvt_pk_bf16_f32 v96, v64, v65
    v_mfma_f32_32x32x8_bf16 v[80:95], v[140:141], v[26:27], v[80:95]
    v_exp_f32 v68, v68
    v_exp_f32 v69, v69
    v_cvt_pk_bf16_f32 v97, v66, v67
    v_exp_f32 v70, v70
    v_exp_f32 v71, v71
    v_mfma_f32_32x32x16_bf16 v[120:135], v[164:167], v[100:103], v[120:135]
    v_cvt_pk_bf16_f32 v98, v68, v69
    v_exp_f32 v72, v72
    v_exp_f32 v73, v73
    v_cvt_pk_bf16_f32 v99, v70, v71
    v_exp_f32 v74, v74
    v_exp_f32 v75, v75
    s_waitcnt lgkmcnt(0)
    v_mfma_f32_32x32x16_bf16 v[104:119], v[152:155], v[96:99], v[104:119]
    v_cvt_pk_bf16_f32 v100, v72, v73
    v_exp_f32 v76, v76
    v_exp_f32 v77, v77
    v_cvt_pk_bf16_f32 v101, v74, v75
    v_exp_f32 v78, v78
    v_exp_f32 v79, v79
    v_cvt_pk_bf16_f32 v102, v76, v77
    v_cvt_pk_bf16_f32 v103, v78, v79
    v_mfma_f32_32x32x16_bf16 v[64:79], v[142:145], v[16:19], 0
    ds_read_b128 v[160:163], v54 offset:9216
    v_exp_f32 v80, v80
    v_exp_f32 v81, v81
    v_exp_f32 v82, v82
    v_exp_f32 v83, v83
    v_cvt_pk_bf16_f32 v96, v80, v81
    v_mfma_f32_32x32x8_bf16 v[64:79], v[146:147], v[20:21], v[64:79]
    ds_read_b128 v[164:167], v54 offset:9888
    v_exp_f32 v84, v84
    v_exp_f32 v85, v85
    v_cvt_pk_bf16_f32 v97, v82, v83
    v_exp_f32 v86, v86
    v_exp_f32 v87, v87
    v_mfma_f32_32x32x16_bf16 v[104:119], v[156:159], v[100:103], v[104:119]
    ds_read_b128 v[136:139], v30 offset:10560
    v_cvt_pk_bf16_f32 v98, v84, v85
    v_exp_f32 v88, v88
    v_exp_f32 v89, v89
    v_cvt_pk_bf16_f32 v99, v86, v87
    v_exp_f32 v90, v90
    v_exp_f32 v91, v91
    v_mfma_f32_32x32x16_bf16 v[120:135], v[152:155], v[96:99], v[120:135]
    ds_read_b64 v[140:141], v31 offset:11584
    v_cvt_pk_bf16_f32 v100, v88, v89
    v_exp_f32 v92, v92
    v_exp_f32 v93, v93
    v_cvt_pk_bf16_f32 v101, v90, v91
    v_exp_f32 v94, v94
    v_exp_f32 v95, v95
    v_cvt_pk_bf16_f32 v102, v92, v93
    v_cvt_pk_bf16_f32 v103, v94, v95
    v_mfma_f32_32x32x16_bf16 v[80:95], v[142:145], v[22:25], 0
    v_exp_f32 v64, v64
    v_exp_f32 v65, v65
    v_exp_f32 v66, v66
    v_exp_f32 v67, v67
    v_cvt_pk_bf16_f32 v96, v64, v65
    v_mfma_f32_32x32x8_bf16 v[80:95], v[146:147], v[26:27], v[80:95]
    v_exp_f32 v68, v68
    v_exp_f32 v69, v69
    v_cvt_pk_bf16_f32 v97, v66, v67
    v_exp_f32 v70, v70
    v_exp_f32 v71, v71
    v_mfma_f32_32x32x16_bf16 v[120:135], v[156:159], v[100:103], v[120:135]
    v_cvt_pk_bf16_f32 v98, v68, v69
    v_exp_f32 v72, v72
    v_exp_f32 v73, v73
    v_cvt_pk_bf16_f32 v99, v70, v71
    v_exp_f32 v74, v74
    v_exp_f32 v75, v75
    s_waitcnt lgkmcnt(0)
    v_mfma_f32_32x32x16_bf16 v[104:119], v[160:163], v[96:99], v[104:119]
    v_cvt_pk_bf16_f32 v100, v72, v73
    v_exp_f32 v76, v76
    v_exp_f32 v77, v77
    v_cvt_pk_bf16_f32 v101, v74, v75
    v_exp_f32 v78, v78
    v_exp_f32 v79, v79
    v_cvt_pk_bf16_f32 v102, v76, v77
    v_cvt_pk_bf16_f32 v103, v78, v79
    v_mfma_f32_32x32x16_bf16 v[64:79], v[136:139], v[16:19], 0
    ds_read_b128 v[152:155], v54 offset:11856
    v_exp_f32 v80, v80
    v_exp_f32 v81, v81
    v_exp_f32 v82, v82
    v_exp_f32 v83, v83
    v_cvt_pk_bf16_f32 v96, v80, v81
    v_mfma_f32_32x32x8_bf16 v[64:79], v[140:141], v[20:21], v[64:79]
    ds_read_b128 v[156:159], v54 offset:12528
    v_exp_f32 v84, v84
    v_exp_f32 v85, v85
    v_cvt_pk_bf16_f32 v97, v82, v83
    v_exp_f32 v86, v86
    v_exp_f32 v87, v87
    v_mfma_f32_32x32x16_bf16 v[104:119], v[164:167], v[100:103], v[104:119]
    ds_read_b128 v[142:145], v30 offset:13200
    v_cvt_pk_bf16_f32 v98, v84, v85
    v_exp_f32 v88, v88
    v_exp_f32 v89, v89
    v_cvt_pk_bf16_f32 v99, v86, v87
    v_exp_f32 v90, v90
    v_exp_f32 v91, v91
    v_mfma_f32_32x32x16_bf16 v[120:135], v[160:163], v[96:99], v[120:135]
    ds_read_b64 v[146:147], v31 offset:14224
    v_cvt_pk_bf16_f32 v100, v88, v89
    v_exp_f32 v92, v92
    v_exp_f32 v93, v93
    v_cvt_pk_bf16_f32 v101, v90, v91
    v_exp_f32 v94, v94
    v_exp_f32 v95, v95
    v_cvt_pk_bf16_f32 v102, v92, v93
    v_cvt_pk_bf16_f32 v103, v94, v95
    v_mfma_f32_32x32x16_bf16 v[80:95], v[136:139], v[22:25], 0
    v_exp_f32 v64, v64
    v_exp_f32 v65, v65
    v_exp_f32 v66, v66
    v_exp_f32 v67, v67
    v_cvt_pk_bf16_f32 v96, v64, v65
    v_mfma_f32_32x32x8_bf16 v[80:95], v[140:141], v[26:27], v[80:95]
    v_exp_f32 v68, v68
    v_exp_f32 v69, v69
    v_cvt_pk_bf16_f32 v97, v66, v67
    v_exp_f32 v70, v70
    v_exp_f32 v71, v71
    v_mfma_f32_32x32x16_bf16 v[120:135], v[164:167], v[100:103], v[120:135]
    v_cvt_pk_bf16_f32 v98, v68, v69
    v_exp_f32 v72, v72
    v_exp_f32 v73, v73
    v_cvt_pk_bf16_f32 v99, v70, v71
    v_exp_f32 v74, v74
    v_exp_f32 v75, v75
    s_waitcnt lgkmcnt(0)
    v_mfma_f32_32x32x16_bf16 v[104:119], v[152:155], v[96:99], v[104:119]
    v_cvt_pk_bf16_f32 v100, v72, v73
    v_exp_f32 v76, v76
    v_exp_f32 v77, v77
    v_cvt_pk_bf16_f32 v101, v74, v75
    v_exp_f32 v78, v78
    v_exp_f32 v79, v79
    v_cvt_pk_bf16_f32 v102, v76, v77
    v_cvt_pk_bf16_f32 v103, v78, v79
    v_mfma_f32_32x32x16_bf16 v[64:79], v[142:145], v[16:19], 0
    ds_read_b128 v[160:163], v54 offset:14496
    v_exp_f32 v80, v80
    v_exp_f32 v81, v81
    v_exp_f32 v82, v82
    v_exp_f32 v83, v83
    v_cvt_pk_bf16_f32 v96, v80, v81
    v_mfma_f32_32x32x8_bf16 v[64:79], v[146:147], v[20:21], v[64:79]
    ds_read_b128 v[164:167], v54 offset:15168
    v_exp_f32 v84, v84
    v_exp_f32 v85, v85
    v_cvt_pk_bf16_f32 v97, v82, v83
    v_exp_f32 v86, v86
    v_exp_f32 v87, v87
    v_mfma_f32_32x32x16_bf16 v[104:119], v[156:159], v[100:103], v[104:119]
    ds_read_b128 v[136:139], v30 offset:15840
    v_cvt_pk_bf16_f32 v98, v84, v85
    v_exp_f32 v88, v88
    v_exp_f32 v89, v89
    v_cvt_pk_bf16_f32 v99, v86, v87
    v_exp_f32 v90, v90
    v_exp_f32 v91, v91
    v_mfma_f32_32x32x16_bf16 v[120:135], v[152:155], v[96:99], v[120:135]
    ds_read_b64 v[140:141], v31 offset:16864
    v_cvt_pk_bf16_f32 v100, v88, v89
    v_exp_f32 v92, v92
    v_exp_f32 v93, v93
    v_cvt_pk_bf16_f32 v101, v90, v91
    v_exp_f32 v94, v94
    v_exp_f32 v95, v95
    v_cvt_pk_bf16_f32 v102, v92, v93
    v_cvt_pk_bf16_f32 v103, v94, v95
    v_mfma_f32_32x32x16_bf16 v[80:95], v[142:145], v[22:25], 0
    v_exp_f32 v64, v64
    v_exp_f32 v65, v65
    v_exp_f32 v66, v66
    v_exp_f32 v67, v67
    v_cvt_pk_bf16_f32 v96, v64, v65
    v_mfma_f32_32x32x8_bf16 v[80:95], v[146:147], v[26:27], v[80:95]
    v_exp_f32 v68, v68
    v_exp_f32 v69, v69
    v_cvt_pk_bf16_f32 v97, v66, v67
    v_exp_f32 v70, v70
    v_exp_f32 v71, v71
    v_mfma_f32_32x32x16_bf16 v[120:135], v[156:159], v[100:103], v[120:135]
    v_cvt_pk_bf16_f32 v98, v68, v69
    v_exp_f32 v72, v72
    v_exp_f32 v73, v73
    v_cvt_pk_bf16_f32 v99, v70, v71
    v_exp_f32 v74, v74
    v_exp_f32 v75, v75
    s_waitcnt lgkmcnt(0)
    v_mfma_f32_32x32x16_bf16 v[104:119], v[160:163], v[96:99], v[104:119]
    v_cvt_pk_bf16_f32 v100, v72, v73
    v_exp_f32 v76, v76
    v_exp_f32 v77, v77
    v_cvt_pk_bf16_f32 v101, v74, v75
    v_exp_f32 v78, v78
    v_exp_f32 v79, v79
    v_cvt_pk_bf16_f32 v102, v76, v77
    v_cvt_pk_bf16_f32 v103, v78, v79
    v_mfma_f32_32x32x16_bf16 v[64:79], v[136:139], v[16:19], 0
    ds_read_b128 v[152:155], v54 offset:17136
    v_exp_f32 v80, v80
    v_exp_f32 v81, v81
    v_exp_f32 v82, v82
    v_exp_f32 v83, v83
    v_cvt_pk_bf16_f32 v96, v80, v81
    v_mfma_f32_32x32x8_bf16 v[64:79], v[140:141], v[20:21], v[64:79]
    ds_read_b128 v[156:159], v54 offset:17808
    v_exp_f32 v84, v84
    v_exp_f32 v85, v85
    v_cvt_pk_bf16_f32 v97, v82, v83
    v_exp_f32 v86, v86
    v_exp_f32 v87, v87
    v_mfma_f32_32x32x16_bf16 v[104:119], v[164:167], v[100:103], v[104:119]
    ds_read_b128 v[142:145], v30 offset:18480
    v_cvt_pk_bf16_f32 v98, v84, v85
    v_exp_f32 v88, v88
    v_exp_f32 v89, v89
    v_cvt_pk_bf16_f32 v99, v86, v87
    v_exp_f32 v90, v90
    v_exp_f32 v91, v91
    v_mfma_f32_32x32x16_bf16 v[120:135], v[160:163], v[96:99], v[120:135]
    ds_read_b64 v[146:147], v31 offset:19504
    ds_read_b32 v151, v4 offset:14356
    v_cvt_pk_bf16_f32 v100, v88, v89
    v_exp_f32 v92, v92
    v_exp_f32 v93, v93
    v_cvt_pk_bf16_f32 v101, v90, v91
    v_exp_f32 v94, v94
    v_exp_f32 v95, v95
    v_cvt_pk_bf16_f32 v102, v92, v93
    v_cvt_pk_bf16_f32 v103, v94, v95
    v_mfma_f32_32x32x16_bf16 v[80:95], v[136:139], v[22:25], 0
    v_exp_f32 v64, v64
    v_exp_f32 v65, v65
    v_exp_f32 v66, v66
    v_exp_f32 v67, v67
    v_cvt_pk_bf16_f32 v96, v64, v65
    v_mfma_f32_32x32x8_bf16 v[80:95], v[140:141], v[26:27], v[80:95]
    v_exp_f32 v68, v68
    v_exp_f32 v69, v69
    v_cvt_pk_bf16_f32 v97, v66, v67
    v_exp_f32 v70, v70
    v_exp_f32 v71, v71
    v_mfma_f32_32x32x16_bf16 v[120:135], v[164:167], v[100:103], v[120:135]
    v_cvt_pk_bf16_f32 v98, v68, v69
    v_exp_f32 v72, v72
    v_exp_f32 v73, v73
    v_cvt_pk_bf16_f32 v99, v70, v71
    v_exp_f32 v74, v74
    v_exp_f32 v75, v75
    s_waitcnt lgkmcnt(0)
    v_mfma_f32_32x32x16_bf16 v[104:119], v[152:155], v[96:99], v[104:119]
    v_cvt_pk_bf16_f32 v100, v72, v73
    v_exp_f32 v76, v76
    v_exp_f32 v77, v77
    v_cvt_pk_bf16_f32 v101, v74, v75
    v_exp_f32 v78, v78
    v_exp_f32 v79, v79
    v_cvt_pk_bf16_f32 v102, v76, v77
    v_cvt_pk_bf16_f32 v103, v78, v79
    v_cmp_gt_u32 vcc, s9, v151
    s_cbranch_vccnz Lkw_108
Lkwo_109:
    v_mfma_f32_32x32x16_bf16 v[64:79], v[142:145], v[16:19], 0
    ds_read_b128 v[160:163], v54 offset:19776
    v_exp_f32 v80, v80
    v_exp_f32 v81, v81
    v_exp_f32 v82, v82
    v_exp_f32 v83, v83
    v_cvt_pk_bf16_f32 v96, v80, v81
    v_mfma_f32_32x32x8_bf16 v[64:79], v[146:147], v[20:21], v[64:79]
    ds_read_b128 v[164:167], v54 offset:20448
    v_exp_f32 v84, v84
    v_exp_f32 v85, v85
    v_cvt_pk_bf16_f32 v97, v82, v83
    v_exp_f32 v86, v86
    v_exp_f32 v87, v87
    v_mfma_f32_32x32x16_bf16 v[104:119], v[156:159], v[100:103], v[104:119]
    ds_read_b128 v[136:139], v30 offset:21120
    v_cvt_pk_bf16_f32 v98, v84, v85
    v_exp_f32 v88, v88
    v_exp_f32 v89, v89
    v_cvt_pk_bf16_f32 v99, v86, v87
    v_exp_f32 v90, v90
    v_exp_f32 v91, v91
    v_mfma_f32_32x32x16_bf16 v[120:135], v[152:155], v[96:99], v[120:135]
    ds_read_b64 v[140:141], v31 offset:22144
    v_cvt_pk_bf16_f32 v100, v88, v89
    v_exp_f32 v92, v92
    v_exp_f32 v93, v93
    v_cvt_pk_bf16_f32 v101, v90, v91
    v_exp_f32 v94, v94
    v_exp_f32 v95, v95
    v_cvt_pk_bf16_f32 v102, v92, v93
    v_cvt_pk_bf16_f32 v103, v94, v95
    v_mfma_f32_32x32x16_bf16 v[80:95], v[142:145], v[22:25], 0
    v_exp_f32 v64, v64
    v_exp_f32 v65, v65
    v_exp_f32 v66, v66
    v_exp_f32 v67, v67
    v_cvt_pk_bf16_f32 v96, v64, v65
    v_mfma_f32_32x32x8_bf16 v[80:95], v[146:147], v[26:27], v[80:95]
    v_exp_f32 v68, v68
    v_exp_f32 v69, v69
    v_cvt_pk_bf16_f32 v97, v66, v67
    v_exp_f32 v70, v70
    v_exp_f32 v71, v71
    v_mfma_f32_32x32x16_bf16 v[120:135], v[156:159], v[100:103], v[120:135]
    v_cvt_pk_bf16_f32 v98, v68, v69
    v_exp_f32 v72, v72
    v_exp_f32 v73, v73
    v_cvt_pk_bf16_f32 v99, v70, v71
    v_exp_f32 v74, v74
    v_exp_f32 v75, v75
    s_waitcnt lgkmcnt(0)
    v_mfma_f32_32x32x16_bf16 v[104:119], v[160:163], v[96:99], v[104:119]
    ds_add_u32 v149, v150 offset:14348
    v_cvt_pk_bf16_f32 v100, v72, v73
    v_exp_f32 v76, v76
    v_exp_f32 v77, v77
    v_cvt_pk_bf16_f32 v101, v74, v75
    v_exp_f32 v78, v78
    v_exp_f32 v79, v79
    v_cvt_pk_bf16_f32 v102, v76, v77
    v_cvt_pk_bf16_f32 v103, v78, v79
    v_mfma_f32_32x32x16_bf16 v[64:79], v[136:139], v[16:19], 0
    ds_read_b128 v[152:155], v54 offset:22416
    v_exp_f32 v80, v80
    v_exp_f32 v81, v81
    v_exp_f32 v82, v82
    v_exp_f32 v83, v83
    v_cvt_pk_bf16_f32 v96, v80, v81
    v_mfma_f32_32x32x8_bf16 v[64:79], v[140:141], v[20:21], v[64:79]
    ds_read_b128 v[156:159], v54 offset:23088
    v_exp_f32 v84, v84
    v_exp_f32 v85, v85
    v_cvt_pk_bf16_f32 v97, v82, v83
    v_exp_f32 v86, v86
    v_exp_f32 v87, v87
    v_mfma_f32_32x32x16_bf16 v[104:119], v[164:167], v[100:103], v[104:119]
    ds_read_b128 v[142:145], v30 offset:23760
    s_cmp_eq_u32 s9, 16
    v_cvt_pk_bf16_f32 v98, v84, v85
    v_exp_f32 v88, v88
    v_exp_f32 v89, v89
    v_cvt_pk_bf16_f32 v99, v86, v87
    v_exp_f32 v90, v90
    v_exp_f32 v91, v91
    v_mfma_f32_32x32x16_bf16 v[120:135], v[160:163], v[96:99], v[120:135]
    ds_read_b64 v[146:147], v31 offset:24784
    v_cvt_pk_bf16_f32 v100, v88, v89
    v_exp_f32 v92, v92
    v_exp_f32 v93, v93
    v_cvt_pk_bf16_f32 v101, v90, v91
    v_exp_f32 v94, v94
    v_exp_f32 v95, v95
    v_cvt_pk_bf16_f32 v102, v92, v93
    v_cvt_pk_bf16_f32 v103, v94, v95
    s_cbranch_scc1 L_attn_last
    v_mfma_f32_32x32x16_bf16 v[80:95], v[136:139], v[22:25], 0
    v_exp_f32 v64, v64
    v_exp_f32 v65, v65
    v_exp_f32 v66, v66
    v_exp_f32 v67, v67
    v_cvt_pk_bf16_f32 v96, v64, v65
    v_mfma_f32_32x32x8_bf16 v[80:95], v[140:141], v[26:27], v[80:95]
    v_exp_f32 v68, v68
    v_exp_f32 v69, v69
    v_cvt_pk_bf16_f32 v97, v66, v67
    v_exp_f32 v70, v70
    v_exp_f32 v71, v71
    v_mfma_f32_32x32x16_bf16 v[120:135], v[164:167], v[100:103], v[120:135]
    v_cvt_pk_bf16_f32 v98, v68, v69
    v_exp_f32 v72, v72
    v_exp_f32 v73, v73
    v_cvt_pk_bf16_f32 v99, v70, v71
    v_exp_f32 v74, v74
    v_exp_f32 v75, v75
    s_waitcnt lgkmcnt(0)
    v_mfma_f32_32x32x16_bf16 v[104:119], v[152:155], v[96:99], v[104:119]
    v_cvt_pk_bf16_f32 v100, v72, v73
    v_exp_f32 v76, v76
    v_exp_f32 v77, v77
    v_cvt_pk_bf16_f32 v101, v74, v75
    v_exp_f32 v78, v78
    v_exp_f32 v79, v79
    v_cvt_pk_bf16_f32 v102, v76, v77
    v_cvt_pk_bf16_f32 v103, v78, v79
    v_mfma_f32_32x32x16_bf16 v[64:79], v[142:145], v[16:19], 0
    ds_read_b128 v[160:163], v54 offset:25056
    v_exp_f32 v80, v80
    v_exp_f32 v81, v81
    v_exp_f32 v82, v82
    v_exp_f32 v83, v83
    v_cvt_pk_bf16_f32 v96, v80, v81
    v_mfma_f32_32x32x8_bf16 v[64:79], v[146:147], v[20:21], v[64:79]
    ds_read_b128 v[164:167], v54 offset:25728
    v_exp_f32 v84, v84
    v_exp_f32 v85, v85
    v_cvt_pk_bf16_f32 v97, v82, v83
    v_exp_f32 v86, v86
    v_exp_f32 v87, v87
    v_mfma_f32_32x32x16_bf16 v[104:119], v[156:159], v[100:103], v[104:119]
    ds_read_b128 v[136:139], v30 offset:26400
    v_cvt_pk_bf16_f32 v98, v84, v85
    v_exp_f32 v88, v88
    v_exp_f32 v89, v89
    v_cvt_pk_bf16_f32 v99, v86, v87
    v_exp_f32 v90, v90
    v_exp_f32 v91, v91
    v_mfma_f32_32x32x16_bf16 v[120:135], v[152:155], v[96:99], v[120:135]
    ds_read_b64 v[140:141], v31 offset:27424
    v_cvt_pk_bf16_f32 v100, v88, v89
    v_exp_f32 v92, v92
    v_exp_f32 v93, v93
    v_cvt_pk_bf16_f32 v101, v90, v91
    v_exp_f32 v94, v94
    v_exp_f32 v95, v95
    v_cvt_pk_bf16_f32 v102, v92, v93
    v_cvt_pk_bf16_f32 v103, v94, v95
    v_mfma_f32_32x32x16_bf16 v[80:95], v[142:145], v[22:25], 0
    v_exp_f32 v64, v64
    v_exp_f32 v65, v65
    v_exp_f32 v66, v66
    v_exp_f32 v67, v67
    v_cvt_pk_bf16_f32 v96, v64, v65
    v_mfma_f32_32x32x8_bf16 v[80:95], v[146:147], v[26:27], v[80:95]
    v_exp_f32 v68, v68
    v_exp_f32 v69, v69
    v_cvt_pk_bf16_f32 v97, v66, v67
    v_exp_f32 v70, v70
    v_exp_f32 v71, v71
    v_mfma_f32_32x32x16_bf16 v[120:135], v[156:159], v[100:103], v[120:135]
    v_cvt_pk_bf16_f32 v98, v68, v69
    v_exp_f32 v72, v72
    v_exp_f32 v73, v73
    v_cvt_pk_bf16_f32 v99, v70, v71
    v_exp_f32 v74, v74
    v_exp_f32 v75, v75
    s_waitcnt lgkmcnt(0)
    v_mfma_f32_32x32x16_bf16 v[104:119], v[160:163], v[96:99], v[104:119]
    v_cvt_pk_bf16_f32 v100, v72, v73
    v_exp_f32 v76, v76
    v_exp_f32 v77, v77
    v_cvt_pk_bf16_f32 v101, v74, v75
    v_exp_f32 v78, v78
    v_exp_f32 v79, v79
    v_cvt_pk_bf16_f32 v102, v76, v77
    v_cvt_pk_bf16_f32 v103, v78, v79
    v_mfma_f32_32x32x16_bf16 v[64:79], v[136:139], v[16:19], 0
    ds_read_b128 v[152:155], v54 offset:27696
    v_exp_f32 v80, v80
    v_exp_f32 v81, v81
    v_exp_f32 v82, v82
    v_exp_f32 v83, v83
    v_cvt_pk_bf16_f32 v96, v80, v81
    v_mfma_f32_32x32x8_bf16 v[64:79], v[140:141], v[20:21], v[64:79]
    ds_read_b128 v[156:159], v54 offset:28368
    v_exp_f32 v84, v84
    v_exp_f32 v85, v85
    v_cvt_pk_bf16_f32 v97, v82, v83
    v_exp_f32 v86, v86
    v_exp_f32 v87, v87
    v_mfma_f32_32x32x16_bf16 v[104:119], v[164:167], v[100:103], v[104:119]
    ds_read_b128 v[142:145], v30 offset:29040
    v_cvt_pk_bf16_f32 v98, v84, v85
    v_exp_f32 v88, v88
    v_exp_f32 v89, v89
    v_cvt_pk_bf16_f32 v99, v86, v87
    v_exp_f32 v90, v90
    v_exp_f32 v91, v91
    v_mfma_f32_32x32x16_bf16 v[120:135], v[160:163], v[96:99], v[120:135]
    ds_read_b64 v[146:147], v31 offset:30064
    v_cvt_pk_bf16_f32 v100, v88, v89
    v_exp_f32 v92, v92
    v_exp_f32 v93, v93
    v_cvt_pk_bf16_f32 v101, v90, v91
    v_exp_f32 v94, v94
    v_exp_f32 v95, v95
    v_cvt_pk_bf16_f32 v102, v92, v93
    v_cvt_pk_bf16_f32 v103, v94, v95
    v_mfma_f32_32x32x16_bf16 v[80:95], v[136:139], v[22:25], 0
    v_exp_f32 v64, v64
    v_exp_f32 v65, v65
    v_exp_f32 v66, v66
    v_exp_f32 v67, v67
    v_cvt_pk_bf16_f32 v96, v64, v65
    v_mfma_f32_32x32x8_bf16 v[80:95], v[140:141], v[26:27], v[80:95]
    v_exp_f32 v68, v68
    v_exp_f32 v69, v69
    v_cvt_pk_bf16_f32 v97, v66, v67
    v_exp_f32 v70, v70
    v_exp_f32 v71, v71
    v_mfma_f32_32x32x16_bf16 v[120:135], v[164:167], v[100:103], v[120:135]
    v_cvt_pk_bf16_f32 v98, v68, v69
    v_exp_f32 v72, v72
    v_exp_f32 v73, v73
    v_cvt_pk_bf16_f32 v99, v70, v71
    v_exp_f32 v74, v74
    v_exp_f32 v75, v75
    s_waitcnt lgkmcnt(0)
    v_mfma_f32_32x32x16_bf16 v[104:119], v[152:155], v[96:99], v[104:119]
    v_cvt_pk_bf16_f32 v100, v72, v73
    v_exp_f32 v76, v76
    v_exp_f32 v77, v77
    v_cvt_pk_bf16_f32 v101, v74, v75
    v_exp_f32 v78, v78
    v_exp_f32 v79, v79
    v_cvt_pk_bf16_f32 v102, v76, v77
    v_cvt_pk_bf16_f32 v103, v78, v79
    v_mfma_f32_32x32x16_bf16 v[64:79], v[142:145], v[16:19], 0
    ds_read_b128 v[160:163], v54 offset:30336
    v_exp_f32 v80, v80
    v_exp_f32 v81, v81
    v_exp_f32 v82, v82
    v_exp_f32 v83, v83
    v_cvt_pk_bf16_f32 v96, v80, v81
    v_mfma_f32_32x32x8_bf16 v[64:79], v[146:147], v[20:21], v[64:79]
    ds_read_b128 v[164:167], v54 offset:31008
    v_exp_f32 v84, v84
    v_exp_f32 v85, v85
    v_cvt_pk_bf16_f32 v97, v82, v83
    v_exp_f32 v86, v86
    v_exp_f32 v87, v87
    v_mfma_f32_32x32x16_bf16 v[104:119], v[156:159], v[100:103], v[104:119]
    ds_read_b128 v[136:139], v30 offset:31680
    v_cvt_pk_bf16_f32 v98, v84, v85
    v_exp_f32 v88, v88
    v_exp_f32 v89, v89
    v_cvt_pk_bf16_f32 v99, v86, v87
    v_exp_f32 v90, v90
    v_exp_f32 v91, v91
    v_mfma_f32_32x32x16_bf16 v[120:135], v[152:155], v[96:99], v[120:135]
    ds_read_b64 v[140:141], v31 offset:32704
    v_cvt_pk_bf16_f32 v100, v88, v89
    v_exp_f32 v92, v92
    v_exp_f32 v93, v93
    v_cvt_pk_bf16_f32 v101, v90, v91
    v_exp_f32 v94, v94
    v_exp_f32 v95, v95
    v_cvt_pk_bf16_f32 v102, v92, v93
    v_cvt_pk_bf16_f32 v103, v94, v95
    v_mfma_f32_32x32x16_bf16 v[80:95], v[142:145], v[22:25], 0
    v_exp_f32 v64, v64
    v_exp_f32 v65, v65
    v_exp_f32 v66, v66
    v_exp_f32 v67, v67
    v_cvt_pk_bf16_f32 v96, v64, v65
    v_mfma_f32_32x32x8_bf16 v[80:95], v[146:147], v[26:27], v[80:95]
    v_exp_f32 v68, v68
    v_exp_f32 v69, v69
    v_cvt_pk_bf16_f32 v97, v66, v67
    v_exp_f32 v70, v70
    v_exp_f32 v71, v71
    v_mfma_f32_32x32x16_bf16 v[120:135], v[156:159], v[100:103], v[120:135]
    v_cvt_pk_bf16_f32 v98, v68, v69
    v_exp_f32 v72, v72
    v_exp_f32 v73, v73
    v_cvt_pk_bf16_f32 v99, v70, v71
    v_exp_f32 v74, v74
    v_exp_f32 v75, v75
    s_waitcnt lgkmcnt(0)
    v_mfma_f32_32x32x16_bf16 v[104:119], v[160:163], v[96:99], v[104:119]
    v_cvt_pk_bf16_f32 v100, v72, v73
    v_exp_f32 v76, v76
    v_exp_f32 v77, v77
    v_cvt_pk_bf16_f32 v101, v74, v75
    v_exp_f32 v78, v78
    v_exp_f32 v79, v79
    v_cvt_pk_bf16_f32 v102, v76, v77
    v_cvt_pk_bf16_f32 v103, v78, v79
    v_mfma_f32_32x32x16_bf16 v[64:79], v[136:139], v[16:19], 0
    ds_read_b128 v[152:155], v54 offset:32976
    v_exp_f32 v80, v80
    v_exp_f32 v81, v81
    v_exp_f32 v82, v82
    v_exp_f32 v83, v83
    v_cvt_pk_bf16_f32 v96, v80, v81
    v_mfma_f32_32x32x8_bf16 v[64:79], v[140:141], v[20:21], v[64:79]
    ds_read_b128 v[156:159], v54 offset:33648
    v_exp_f32 v84, v84
    v_exp_f32 v85, v85
    v_cvt_pk_bf16_f32 v97, v82, v83
    v_exp_f32 v86, v86
    v_exp_f32 v87, v87
    v_mfma_f32_32x32x16_bf16 v[104:119], v[164:167], v[100:103], v[104:119]
    ds_read_b128 v[142:145], v30 offset:34320
    v_cvt_pk_bf16_f32 v98, v84, v85
    v_exp_f32 v88, v88
    v_exp_f32 v89, v89
    v_cvt_pk_bf16_f32 v99, v86, v87
    v_exp_f32 v90, v90
    v_exp_f32 v91, v91
    v_mfma_f32_32x32x16_bf16 v[120:135], v[160:163], v[96:99], v[120:135]
    ds_read_b64 v[146:147], v31 offset:35344
    v_cvt_pk_bf16_f32 v100, v88, v89
    v_exp_f32 v92, v92
    v_exp_f32 v93, v93
    v_cvt_pk_bf16_f32 v101, v90, v91
    v_exp_f32 v94, v94
    v_exp_f32 v95, v95
    v_cvt_pk_bf16_f32 v102, v92, v93
    v_cvt_pk_bf16_f32 v103, v94, v95
    v_mfma_f32_32x32x16_bf16 v[80:95], v[136:139], v[22:25], 0
    v_exp_f32 v64, v64
    v_exp_f32 v65, v65
    v_exp_f32 v66, v66
    v_exp_f32 v67, v67
    v_cvt_pk_bf16_f32 v96, v64, v65
    v_mfma_f32_32x32x8_bf16 v[80:95], v[140:141], v[26:27], v[80:95]
    v_exp_f32 v68, v68
    v_exp_f32 v69, v69
    v_cvt_pk_bf16_f32 v97, v66, v67
    v_exp_f32 v70, v70
    v_exp_f32 v71, v71
    v_mfma_f32_32x32x16_bf16 v[120:135], v[164:167], v[100:103], v[120:135]
    v_cvt_pk_bf16_f32 v98, v68, v69
    v_exp_f32 v72, v72
    v_exp_f32 v73, v73
    v_cvt_pk_bf16_f32 v99, v70, v71
    v_exp_f32 v74, v74
    v_exp_f32 v75, v75
    s_waitcnt lgkmcnt(0)
    v_mfma_f32_32x32x16_bf16 v[104:119], v[152:155], v[96:99], v[104:119]
    v_cvt_pk_bf16_f32 v100, v72, v73
    v_exp_f32 v76, v76
    v_exp_f32 v77, v77
    v_cvt_pk_bf16_f32 v101, v74, v75
    v_exp_f32 v78, v78
    v_exp_f32 v79, v79
    v_cvt_pk_bf16_f32 v102, v76, v77
    v_cvt_pk_bf16_f32 v103, v78, v79
    v_mfma_f32_32x32x16_bf16 v[64:79], v[142:145], v[16:19], 0
    ds_read_b128 v[160:163], v54 offset:35616
    v_exp_f32 v80, v80
    v_exp_f32 v81, v81
    v_exp_f32 v82, v82
    v_exp_f32 v83, v83
    v_cvt_pk_bf16_f32 v96, v80, v81
    v_mfma_f32_32x32x8_bf16 v[64:79], v[146:147], v[20:21], v[64:79]
    ds_read_b128 v[164:167], v54 offset:36288
    v_exp_f32 v84, v84
    v_exp_f32 v85, v85
    v_cvt_pk_bf16_f32 v97, v82, v83
    v_exp_f32 v86, v86
    v_exp_f32 v87, v87
    v_mfma_f32_32x32x16_bf16 v[104:119], v[156:159], v[100:103], v[104:119]
    ds_read_b128 v[136:139], v30 offset:36960
    v_cvt_pk_bf16_f32 v98, v84, v85
    v_exp_f32 v88, v88
    v_exp_f32 v89, v89
    v_cvt_pk_bf16_f32 v99, v86, v87
    v_exp_f32 v90, v90
    v_exp_f32 v91, v91
    v_mfma_f32_32x32x16_bf16 v[120:135], v[152:155], v[96:99], v[120:135]
    ds_read_b64 v[140:141], v31 offset:37984
    v_cvt_pk_bf16_f32 v100, v88, v89
    v_exp_f32 v92, v92
    v_exp_f32 v93, v93
    v_cvt_pk_bf16_f32 v101, v90, v91
    v_exp_f32 v94, v94
    v_exp_f32 v95, v95
    v_cvt_pk_bf16_f32 v102, v92, v93
    v_cvt_pk_bf16_f32 v103, v94, v95
    v_mfma_f32_32x32x16_bf16 v[80:95], v[142:145], v[22:25], 0
    v_exp_f32 v64, v64
    v_exp_f32 v65, v65
    v_exp_f32 v66, v66
    v_exp_f32 v67, v67
    v_cvt_pk_bf16_f32 v96, v64, v65
    v_mfma_f32_32x32x8_bf16 v[80:95], v[146:147], v[26:27], v[80:95]
    v_exp_f32 v68, v68
    v_exp_f32 v69, v69
    v_cvt_pk_bf16_f32 v97, v66, v67
    v_exp_f32 v70, v70
    v_exp_f32 v71, v71
    v_mfma_f32_32x32x16_bf16 v[120:135], v[156:159], v[100:103], v[120:135]
    v_cvt_pk_bf16_f32 v98, v68, v69
    v_exp_f32 v72, v72
    v_exp_f32 v73, v73
    v_cvt_pk_bf16_f32 v99, v70, v71
    v_exp_f32 v74, v74
    v_exp_f32 v75, v75
    s_waitcnt lgkmcnt(0)
    v_mfma_f32_32x32x16_bf16 v[104:119], v[160:163], v[96:99], v[104:119]
    v_cvt_pk_bf16_f32 v100, v72, v73
    v_exp_f32 v76, v76
    v_exp_f32 v77, v77
    v_cvt_pk_bf16_f32 v101, v74, v75
    v_exp_f32 v78, v78
    v_exp_f32 v79, v79
    v_cvt_pk_bf16_f32 v102, v76, v77
    v_cvt_pk_bf16_f32 v103, v78, v79
    v_mfma_f32_32x32x16_bf16 v[64:79], v[136:139], v[16:19], 0
    ds_read_b128 v[152:155], v54 offset:38256
    v_exp_f32 v80, v80
    v_exp_f32 v81, v81
    v_exp_f32 v82, v82
    v_exp_f32 v83, v83
    v_cvt_pk_bf16_f32 v96, v80, v81
    v_mfma_f32_32x32x8_bf16 v[64:79], v[140:141], v[20:21], v[64:79]
    ds_read_b128 v[156:159], v54 offset:38928
    v_exp_f32 v84, v84
    v_exp_f32 v85, v85
    v_cvt_pk_bf16_f32 v97, v82, v83
    v_exp_f32 v86, v86
    v_exp_f32 v87, v87
    v_mfma_f32_32x32x16_bf16 v[104:119], v[164:167], v[100:103], v[104:119]
    ds_read_b128 v[142:145], v30 offset:39600
    v_cvt_pk_bf16_f32 v98, v84, v85
    v_exp_f32 v88, v88
    v_exp_f32 v89, v89
    v_cvt_pk_bf16_f32 v99, v86, v87
    v_exp_f32 v90, v90
    v_exp_f32 v91, v91
    v_mfma_f32_32x32x16_bf16 v[120:135], v[160:163], v[96:99], v[120:135]
    ds_read_b64 v[146:147], v31 offset:40624
    ds_read_b32 v151, v4 offset:14352
    v_cvt_pk_bf16_f32 v100, v88, v89
    v_exp_f32 v92, v92
    v_exp_f32 v93, v93
    v_cvt_pk_bf16_f32 v101, v90, v91
    v_exp_f32 v94, v94
    v_exp_f32 v95, v95
    v_cvt_pk_bf16_f32 v102, v92, v93
    v_cvt_pk_bf16_f32 v103, v94, v95
    v_mfma_f32_32x32x16_bf16 v[80:95], v[136:139], v[22:25], 0
    v_exp_f32 v64, v64
    v_exp_f32 v65, v65
    v_exp_f32 v66, v66
    v_exp_f32 v67, v67
    v_cvt_pk_bf16_f32 v96, v64, v65
    v_mfma_f32_32x32x8_bf16 v[80:95], v[140:141], v[26:27], v[80:95]
    v_exp_f32 v68, v68
    v_exp_f32 v69, v69
    v_cvt_pk_bf16_f32 v97, v66, v67
    v_exp_f32 v70, v70
    v_exp_f32 v71, v71
    v_mfma_f32_32x32x16_bf16 v[120:135], v[164:167], v[100:103], v[120:135]
    v_cvt_pk_bf16_f32 v98, v68, v69
    v_exp_f32 v72, v72
    v_exp_f32 v73, v73
    v_cvt_pk_bf16_f32 v99, v70, v71
    v_exp_f32 v74, v74
    v_exp_f32 v75, v75
    s_waitcnt lgkmcnt(0)
    v_mfma_f32_32x32x16_bf16 v[104:119], v[152:155], v[96:99], v[104:119]
    v_cvt_pk_bf16_f32 v100, v72, v73
    v_exp_f32 v76, v76
    v_exp_f32 v77, v77
    v_cvt_pk_bf16_f32 v101, v74, v75
    v_exp_f32 v78, v78
    v_exp_f32 v79, v79
    v_cvt_pk_bf16_f32 v102, v76, v77
    v_cvt_pk_bf16_f32 v103, v78, v79
    v_cmp_gt_u32 vcc, s9, v151
    s_cbranch_vccnz Lkw_110
Lkwo_111:
    v_mfma_f32_32x32x16_bf16 v[64:79], v[142:145], v[16:19], 0
    ds_read_b128 v[160:163], v54 offset:40896
    v_exp_f32 v80, v80
    v_exp_f32 v81, v81
    v_exp_f32 v82, v82
    v_exp_f32 v83, v83
    v_cvt_pk_bf16_f32 v96, v80, v81
    v_mfma_f32_32x32x8_bf16 v[64:79], v[146:147], v[20:21], v[64:79]
    ds_read_b128 v[164:167], v54 offset:41568
    v_exp_f32 v84, v84
    v_exp_f32 v85, v85
    v_cvt_pk_bf16_f32 v97, v82, v83
    v_exp_f32 v86, v86
    v_exp_f32 v87, v87
    v_mfma_f32_32x32x16_bf16 v[104:119], v[156:159], v[100:103], v[104:119]
    ds_read_b128 v[136:139], v30 offset:0
    v_cvt_pk_bf16_f32 v98, v84, v85
    v_exp_f32 v88, v88
    v_exp_f32 v89, v89
    v_cvt_pk_bf16_f32 v99, v86, v87
    v_exp_f32 v90, v90
    v_exp_f32 v91, v91
    v_mfma_f32_32x32x16_bf16 v[120:135], v[152:155], v[96:99], v[120:135]
    ds_read_b64 v[140:141], v31 offset:1024
    v_cvt_pk_bf16_f32 v100, v88, v89
    v_exp_f32 v92, v92
    v_exp_f32 v93, v93
    v_cvt_pk_bf16_f32 v101, v90, v91
    v_exp_f32 v94, v94
    v_exp_f32 v95, v95
    v_cvt_pk_bf16_f32 v102, v92, v93
    v_cvt_pk_bf16_f32 v103, v94, v95
    v_mfma_f32_32x32x16_bf16 v[80:95], v[142:145], v[22:25], 0
    v_exp_f32 v64, v64
    v_exp_f32 v65, v65
    v_exp_f32 v66, v66
    v_exp_f32 v67, v67
    v_cvt_pk_bf16_f32 v96, v64, v65
    v_mfma_f32_32x32x8_bf16 v[80:95], v[146:147], v[26:27], v[80:95]
    v_exp_f32 v68, v68
    v_exp_f32 v69, v69
    v_cvt_pk_bf16_f32 v97, v66, v67
    v_exp_f32 v70, v70
    v_exp_f32 v71, v71
    v_mfma_f32_32x32x16_bf16 v[120:135], v[156:159], v[100:103], v[120:135]
    v_cvt_pk_bf16_f32 v98, v68, v69
    v_exp_f32 v72, v72
    v_exp_f32 v73, v73
    v_cvt_pk_bf16_f32 v99, v70, v71
    v_exp_f32 v74, v74
    v_exp_f32 v75, v75
    s_waitcnt lgkmcnt(0)
    v_mfma_f32_32x32x16_bf16 v[104:119], v[160:163], v[96:99], v[104:119]
    ds_add_u32 v149, v150 offset:14348
    v_cvt_pk_bf16_f32 v100, v72, v73
    v_exp_f32 v76, v76
    v_exp_f32 v77, v77
    v_cvt_pk_bf16_f32 v101, v74, v75
    v_exp_f32 v78, v78
    v_exp_f32 v79, v79
    v_cvt_pk_bf16_f32 v102, v76, v77
    v_cvt_pk_bf16_f32 v103, v78, v79
    v_mfma_f32_32x32x16_bf16 v[64:79], v[136:139], v[16:19], 0
    ds_read_b128 v[152:155], v54 offset:1296
    v_exp_f32 v80, v80
    v_exp_f32 v81, v81
    v_exp_f32 v82, v82
    v_exp_f32 v83, v83
    v_cvt_pk_bf16_f32 v96, v80, v81
    v_mfma_f32_32x32x8_bf16 v[64:79], v[140:141], v[20:21], v[64:79]
    ds_read_b128 v[156:159], v54 offset:1968
    v_exp_f32 v84, v84
    v_exp_f32 v85, v85
    v_cvt_pk_bf16_f32 v97, v82, v83
    v_exp_f32 v86, v86
    v_exp_f32 v87, v87
    v_mfma_f32_32x32x16_bf16 v[104:119], v[164:167], v[100:103], v[104:119]
    ds_read_b128 v[142:145], v30 offset:2640
    s_add_u32 s9, s9, 4
    v_cvt_pk_bf16_f32 v98, v84, v85
    v_exp_f32 v88, v88
    v_exp_f32 v89, v89
    v_cvt_pk_bf16_f32 v99, v86, v87
    v_exp_f32 v90, v90
    v_exp_f32 v91, v91
    v_mfma_f32_32x32x16_bf16 v[120:135], v[160:163], v[96:99], v[120:135]
    ds_read_b64 v[146:147], v31 offset:3664
    v_cvt_pk_bf16_f32 v100, v88, v89
    v_exp_f32 v92, v92
    v_exp_f32 v93, v93
    v_cvt_pk_bf16_f32 v101, v90, v91
    v_exp_f32 v94, v94
    v_exp_f32 v95, v95
    v_cvt_pk_bf16_f32 v102, v92, v93
    v_cvt_pk_bf16_f32 v103, v94, v95
    s_branch L_attn
L_attn_last:
    v_mfma_f32_32x32x16_bf16 v[80:95], v[136:139], v[22:25], 0
    v_exp_f32 v64, v64
    v_exp_f32 v65, v65
    v_exp_f32 v66, v66
    v_exp_f32 v67, v67
    v_cvt_pk_bf16_f32 v96, v64, v65
    v_mfma_f32_32x32x8_bf16 v[80:95], v[140:141], v[26:27], v[80:95]
    v_exp_f32 v68, v68
    v_exp_f32 v69, v69
    v_cvt_pk_bf16_f32 v97, v66, v67
    v_exp_f32 v70, v70
    v_exp_f32 v71, v71
    v_mfma_f32_32x32x16_bf16 v[120:135], v[164:167], v[100:103], v[120:135]
    v_cvt_pk_bf16_f32 v98, v68, v69
    v_exp_f32 v72, v72
    v_exp_f32 v73, v73
    v_cvt_pk_bf16_f32 v99, v70, v71
    v_exp_f32 v74, v74
    v_exp_f32 v75, v75
    s_waitcnt lgkmcnt(0)
    v_mfma_f32_32x32x16_bf16 v[104:119], v[152:155], v[96:99], v[104:119]
    v_cvt_pk_bf16_f32 v100, v72, v73
    v_exp_f32 v76, v76
    v_exp_f32 v77, v77
    v_cvt_pk_bf16_f32 v101, v74, v75
    v_exp_f32 v78, v78
    v_exp_f32 v79, v79
    v_cvt_pk_bf16_f32 v102, v76, v77
    v_cvt_pk_bf16_f32 v103, v78, v79
    v_mfma_f32_32x32x16_bf16 v[64:79], v[142:145], v[16:19], 0
    ds_read_b128 v[160:163], v54 offset:25056
    v_exp_f32 v80, v80
    v_exp_f32 v81, v81
    v_exp_f32 v82, v82
    v_exp_f32 v83, v83
    v_cvt_pk_bf16_f32 v96, v80, v81
    v_mfma_f32_32x32x8_bf16 v[64:79], v[146:147], v[20:21], v[64:79]
    ds_read_b128 v[164:167], v54 offset:25728
    v_exp_f32 v84, v84
    v_exp_f32 v85, v85
    v_cvt_pk_bf16_f32 v97, v82, v83
    v_exp_f32 v86, v86
    v_exp_f32 v87, v87
    v_mfma_f32_32x32x16_bf16 v[104:119], v[156:159], v[100:103], v[104:119]
    ds_read_b128 v[136:139], v30 offset:26400
    v_cvt_pk_bf16_f32 v98, v84, v85
    v_exp_f32 v88, v88
    v_exp_f32 v89, v89
    v_cvt_pk_bf16_f32 v99, v86, v87
    v_exp_f32 v90, v90
    v_exp_f32 v91, v91
    v_mfma_f32_32x32x16_bf16 v[120:135], v[152:155], v[96:99], v[120:135]
    ds_read_b64 v[140:141], v31 offset:27424
    ds_read_b32 v151, v4 offset:14344
    v_cvt_pk_bf16_f32 v100, v88, v89
    v_exp_f32 v92, v92
    v_exp_f32 v93, v93
    v_cvt_pk_bf16_f32 v101, v90, v91
    v_exp_f32 v94, v94
    v_exp_f32 v95, v95
    v_cvt_pk_bf16_f32 v102, v92, v93
    v_cvt_pk_bf16_f32 v103, v94, v95
    v_mfma_f32_32x32x16_bf16 v[80:95], v[142:145], v[22:25], 0
    v_exp_f32 v64, v64
    v_exp_f32 v65, v65
    v_exp_f32 v66, v66
    v_exp_f32 v67, v67
    v_cvt_pk_bf16_f32 v96, v64, v65
    v_mfma_f32_32x32x8_bf16 v[80:95], v[146:147], v[26:27], v[80:95]
    v_exp_f32 v68, v68
    v_exp_f32 v69, v69
    v_cvt_pk_bf16_f32 v97, v66, v67
    v_exp_f32 v70, v70
    v_exp_f32 v71, v71
    v_mfma_f32_32x32x16_bf16 v[120:135], v[156:159], v[100:103], v[120:135]
    v_cvt_pk_bf16_f32 v98, v68, v69
    v_exp_f32 v72, v72
    v_exp_f32 v73, v73
    v_cvt_pk_bf16_f32 v99, v70, v71
    v_exp_f32 v74, v74
    v_exp_f32 v75, v75
    s_waitcnt lgkmcnt(0)
    v_mfma_f32_32x32x16_bf16 v[104:119], v[160:163], v[96:99], v[104:119]
    v_cvt_pk_bf16_f32 v100, v72, v73
    v_exp_f32 v76, v76
    v_exp_f32 v77, v77
    v_cvt_pk_bf16_f32 v101, v74, v75
    v_exp_f32 v78, v78
    v_exp_f32 v79, v79
    v_cvt_pk_bf16_f32 v102, v76, v77
    v_cvt_pk_bf16_f32 v103, v78, v79
    v_mfma_f32_32x32x16_bf16 v[64:79], v[136:139], v[16:19], 0
    ds_read_b128 v[152:155], v54 offset:27696
    v_exp_f32 v80, v80
    v_exp_f32 v81, v81
    v_exp_f32 v82, v82
    v_exp_f32 v83, v83
    v_cvt_pk_bf16_f32 v96, v80, v81
    v_mfma_f32_32x32x8_bf16 v[64:79], v[140:141], v[20:21], v[64:79]
    ds_read_b128 v[156:159], v54 offset:28368
    v_exp_f32 v84, v84
    v_exp_f32 v85, v85
    v_cvt_pk_bf16_f32 v97, v82, v83
    v_exp_f32 v86, v86
    v_exp_f32 v87, v87
    v_mfma_f32_32x32x16_bf16 v[104:119], v[164:167], v[100:103], v[104:119]
    ds_read_b128 v[142:145], v30 offset:29040
    v_cvt_pk_bf16_f32 v98, v84, v85
    v_exp_f32 v88, v88
    v_exp_f32 v89, v89
    v_cvt_pk_bf16_f32 v99, v86, v87
    v_exp_f32 v90, v90
    v_exp_f32 v91, v91
    v_mfma_f32_32x32x16_bf16 v[120:135], v[160:163], v[96:99], v[120:135]
    ds_read_b64 v[146:147], v31 offset:30064
    v_cvt_pk_bf16_f32 v100, v88, v89
    v_exp_f32 v92, v92
    v_exp_f32 v93, v93
    v_cvt_pk_bf16_f32 v101, v90, v91
    v_exp_f32 v94, v94
    v_exp_f32 v95, v95
    v_cvt_pk_bf16_f32 v102, v92, v93
    v_cvt_pk_bf16_f32 v103, v94, v95
    v_mfma_f32_32x32x16_bf16 v[80:95], v[136:139], v[22:25], 0
    v_exp_f32 v64, v64
    v_exp_f32 v65, v65
    v_exp_f32 v66, v66
    v_exp_f32 v67, v67
    v_cvt_pk_bf16_f32 v96, v64, v65
    v_mfma_f32_32x32x8_bf16 v[80:95], v[140:141], v[26:27], v[80:95]
    v_exp_f32 v68, v68
    v_exp_f32 v69, v69
    v_cvt_pk_bf16_f32 v97, v66, v67
    v_exp_f32 v70, v70
    v_exp_f32 v71, v71
    v_mfma_f32_32x32x16_bf16 v[120:135], v[164:167], v[100:103], v[120:135]
    v_cvt_pk_bf16_f32 v98, v68, v69
    v_exp_f32 v72, v72
    v_exp_f32 v73, v73
    v_cvt_pk_bf16_f32 v99, v70, v71
    v_exp_f32 v74, v74
    v_exp_f32 v75, v75
    s_waitcnt lgkmcnt(0)
    v_mfma_f32_32x32x16_bf16 v[104:119], v[152:155], v[96:99], v[104:119]
    v_cvt_pk_bf16_f32 v100, v72, v73
    v_exp_f32 v76, v76
    v_exp_f32 v77, v77
    v_cvt_pk_bf16_f32 v101, v74, v75
    v_exp_f32 v78, v78
    v_exp_f32 v79, v79
    v_cvt_pk_bf16_f32 v102, v76, v77
    v_cvt_pk_bf16_f32 v103, v78, v79
    v_mfma_f32_32x32x16_bf16 v[64:79], v[142:145], v[16:19], 0
    ds_read_b128 v[160:163], v54 offset:30336
    v_exp_f32 v80, v80
    v_exp_f32 v81, v81
    v_exp_f32 v82, v82
    v_exp_f32 v83, v83
    v_cvt_pk_bf16_f32 v96, v80, v81
    v_mfma_f32_32x32x8_bf16 v[64:79], v[146:147], v[20:21], v[64:79]
    ds_read_b128 v[164:167], v54 offset:31008
    v_exp_f32 v84, v84
    v_exp_f32 v85, v85
    v_cvt_pk_bf16_f32 v97, v82, v83
    v_exp_f32 v86, v86
    v_exp_f32 v87, v87
    v_mfma_f32_32x32x16_bf16 v[104:119], v[156:159], v[100:103], v[104:119]
    ds_read_b128 v[136:139], v30 offset:31680
    v_cvt_pk_bf16_f32 v98, v84, v85
    v_exp_f32 v88, v88
    v_exp_f32 v89, v89
    v_cvt_pk_bf16_f32 v99, v86, v87
    v_exp_f32 v90, v90
    v_exp_f32 v91, v91
    v_mfma_f32_32x32x16_bf16 v[120:135], v[152:155], v[96:99], v[120:135]
    ds_read_b64 v[140:141], v31 offset:32704
    v_cvt_pk_bf16_f32 v100, v88, v89
    v_exp_f32 v92, v92
    v_exp_f32 v93, v93
    v_cvt_pk_bf16_f32 v101, v90, v91
    v_exp_f32 v94, v94
    v_exp_f32 v95, v95
    v_cvt_pk_bf16_f32 v102, v92, v93
    v_cvt_pk_bf16_f32 v103, v94, v95
    v_mfma_f32_32x32x16_bf16 v[80:95], v[142:145], v[22:25], 0
    v_exp_f32 v64, v64
    v_exp_f32 v65, v65
    v_exp_f32 v66, v66
    v_exp_f32 v67, v67
    v_cvt_pk_bf16_f32 v96, v64, v65
    v_mfma_f32_32x32x8_bf16 v[80:95], v[146:147], v[26:27], v[80:95]
    v_exp_f32 v68, v68
    v_exp_f32 v69, v69
    v_cvt_pk_bf16_f32 v97, v66, v67
    v_exp_f32 v70, v70
    v_exp_f32 v71, v71
    v_mfma_f32_32x32x16_bf16 v[120:135], v[156:159], v[100:103], v[120:135]
    v_cvt_pk_bf16_f32 v98, v68, v69
    v_exp_f32 v72, v72
    v_exp_f32 v73, v73
    v_cvt_pk_bf16_f32 v99, v70, v71
    v_exp_f32 v74, v74
    v_exp_f32 v75, v75
    s_waitcnt lgkmcnt(0)
    v_mfma_f32_32x32x16_bf16 v[104:119], v[160:163], v[96:99], v[104:119]
    v_cvt_pk_bf16_f32 v100, v72, v73
    v_exp_f32 v76, v76
    v_exp_f32 v77, v77
    v_cvt_pk_bf16_f32 v101, v74, v75
    v_exp_f32 v78, v78
    v_exp_f32 v79, v79
    v_cvt_pk_bf16_f32 v102, v76, v77
    v_cvt_pk_bf16_f32 v103, v78, v79
    v_mfma_f32_32x32x16_bf16 v[64:79], v[136:139], v[16:19], 0
    ds_read_b128 v[152:155], v54 offset:32976
    v_exp_f32 v80, v80
    v_exp_f32 v81, v81
    v_exp_f32 v82, v82
    v_exp_f32 v83, v83
    v_cvt_pk_bf16_f32 v96, v80, v81
    v_mfma_f32_32x32x8_bf16 v[64:79], v[140:141], v[20:21], v[64:79]
    ds_read_b128 v[156:159], v54 offset:33648
    v_exp_f32 v84, v84
    v_exp_f32 v85, v85
    v_cvt_pk_bf16_f32 v97, v82, v83
    v_exp_f32 v86, v86
    v_exp_f32 v87, v87
    v_mfma_f32_32x32x16_bf16 v[104:119], v[164:167], v[100:103], v[104:119]
    ds_read_b128 v[142:145], v30 offset:34320
    v_cvt_pk_bf16_f32 v98, v84, v85
    v_exp_f32 v88, v88
    v_exp_f32 v89, v89
    v_cvt_pk_bf16_f32 v99, v86, v87
    v_exp_f32 v90, v90
    v_exp_f32 v91, v91
    v_mfma_f32_32x32x16_bf16 v[120:135], v[160:163], v[96:99], v[120:135]
    ds_read_b64 v[146:147], v31 offset:35344
    v_cvt_pk_bf16_f32 v100, v88, v89
    v_exp_f32 v92, v92
    v_exp_f32 v93, v93
    v_cvt_pk_bf16_f32 v101, v90, v91
    v_exp_f32 v94, v94
    v_exp_f32 v95, v95
    v_cvt_pk_bf16_f32 v102, v92, v93
    v_cvt_pk_bf16_f32 v103, v94, v95
    v_cmp_gt_u32 vcc, 44, v151
    s_cbranch_vccnz Lkw_112
Lkwo_113:
    v_mfma_f32_32x32x16_bf16 v[80:95], v[136:139], v[22:25], 0
    v_exp_f32 v64, v64
    v_exp_f32 v65, v65
    v_exp_f32 v66, v66
    v_exp_f32 v67, v67
    v_cvt_pk_bf16_f32 v96, v64, v65
    v_mfma_f32_32x32x8_bf16 v[80:95], v[140:141], v[26:27], v[80:95]
    v_exp_f32 v68, v68
    v_exp_f32 v69, v69
    v_cvt_pk_bf16_f32 v97, v66, v67
    v_exp_f32 v70, v70
    v_exp_f32 v71, v71
    v_mfma_f32_32x32x16_bf16 v[120:135], v[164:167], v[100:103], v[120:135]
    v_cvt_pk_bf16_f32 v98, v68, v69
    v_exp_f32 v72, v72
    v_exp_f32 v73, v73
    v_cvt_pk_bf16_f32 v99, v70, v71
    v_exp_f32 v74, v74
    v_exp_f32 v75, v75
    s_waitcnt lgkmcnt(0)
    v_mfma_f32_32x32x16_bf16 v[104:119], v[152:155], v[96:99], v[104:119]
    v_cvt_pk_bf16_f32 v100, v72, v73
    v_exp_f32 v76, v76
    v_exp_f32 v77, v77
    v_cvt_pk_bf16_f32 v101, v74, v75
    v_exp_f32 v78, v78
    v_exp_f32 v79, v79
    v_cvt_pk_bf16_f32 v102, v76, v77
    v_cvt_pk_bf16_f32 v103, v78, v79
    v_mfma_f32_32x32x16_bf16 v[64:79], v[142:145], v[16:19], 0
    ds_read_b128 v[160:163], v54 offset:35616
    s_add_u32 s98, s13, 0
    buffer_load_dwordx4 v[168:171], v15, s[56:59], s98 offen sc1
    v_exp_f32 v80, v80
    v_exp_f32 v81, v81
    v_exp_f32 v82, v82
    v_exp_f32 v83, v83
    v_cvt_pk_bf16_f32 v96, v80, v81
    v_mfma_f32_32x32x8_bf16 v[64:79], v[146:147], v[20:21], v[64:79]
    ds_read_b128 v[164:167], v54 offset:36288
    v_exp_f32 v84, v84
    v_exp_f32 v85, v85
    v_cvt_pk_bf16_f32 v97, v82, v83
    v_exp_f32 v86, v86
    v_exp_f32 v87, v87
    v_mfma_f32_32x32x16_bf16 v[104:119], v[156:159], v[100:103], v[104:119]
    ds_read_b128 v[136:139], v30 offset:36960
    s_add_u32 s98, s13, 4096
    buffer_load_dwordx4 v[172:175], v15, s[56:59], s98 offen sc1
    v_cvt_pk_bf16_f32 v98, v84, v85
    v_exp_f32 v88, v88
    v_exp_f32 v89, v89
    v_cvt_pk_bf16_f32 v99, v86, v87
    v_exp_f32 v90, v90
    v_exp_f32 v91, v91
    v_mfma_f32_32x32x16_bf16 v[120:135], v[152:155], v[96:99], v[120:135]
    ds_read_b64 v[140:141], v31 offset:37984
    s_add_u32 s98, s13, 8192
    buffer_load_dwordx4 v[176:179], v15, s[56:59], s98 offen sc1
    v_cvt_pk_bf16_f32 v100, v88, v89
    v_exp_f32 v92, v92
    v_exp_f32 v93, v93
    v_cvt_pk_bf16_f32 v101, v90, v91
    v_exp_f32 v94, v94
    v_exp_f32 v95, v95
    v_cvt_pk_bf16_f32 v102, v92, v93
    v_cvt_pk_bf16_f32 v103, v94, v95
    v_mfma_f32_32x32x16_bf16 v[80:95], v[142:145], v[22:25], 0
    s_add_u32 s98, s13, 12288
    buffer_load_dwordx4 v[180:183], v15, s[56:59], s98 offen sc1
    v_exp_f32 v64, v64
    v_exp_f32 v65, v65
    v_exp_f32 v66, v66
    v_exp_f32 v67, v67
    v_cvt_pk_bf16_f32 v96, v64, v65
    v_mfma_f32_32x32x8_bf16 v[80:95], v[146:147], v[26:27], v[80:95]
    v_exp_f32 v68, v68
    v_exp_f32 v69, v69
    v_cvt_pk_bf16_f32 v97, v66, v67
    v_exp_f32 v70, v70
    v_exp_f32 v71, v71
    v_mfma_f32_32x32x16_bf16 v[120:135], v[156:159], v[100:103], v[120:135]
    s_add_u32 s98, s13, 16384
    buffer_load_dwordx4 v[184:187], v15, s[56:59], s98 offen sc1
    v_cvt_pk_bf16_f32 v98, v68, v69
    v_exp_f32 v72, v72
    v_exp_f32 v73, v73
    v_cvt_pk_bf16_f32 v99, v70, v71
    v_exp_f32 v74, v74
    v_exp_f32 v75, v75
    s_waitcnt lgkmcnt(0)
    v_mfma_f32_32x32x16_bf16 v[104:119], v[160:163], v[96:99], v[104:119]
    s_add_u32 s98, s13, 20480
    buffer_load_dwordx4 v[188:191], v15, s[56:59], s98 offen sc1
    v_cvt_pk_bf16_f32 v100, v72, v73
    v_exp_f32 v76, v76
    v_exp_f32 v77, v77
    v_cvt_pk_bf16_f32 v101, v74, v75
    v_exp_f32 v78, v78
    v_exp_f32 v79, v79
    v_cvt_pk_bf16_f32 v102, v76, v77
    v_cvt_pk_bf16_f32 v103, v78, v79
    v_mfma_f32_32x32x16_bf16 v[64:79], v[136:139], v[16:19], 0
    ds_read_b128 v[152:155], v54 offset:38256
    s_add_u32 s98, s13, 24576
    buffer_load_dwordx4 v[192:195], v15, s[56:59], s98 offen sc1
    v_exp_f32 v80, v80
    v_exp_f32 v81, v81
    v_exp_f32 v82, v82
    v_exp_f32 v83, v83
    v_cvt_pk_bf16_f32 v96, v80, v81
    v_mfma_f32_32x32x8_bf16 v[64:79], v[140:141], v[20:21], v[64:79]
    ds_read_b128 v[156:159], v54 offset:38928
    v_exp_f32 v84, v84
    v_exp_f32 v85, v85
    v_cvt_pk_bf16_f32 v97, v82, v83
    v_exp_f32 v86, v86
    v_exp_f32 v87, v87
    v_mfma_f32_32x32x16_bf16 v[104:119], v[164:167], v[100:103], v[104:119]
    ds_read_b128 v[142:145], v30 offset:39600
    s_add_u32 s98, s13, 28672
    buffer_load_dwordx4 v[196:199], v15, s[56:59], s98 offen sc1
    v_cvt_pk_bf16_f32 v98, v84, v85
    v_exp_f32 v88, v88
    v_exp_f32 v89, v89
    v_cvt_pk_bf16_f32 v99, v86, v87
    v_exp_f32 v90, v90
    v_exp_f32 v91, v91
    v_mfma_f32_32x32x16_bf16 v[120:135], v[160:163], v[96:99], v[120:135]
    ds_read_b64 v[146:147], v31 offset:40624
    s_add_u32 s98, s13, 32768
    buffer_load_dwordx4 v[200:203], v15, s[56:59], s98 offen sc1
    v_cvt_pk_bf16_f32 v100, v88, v89
    v_exp_f32 v92, v92
    v_exp_f32 v93, v93
    v_cvt_pk_bf16_f32 v101, v90, v91
    v_exp_f32 v94, v94
    v_exp_f32 v95, v95
    v_cvt_pk_bf16_f32 v102, v92, v93
    v_cvt_pk_bf16_f32 v103, v94, v95
    v_mfma_f32_32x32x16_bf16 v[80:95], v[136:139], v[22:25], 0
    s_add_u32 s98, s13, 36864
    buffer_load_dwordx4 v[204:207], v15, s[56:59], s98 offen sc1
    v_exp_f32 v64, v64
    v_exp_f32 v65, v65
    v_exp_f32 v66, v66
    v_exp_f32 v67, v67
    v_cvt_pk_bf16_f32 v96, v64, v65
    v_mfma_f32_32x32x8_bf16 v[80:95], v[140:141], v[26:27], v[80:95]
    v_exp_f32 v68, v68
    v_exp_f32 v69, v69
    v_cvt_pk_bf16_f32 v97, v66, v67
    v_exp_f32 v70, v70
    v_exp_f32 v71, v71
    v_mfma_f32_32x32x16_bf16 v[120:135], v[164:167], v[100:103], v[120:135]
    s_add_u32 s98, s13, 40960
    buffer_load_dwordx4 v[208:211], v15, s[56:59], s98 offen sc1
    v_cvt_pk_bf16_f32 v98, v68, v69
    v_exp_f32 v72, v72
    v_exp_f32 v73, v73
    v_cvt_pk_bf16_f32 v99, v70, v71
    v_exp_f32 v74, v74
    v_exp_f32 v75, v75
    s_waitcnt lgkmcnt(0)
    v_mfma_f32_32x32x16_bf16 v[104:119], v[152:155], v[96:99], v[104:119]
    s_add_u32 s98, s13, 45056
    buffer_load_dwordx4 v[212:215], v15, s[56:59], s98 offen sc1
    v_cvt_pk_bf16_f32 v100, v72, v73
    v_exp_f32 v76, v76
    v_exp_f32 v77, v77
    v_cvt_pk_bf16_f32 v101, v74, v75
    v_exp_f32 v78, v78
    v_exp_f32 v79, v79
    v_cvt_pk_bf16_f32 v102, v76, v77
    v_cvt_pk_bf16_f32 v103, v78, v79
    v_mfma_f32_32x32x16_bf16 v[64:79], v[142:145], v[16:19], 0
    ds_read_b128 v[160:163], v54 offset:40896
    s_add_u32 s98, s13, 49152
    buffer_load_dwordx4 v[216:219], v15, s[56:59], s98 offen sc1
    v_exp_f32 v80, v80
    v_exp_f32 v81, v81
    v_exp_f32 v82, v82
    v_exp_f32 v83, v83
    v_cvt_pk_bf16_f32 v96, v80, v81
    v_mfma_f32_32x32x8_bf16 v[64:79], v[146:147], v[20:21], v[64:79]
    ds_read_b128 v[164:167], v54 offset:41568
    v_exp_f32 v84, v84
    v_exp_f32 v85, v85
    v_cvt_pk_bf16_f32 v97, v82, v83
    v_exp_f32 v86, v86
    v_exp_f32 v87, v87
    v_mfma_f32_32x32x16_bf16 v[104:119], v[156:159], v[100:103], v[104:119]
    ds_read_b32 v151, v4 offset:14344
    s_add_u32 s98, s13, 53248
    buffer_load_dwordx4 v[220:223], v15, s[56:59], s98 offen sc1
    v_cvt_pk_bf16_f32 v98, v84, v85
    v_exp_f32 v88, v88
    v_exp_f32 v89, v89
    v_cvt_pk_bf16_f32 v99, v86, v87
    v_exp_f32 v90, v90
    v_exp_f32 v91, v91
    v_mfma_f32_32x32x16_bf16 v[120:135], v[152:155], v[96:99], v[120:135]
    s_add_u32 s98, s13, 57344
    buffer_load_dwordx4 v[224:227], v15, s[56:59], s98 offen sc1
    v_cvt_pk_bf16_f32 v100, v88, v89
    v_exp_f32 v92, v92
    v_exp_f32 v93, v93
    v_cvt_pk_bf16_f32 v101, v90, v91
    v_exp_f32 v94, v94
    v_exp_f32 v95, v95
    v_cvt_pk_bf16_f32 v102, v92, v93
    v_cvt_pk_bf16_f32 v103, v94, v95
    v_mfma_f32_32x32x16_bf16 v[80:95], v[142:145], v[22:25], 0
    s_add_u32 s98, s13, 61440
    buffer_load_dwordx4 v[228:231], v15, s[56:59], s98 offen sc1
    v_exp_f32 v64, v64
    v_exp_f32 v65, v65
    v_exp_f32 v66, v66
    v_exp_f32 v67, v67
    v_cvt_pk_bf16_f32 v96, v64, v65
    v_mfma_f32_32x32x8_bf16 v[80:95], v[146:147], v[26:27], v[80:95]
    v_exp_f32 v68, v68
    v_exp_f32 v69, v69
    v_cvt_pk_bf16_f32 v97, v66, v67
    v_exp_f32 v70, v70
    v_exp_f32 v71, v71
    v_mfma_f32_32x32x16_bf16 v[120:135], v[156:159], v[100:103], v[120:135]
    s_add_u32 s98, s13, 65536
    buffer_load_dwordx4 v[232:235], v15, s[56:59], s98 offen sc1
    v_cvt_pk_bf16_f32 v98, v68, v69
    v_exp_f32 v72, v72
    v_exp_f32 v73, v73
    v_cvt_pk_bf16_f32 v99, v70, v71
    v_exp_f32 v74, v74
    v_exp_f32 v75, v75
    s_waitcnt lgkmcnt(0)
    v_mfma_f32_32x32x16_bf16 v[104:119], v[160:163], v[96:99], v[104:119]
    s_add_u32 s98, s13, 69632
    buffer_load_dwordx4 v[236:239], v15, s[56:59], s98 offen sc1
    v_cvt_pk_bf16_f32 v100, v72, v73
    v_exp_f32 v76, v76
    v_exp_f32 v77, v77
    v_cvt_pk_bf16_f32 v101, v74, v75
    v_exp_f32 v78, v78
    v_exp_f32 v79, v79
    v_cvt_pk_bf16_f32 v102, v76, v77
    v_cvt_pk_bf16_f32 v103, v78, v79
    s_add_u32 s98, s13, 73728
    buffer_load_dwordx4 v[240:243], v15, s[56:59], s98 offen sc1
    v_exp_f32 v80, v80
    v_exp_f32 v81, v81
    v_exp_f32 v82, v82
    v_exp_f32 v83, v83
    v_cvt_pk_bf16_f32 v96, v80, v81
    v_exp_f32 v84, v84
    v_exp_f32 v85, v85
    v_cvt_pk_bf16_f32 v97, v82, v83
    v_exp_f32 v86, v86
    v_exp_f32 v87, v87
    v_mfma_f32_32x32x16_bf16 v[104:119], v[164:167], v[100:103], v[104:119]
    s_add_u32 s98, s13, 77824
    buffer_load_dwordx4 v[244:247], v15, s[56:59], s98 offen sc1
    v_cvt_pk_bf16_f32 v98, v84, v85
    v_exp_f32 v88, v88
    v_exp_f32 v89, v89
    v_cvt_pk_bf16_f32 v99, v86, v87
    v_exp_f32 v90, v90
    v_exp_f32 v91, v91
    v_mfma_f32_32x32x16_bf16 v[120:135], v[160:163], v[96:99], v[120:135]
    v_cvt_pk_bf16_f32 v100, v88, v89
    v_exp_f32 v92, v92
    v_exp_f32 v93, v93
    v_cvt_pk_bf16_f32 v101, v90, v91
    v_exp_f32 v94, v94
    v_exp_f32 v95, v95
    v_cvt_pk_bf16_f32 v102, v92, v93
    v_cvt_pk_bf16_f32 v103, v94, v95
    s_nop 1
    v_mfma_f32_32x32x16_bf16 v[120:135], v[164:167], v[100:103], v[120:135]
    v_cmp_gt_u32 vcc, 52, v151
    s_nop 0
    s_mov_b32 s11, vcc_lo
    v_mov_b32 v8, 0x17800000
L_finalize:
    ds_read_b128 v[64:67], v52 offset:0
    ds_read_b128 v[68:71], v52 offset:1024
    ds_read_b128 v[72:75], v52 offset:2048
    ds_read_b128 v[76:79], v52 offset:3072
    ds_read_b128 v[80:83], v52 offset:4096
    ds_read_b128 v[32:35], v52 offset:5120
    ds_read_b128 v[36:39], v52 offset:6144
    ds_read_b128 v[40:43], v52 offset:7168
    ds_read_b128 v[44:47], v52 offset:8192
    ds_read_b128 v[48:51], v52 offset:9216
    ds_read_b128 v[84:87], v52 offset:10240
    ds_read_b128 v[88:91], v52 offset:11264
    ds_read_b128 v[92:95], v52 offset:12288
    ds_read_b128 v[96:99], v52 offset:13312
    ds_read_b128 v[100:103], v52 offset:14336
    v_mov_b32 v5, v112
    v_mov_b32 v28, v112
    s_nop 1
    v_permlane32_swap_b32 v5, v28
    v_cmp_nge_f32 vcc, v28, v8
    v_rcp_f32 v28, v28
    s_and_b64 vcc, vcc, s[94:95]
    s_cbranch_vccnz L_fallback
    v_mul_f32 v104, v104, v28
    v_mul_f32 v105, v105, v28
    v_mul_f32 v106, v106, v28
    v_mul_f32 v107, v107, v28
    v_mul_f32 v108, v108, v28
    v_mul_f32 v109, v109, v28
    v_mul_f32 v110, v110, v28
    v_mul_f32 v111, v111, v28
    v_mul_f32 v112, v112, v28
    v_mul_f32 v113, v113, v28
    v_mul_f32 v114, v114, v28
    v_mul_f32 v115, v115, v28
    v_cvt_pk_bf16_f32 v152, v104, v105
    v_cvt_pk_bf16_f32 v153, v106, v107
    v_cvt_pk_bf16_f32 v154, v108, v109
    v_cvt_pk_bf16_f32 v155, v110, v111
    v_min_u32 v152, -2, v152
    buffer_store_dwordx4 v[152:155], v55, s[56:59], s52 offen sc1
    v_cvt_pk_bf16_f32 v160, v112, v113
    v_cvt_pk_bf16_f32 v161, v114, v115
    v_mov_b32 v5, v128
    v_mov_b32 v30, v128
    s_nop 1
    v_permlane32_swap_b32 v5, v30
    v_cmp_nge_f32 vcc, v30, v8
    v_rcp_f32 v30, v30
    s_and_b64 vcc, vcc, s[94:95]
    s_cbranch_vccnz L_fallback
    v_mul_f32 v120, v120, v30
    v_mul_f32 v121, v121, v30
    v_mul_f32 v122, v122, v30
    v_mul_f32 v123, v123, v30
    v_mul_f32 v124, v124, v30
    v_mul_f32 v125, v125, v30
    v_mul_f32 v126, v126, v30
    v_mul_f32 v127, v127, v30
    v_mul_f32 v128, v128, v30
    v_mul_f32 v129, v129, v30
    v_mul_f32 v130, v130, v30
    v_mul_f32 v131, v131, v30
    v_cvt_pk_bf16_f32 v156, v120, v121
    v_cvt_pk_bf16_f32 v157, v122, v123
    v_cvt_pk_bf16_f32 v158, v124, v125
    v_cvt_pk_bf16_f32 v159, v126, v127
    v_min_u32 v156, -2, v156
    buffer_store_dwordx4 v[156:159], v55, s[56:59], s51 offen sc1
    v_cvt_pk_bf16_f32 v162, v128, v129
    v_cvt_pk_bf16_f32 v163, v130, v131
    v_min_u32 v160, -2, v160
    s_mov_b32 exec_lo, 0xffffffff
    s_mov_b32 exec_hi, 0x0
    buffer_store_dwordx4 v[160:163], v55, s[56:59], s53 offen sc1
    s_mov_b64 exec, -1
    s_setprio 0
    s_cmp_eq_u32 s11, 0
    s_cbranch_scc1 Lw_ok_116
    s_mov_b32 s96, 4000000
Lw8_117:
    ds_read_b32 v151, v4 offset:14344
    s_sub_u32 s96, s96, 1
    s_cmp_eq_u32 s96, 0
    s_waitcnt lgkmcnt(0)
    s_cbranch_scc1 Lw8o_118
    v_cmp_gt_u32 vcc, 52, v151
    s_cbranch_vccz Lw8o_118
    s_sleep 1
    s_branch Lw8_117
Lw8o_118:
    ds_read_b128 v[64:67], v52 offset:0
    ds_read_b128 v[68:71], v52 offset:1024
    ds_read_b128 v[72:75], v52 offset:2048
    ds_read_b128 v[76:79], v52 offset:3072
    ds_read_b128 v[80:83], v52 offset:4096
    ds_read_b128 v[32:35], v52 offset:5120
    ds_read_b128 v[36:39], v52 offset:6144
    ds_read_b128 v[40:43], v52 offset:7168
    ds_read_b128 v[44:47], v52 offset:8192
    ds_read_b128 v[48:51], v52 offset:9216
    ds_read_b128 v[84:87], v52 offset:10240
    ds_read_b128 v[88:91], v52 offset:11264
    ds_read_b128 v[92:95], v52 offset:12288
    ds_read_b128 v[96:99], v52 offset:13312
    ds_read_b128 v[100:103], v52 offset:14336
Lw_ok_116:
    s_waitcnt vmcnt(3) lgkmcnt(10)
    v_max3_u32 v5, v168, v172, v176
    v_max_u32 v5, v5, v180
    v_cmp_eq_u32 vcc, -1, v5
    s_cbranch_vccnz Lbr_119
Lbb_120:
    v_mfma_f32_16x16x32_bf16 v[104:107], v[64:67], v[168:171], 0
    ds_read_b128 v[16:19], v52 offset:15360
    v_mfma_f32_16x16x32_bf16 v[108:111], v[68:71], v[168:171], 0
    ds_read_b128 v[20:23], v52 offset:16384
    v_mfma_f32_16x16x32_bf16 v[112:115], v[72:75], v[168:171], 0
    ds_read_b128 v[24:27], v52 offset:17408
    v_mfma_f32_16x16x32_bf16 v[116:119], v[76:79], v[168:171], 0
    ds_read_b128 v[56:59], v52 offset:18432
    v_mfma_f32_16x16x32_bf16 v[120:123], v[80:83], v[168:171], 0
    ds_read_b128 v[60:63], v52 offset:19456
    s_waitcnt lgkmcnt(10)
    v_mfma_f32_16x16x32_bf16 v[104:107], v[32:35], v[172:175], v[104:107]
    ds_read_b128 v[64:67], v52 offset:20480
    v_mfma_f32_16x16x32_bf16 v[108:111], v[36:39], v[172:175], v[108:111]
    ds_read_b128 v[68:71], v52 offset:21504
    v_mfma_f32_16x16x32_bf16 v[112:115], v[40:43], v[172:175], v[112:115]
    ds_read_b128 v[72:75], v52 offset:22528
    v_mfma_f32_16x16x32_bf16 v[116:119], v[44:47], v[172:175], v[116:119]
    ds_read_b128 v[76:79], v52 offset:23552
    v_mfma_f32_16x16x32_bf16 v[120:123], v[48:51], v[172:175], v[120:123]
    ds_read_b128 v[80:83], v52 offset:24576
    s_waitcnt lgkmcnt(10)
    v_mfma_f32_16x16x32_bf16 v[104:107], v[84:87], v[176:179], v[104:107]
    ds_read_b128 v[32:35], v52 offset:25600
    v_mfma_f32_16x16x32_bf16 v[108:111], v[88:91], v[176:179], v[108:111]
    ds_read_b128 v[36:39], v52 offset:26624
    v_mfma_f32_16x16x32_bf16 v[112:115], v[92:95], v[176:179], v[112:115]
    ds_read_b128 v[40:43], v52 offset:27648
    v_mfma_f32_16x16x32_bf16 v[116:119], v[96:99], v[176:179], v[116:119]
    ds_read_b128 v[44:47], v52 offset:28672
    v_mfma_f32_16x16x32_bf16 v[120:123], v[100:103], v[176:179], v[120:123]
    ds_read_b128 v[48:51], v52 offset:29696
    s_waitcnt lgkmcnt(10)
    v_mfma_f32_16x16x32_bf16 v[104:107], v[16:19], v[180:183], v[104:107]
    ds_read_b128 v[84:87], v52 offset:30720
    v_mfma_f32_16x16x32_bf16 v[108:111], v[20:23], v[180:183], v[108:111]
    ds_read_b128 v[88:91], v52 offset:31744
    v_mfma_f32_16x16x32_bf16 v[112:115], v[24:27], v[180:183], v[112:115]
    ds_read_b128 v[92:95], v52 offset:32768
    v_mfma_f32_16x16x32_bf16 v[116:119], v[56:59], v[180:183], v[116:119]
    ds_read_b128 v[96:99], v52 offset:33792
    v_mfma_f32_16x16x32_bf16 v[120:123], v[60:63], v[180:183], v[120:123]
    ds_read_b128 v[100:103], v52 offset:34816
    s_waitcnt lgkmcnt(10)
    v_max3_u32 v5, v184, v188, v192
    v_max_u32 v5, v5, v196
    v_cmp_eq_u32 vcc, -1, v5
    s_cbranch_vccnz Lbr_121
Lbb_122:
    v_mfma_f32_16x16x32_bf16 v[104:107], v[64:67], v[184:187], v[104:107]
    ds_read_b128 v[16:19], v52 offset:35840
    v_mfma_f32_16x16x32_bf16 v[108:111], v[68:71], v[184:187], v[108:111]
    ds_read_b128 v[20:23], v52 offset:36864
    v_mfma_f32_16x16x32_bf16 v[112:115], v[72:75], v[184:187], v[112:115]
    ds_read_b128 v[24:27], v52 offset:37888
    v_mfma_f32_16x16x32_bf16 v[116:119], v[76:79], v[184:187], v[116:119]
    ds_read_b128 v[56:59], v52 offset:38912
    v_mfma_f32_16x16x32_bf16 v[120:123], v[80:83], v[184:187], v[120:123]
    ds_read_b128 v[60:63], v52 offset:39936
    ds_add_u32 v149, v150 offset:14368
    s_waitcnt lgkmcnt(10)
    v_mfma_f32_16x16x32_bf16 v[104:107], v[32:35], v[188:191], v[104:107]
    ds_read_b128 v[64:67], v52 offset:40960
    v_mfma_f32_16x16x32_bf16 v[108:111], v[36:39], v[188:191], v[108:111]
    ds_read_b128 v[68:71], v52 offset:41984
    v_mfma_f32_16x16x32_bf16 v[112:115], v[40:43], v[188:191], v[112:115]
    ds_read_b128 v[72:75], v52 offset:43008
    v_mfma_f32_16x16x32_bf16 v[116:119], v[44:47], v[188:191], v[116:119]
    ds_read_b128 v[76:79], v52 offset:44032
    v_mfma_f32_16x16x32_bf16 v[120:123], v[48:51], v[188:191], v[120:123]
    ds_read_b128 v[80:83], v52 offset:45056
    s_waitcnt lgkmcnt(10)
    v_mfma_f32_16x16x32_bf16 v[104:107], v[84:87], v[192:195], v[104:107]
    ds_read_b128 v[32:35], v52 offset:46080
    v_mfma_f32_16x16x32_bf16 v[108:111], v[88:91], v[192:195], v[108:111]
    ds_read_b128 v[36:39], v52 offset:47104
    v_mfma_f32_16x16x32_bf16 v[112:115], v[92:95], v[192:195], v[112:115]
    ds_read_b128 v[40:43], v52 offset:48128
    v_mfma_f32_16x16x32_bf16 v[116:119], v[96:99], v[192:195], v[116:119]
    ds_read_b128 v[44:47], v52 offset:49152
    v_mfma_f32_16x16x32_bf16 v[120:123], v[100:103], v[192:195], v[120:123]
    ds_read_b128 v[48:51], v52 offset:50176
    s_waitcnt lgkmcnt(10)
    v_mfma_f32_16x16x32_bf16 v[104:107], v[16:19], v[196:199], v[104:107]
    ds_read_b128 v[84:87], v53 offset:0
    v_mfma_f32_16x16x32_bf16 v[108:111], v[20:23], v[196:199], v[108:111]
    ds_read_b128 v[88:91], v53 offset:1024
    v_mfma_f32_16x16x32_bf16 v[112:115], v[24:27], v[196:199], v[112:115]
    ds_read_b128 v[92:95], v53 offset:2048
    v_mfma_f32_16x16x32_bf16 v[116:119], v[56:59], v[196:199], v[116:119]
    ds_read_b128 v[96:99], v53 offset:3072
    v_mfma_f32_16x16x32_bf16 v[120:123], v[60:63], v[196:199], v[120:123]
    ds_read_b128 v[100:103], v53 offset:4096
    s_waitcnt lgkmcnt(10)
    v_max3_u32 v5, v200, v204, v208
    v_max_u32 v5, v5, v212
    v_cmp_eq_u32 vcc, -1, v5
    s_cbranch_vccnz Lbr_123
Lbb_124:
    v_mfma_f32_16x16x32_bf16 v[104:107], v[64:67], v[200:203], v[104:107]
    ds_read_b128 v[16:19], v53 offset:5120
    v_mfma_f32_16x16x32_bf16 v[108:111], v[68:71], v[200:203], v[108:111]
    ds_read_b128 v[20:23], v53 offset:6144
    v_mfma_f32_16x16x32_bf16 v[112:115], v[72:75], v[200:203], v[112:115]
    ds_read_b128 v[24:27], v53 offset:7168
    v_mfma_f32_16x16x32_bf16 v[116:119], v[76:79], v[200:203], v[116:119]
    ds_read_b128 v[56:59], v53 offset:8192
    v_mfma_f32_16x16x32_bf16 v[120:123], v[80:83], v[200:203], v[120:123]
    ds_read_b128 v[60:63], v53 offset:9216
    s_mul_i32 s99, s84, 2560
    v_mul_u32_u24 v6, 160, v2
    v_lshl_add_u32 v6, v3, 3, v6
    v_add_u32 v6, s99, v6
    v_add_u32 v9, s99, v15
    s_mov_b32 s12, 2400
    v_add_u32 v7, 0, v1
    v_mul_u32_u24 v8, 6554, v7
    v_lshrrev_b32 v8, 16, v8
    v_lshlrev_b32 v7, 4, v7
    v_mad_u32_u24 v11, v8, s12, v7
    v_add_u32 v7, 64, v1
    v_mul_u32_u24 v8, 6554, v7
    v_lshrrev_b32 v8, 16, v8
    v_lshlrev_b32 v7, 4, v7
    v_mad_u32_u24 v12, v8, s12, v7
    v_add_u32 v7, 128, v1
    v_mul_u32_u24 v8, 6554, v7
    v_lshrrev_b32 v8, 16, v8
    v_lshlrev_b32 v7, 4, v7
    v_mad_u32_u24 v13, v8, s12, v7
    s_lshl_b32 s10, s4, 2
    s_add_u32 s10, s10, s84
    s_mul_i32 s10, s10, 40960
    s_mul_i32 s98, s5, 160
    s_add_u32 s10, s10, s98
    s_add_u32 s10, s10, 1280
    s_waitcnt vmcnt(0) lgkmcnt(10)
    ds_add_u32 v149, v150 offset:14360
    v_mfma_f32_16x16x32_bf16 v[104:107], v[32:35], v[204:207], v[104:107]
    ds_read_b128 v[64:67], v53 offset:10240
    v_mfma_f32_16x16x32_bf16 v[108:111], v[36:39], v[204:207], v[108:111]
    ds_read_b128 v[68:71], v53 offset:11264
    v_mfma_f32_16x16x32_bf16 v[112:115], v[40:43], v[204:207], v[112:115]
    ds_read_b128 v[72:75], v53 offset:12288
    v_mfma_f32_16x16x32_bf16 v[116:119], v[44:47], v[204:207], v[116:119]
    ds_read_b128 v[76:79], v53 offset:13312
    v_mfma_f32_16x16x32_bf16 v[120:123], v[48:51], v[204:207], v[120:123]
    ds_read_b128 v[80:83], v53 offset:14336
    s_waitcnt lgkmcnt(10)
    v_mfma_f32_16x16x32_bf16 v[104:107], v[84:87], v[208:211], v[104:107]
    ds_read_b128 v[32:35], v53 offset:15360
    v_mfma_f32_16x16x32_bf16 v[108:111], v[88:91], v[208:211], v[108:111]
    ds_read_b128 v[36:39], v53 offset:16384
    v_mfma_f32_16x16x32_bf16 v[112:115], v[92:95], v[208:211], v[112:115]
    ds_read_b128 v[40:43], v53 offset:17408
    v_mfma_f32_16x16x32_bf16 v[116:119], v[96:99], v[208:211], v[116:119]
    ds_read_b128 v[44:47], v53 offset:18432
    v_mfma_f32_16x16x32_bf16 v[120:123], v[100:103], v[208:211], v[120:123]
    ds_read_b128 v[48:51], v53 offset:19456
    s_waitcnt lgkmcnt(10)
    v_mfma_f32_16x16x32_bf16 v[104:107], v[16:19], v[212:215], v[104:107]
    ds_read_b128 v[84:87], v53 offset:20480
    v_mfma_f32_16x16x32_bf16 v[108:111], v[20:23], v[212:215], v[108:111]
    ds_read_b128 v[88:91], v53 offset:21504
    v_mfma_f32_16x16x32_bf16 v[112:115], v[24:27], v[212:215], v[112:115]
    ds_read_b128 v[92:95], v53 offset:22528
    v_mfma_f32_16x16x32_bf16 v[116:119], v[56:59], v[212:215], v[116:119]
    ds_read_b128 v[96:99], v53 offset:23552
    v_mfma_f32_16x16x32_bf16 v[120:123], v[60:63], v[212:215], v[120:123]
    ds_read_b128 v[100:103], v53 offset:24576
    s_waitcnt lgkmcnt(10)
    v_max3_u32 v5, v216, v220, v224
    v_max_u32 v5, v5, v228
    v_cmp_eq_u32 vcc, -1, v5
    s_cbranch_vccnz Lbr_125
Lbb_126:
    v_mfma_f32_16x16x32_bf16 v[104:107], v[64:67], v[216:219], v[104:107]
    ds_read_b128 v[16:19], v53 offset:25600
    v_mfma_f32_16x16x32_bf16 v[108:111], v[68:71], v[216:219], v[108:111]
    ds_read_b128 v[20:23], v53 offset:26624
    v_mfma_f32_16x16x32_bf16 v[112:115], v[72:75], v[216:219], v[112:115]
    ds_read_b128 v[24:27], v53 offset:27648
    v_mfma_f32_16x16x32_bf16 v[116:119], v[76:79], v[216:219], v[116:119]
    ds_read_b128 v[56:59], v53 offset:28672
    v_mfma_f32_16x16x32_bf16 v[120:123], v[80:83], v[216:219], v[120:123]
    ds_read_b128 v[60:63], v53 offset:29696
    s_waitcnt lgkmcnt(10)
    v_mfma_f32_16x16x32_bf16 v[104:107], v[32:35], v[220:223], v[104:107]
    ds_read_b128 v[64:67], v53 offset:30720
    v_mfma_f32_16x16x32_bf16 v[108:111], v[36:39], v[220:223], v[108:111]
    ds_read_b128 v[68:71], v53 offset:31744
    v_mfma_f32_16x16x32_bf16 v[112:115], v[40:43], v[220:223], v[112:115]
    ds_read_b128 v[72:75], v53 offset:32768
    v_mfma_f32_16x16x32_bf16 v[116:119], v[44:47], v[220:223], v[116:119]
    ds_read_b128 v[76:79], v53 offset:33792
    v_mfma_f32_16x16x32_bf16 v[120:123], v[48:51], v[220:223], v[120:123]
    ds_read_b128 v[80:83], v53 offset:34816
    s_waitcnt lgkmcnt(10)
    v_mfma_f32_16x16x32_bf16 v[104:107], v[84:87], v[224:227], v[104:107]
    ds_read_b128 v[32:35], v53 offset:35840
    v_mfma_f32_16x16x32_bf16 v[108:111], v[88:91], v[224:227], v[108:111]
    ds_read_b128 v[36:39], v53 offset:36864
    v_mfma_f32_16x16x32_bf16 v[112:115], v[92:95], v[224:227], v[112:115]
    ds_read_b128 v[40:43], v53 offset:37888
    v_mfma_f32_16x16x32_bf16 v[116:119], v[96:99], v[224:227], v[116:119]
    ds_read_b128 v[44:47], v53 offset:38912
    v_mfma_f32_16x16x32_bf16 v[120:123], v[100:103], v[224:227], v[120:123]
    ds_read_b128 v[48:51], v53 offset:39936
    s_waitcnt lgkmcnt(10)
    v_mfma_f32_16x16x32_bf16 v[104:107], v[16:19], v[228:231], v[104:107]
    ds_read_b128 v[84:87], v53 offset:40960
    v_mfma_f32_16x16x32_bf16 v[108:111], v[20:23], v[228:231], v[108:111]
    ds_read_b128 v[88:91], v53 offset:41984
    v_mfma_f32_16x16x32_bf16 v[112:115], v[24:27], v[228:231], v[112:115]
    ds_read_b128 v[92:95], v53 offset:43008
    v_mfma_f32_16x16x32_bf16 v[116:119], v[56:59], v[228:231], v[116:119]
    ds_read_b128 v[96:99], v53 offset:44032
    v_mfma_f32_16x16x32_bf16 v[120:123], v[60:63], v[228:231], v[120:123]
    ds_read_b128 v[100:103], v53 offset:45056
    s_waitcnt lgkmcnt(10)
    v_max3_u32 v5, v232, v236, v240
    v_max_u32 v5, v5, v244
    v_cmp_eq_u32 vcc, -1, v5
    s_cbranch_vccnz Lbr_127
Lbb_128:
    v_mfma_f32_16x16x32_bf16 v[104:107], v[64:67], v[232:235], v[104:107]
    ds_read_b128 v[16:19], v53 offset:46080
    v_mfma_f32_16x16x32_bf16 v[108:111], v[68:71], v[232:235], v[108:111]
    ds_read_b128 v[20:23], v53 offset:47104
    v_mfma_f32_16x16x32_bf16 v[112:115], v[72:75], v[232:235], v[112:115]
    ds_read_b128 v[24:27], v53 offset:48128
    v_mfma_f32_16x16x32_bf16 v[116:119], v[76:79], v[232:235], v[116:119]
    ds_read_b128 v[56:59], v53 offset:49152
    v_mfma_f32_16x16x32_bf16 v[120:123], v[80:83], v[232:235], v[120:123]
    ds_read_b128 v[60:63], v53 offset:50176
    s_waitcnt lgkmcnt(10)
    v_mfma_f32_16x16x32_bf16 v[104:107], v[32:35], v[236:239], v[104:107]
    v_mfma_f32_16x16x32_bf16 v[108:111], v[36:39], v[236:239], v[108:111]
    v_mfma_f32_16x16x32_bf16 v[112:115], v[40:43], v[236:239], v[112:115]
    v_mfma_f32_16x16x32_bf16 v[116:119], v[44:47], v[236:239], v[116:119]
    v_mfma_f32_16x16x32_bf16 v[120:123], v[48:51], v[236:239], v[120:123]
    s_waitcnt lgkmcnt(5)
    v_mfma_f32_16x16x32_bf16 v[104:107], v[84:87], v[240:243], v[104:107]
    v_mfma_f32_16x16x32_bf16 v[108:111], v[88:91], v[240:243], v[108:111]
    v_mfma_f32_16x16x32_bf16 v[112:115], v[92:95], v[240:243], v[112:115]
    v_mfma_f32_16x16x32_bf16 v[116:119], v[96:99], v[240:243], v[116:119]
    v_mfma_f32_16x16x32_bf16 v[120:123], v[100:103], v[240:243], v[120:123]
    s_waitcnt lgkmcnt(0)
    v_mfma_f32_16x16x32_bf16 v[104:107], v[16:19], v[244:247], v[104:107]
    v_mfma_f32_16x16x32_bf16 v[108:111], v[20:23], v[244:247], v[108:111]
    v_mfma_f32_16x16x32_bf16 v[112:115], v[24:27], v[244:247], v[112:115]
    v_mfma_f32_16x16x32_bf16 v[116:119], v[56:59], v[244:247], v[116:119]
    v_mfma_f32_16x16x32_bf16 v[120:123], v[60:63], v[244:247], v[120:123]
    s_nop 3
    v_cvt_pk_bf16_f32 v104, v104, v105
    v_cvt_pk_bf16_f32 v105, v106, v107
    ds_write_b64 v6, v[104:105] offset:0
    v_cvt_pk_bf16_f32 v108, v108, v109
    v_cvt_pk_bf16_f32 v109, v110, v111
    ds_write_b64 v6, v[108:109] offset:32
    v_cvt_pk_bf16_f32 v112, v112, v113
    v_cvt_pk_bf16_f32 v113, v114, v115
    ds_write_b64 v6, v[112:113] offset:64
    v_cvt_pk_bf16_f32 v116, v116, v117
    v_cvt_pk_bf16_f32 v117, v118, v119
    ds_write_b64 v6, v[116:117] offset:96
    v_cvt_pk_bf16_f32 v120, v120, v121
    v_cvt_pk_bf16_f32 v121, v122, v123
    ds_write_b64 v6, v[120:121] offset:128
    ds_read_b128 v[128:131], v9 offset:0
    ds_read_b128 v[132:135], v9 offset:1024
    s_mov_b32 exec_lo, 0xffffffff
    s_mov_b32 exec_hi, 0x0
    ds_read_b128 v[136:139], v9 offset:2048
    s_mov_b64 exec, -1
    s_waitcnt lgkmcnt(2)
    buffer_store_dwordx4 v[128:131], v11, s[64:67], s10 offen
    s_waitcnt lgkmcnt(1)
    buffer_store_dwordx4 v[132:135], v12, s[64:67], s10 offen
    s_waitcnt lgkmcnt(0)
    s_mov_b32 exec_lo, 0xffffffff
    s_mov_b32 exec_hi, 0x0
    buffer_store_dwordx4 v[136:139], v13, s[64:67], s10 offen
    s_mov_b64 exec, -1
    s_branch L_abl_end
L_groupA:
    v_mov_b32 v53, 1
    v_mov_b32 v252, 0
    v_mov_b32 v253, 0
    ds_write_b64 v4, v[252:253] offset:14344
    ds_write_b64 v4, v[252:253] offset:14352
    ds_write_b64 v4, v[252:253] offset:14360
    ds_write_b64 v4, v[252:253] offset:14368
    ds_write_b64 v4, v[252:253] offset:14376
    s_waitcnt lgkmcnt(0)
    s_mov_b64 s[60:61], s[34:35]
    s_mov_b32 s62, 256
    s_mov_b32 s63, 0x20000
    s_xor_b32 s9, s3, 3
    s_or_b32 s9, s2, s9
    s_cmp_lg_u32 s9, 0
    s_cbranch_scc1 Lnt_2
    s_or_b32 s9, s38, 1
    v_mov_b32 v5, s9
    s_mov_b64 exec, 0x1
    buffer_store_dword v5, v4, s[60:63], 0 offen sc1
    s_mov_b64 exec, -1
Lnt_2:
    s_mov_b64 s[56:57], s[36:37]
    s_mov_b32 s58, 16777216
    s_mov_b32 s59, 0x20000
    s_mov_b64 s[64:65], s[32:33]
    s_mov_b32 s66, 5242880
    s_mov_b32 s67, 0x20000
    s_mov_b64 s[76:77], s[24:25]
    s_mov_b32 s78, 819200
    s_mov_b32 s79, 0x20000
    s_mov_b64 s[80:81], s[30:31]
    s_mov_b32 s82, 819200
    s_mov_b32 s83, 0x20000
    s_mov_b64 s[68:69], s[26:27]
    s_mov_b32 s70, 2621440
    s_mov_b32 s71, 0x20000
    s_mov_b64 s[72:73], s[28:29]
    s_mov_b32 s74, 2457600
    s_mov_b32 s75, 0x20000
    v_lshlrev_b32 v5, 8, v2
    v_add_u32 v7, 0, v3
    v_xor_b32 v7, v7, v2
    v_lshl_add_u32 v216, v7, 4, v5
    v_add_u32 v7, 4, v3
    v_xor_b32 v7, v7, v2
    v_lshl_add_u32 v217, v7, 4, v5
    v_add_u32 v7, 8, v3
    v_xor_b32 v7, v7, v2
    v_lshl_add_u32 v218, v7, 4, v5
    v_add_u32 v7, 12, v3
    v_xor_b32 v7, v7, v2
    v_lshl_add_u32 v219, v7, 4, v5
    v_lshrrev_b32 v5, 2, v1
    v_and_b32 v7, 3, v1
    v_lshlrev_b32 v7, 3, v7
    v_mul_u32_u24 v220, 160, v5
    v_add_u32 v220, v220, v7
    v_lshl_add_u32 v5, v3, 2, v5
    v_mul_u32_u24 v222, 40, v5
    s_lshl_b32 s12, s84, 3
    s_add_u32 s12, s12, 96384
    v_add3_u32 v222, v222, v7, s12
    s_and_b32 s12, s84, 1
    s_lshl_b32 s12, s12, 4
    v_add_u32 v9, s12, v2
    s_and_b32 s12, s84, 2
    s_lshl_b32 s12, s12, 1
    v_add_u32 v5, 0, v3
    v_mul_u32_u24 v7, 52, v5
    v_lshrrev_b32 v7, 8, v7
    v_mul_u32_u24 v8, 5, v7
    v_sub_u32 v5, v5, v8
    v_add_u32 v7, s12, v7
    v_lshrrev_b32 v223, 1, v5
    v_lshl_add_u32 v223, v223, 5, v9
    v_lshlrev_b32 v223, 4, v223
    v_lshl_add_u32 v223, v7, 10, v223
    v_and_b32 v10, 1, v5
    v_lshl_add_u32 v223, v10, 3, v223
    v_lshlrev_b32 v10, 3, v9
    v_lshl_add_u32 v10, v7, 9, v10
    v_add_u32 v10, 10240, v10
    v_cmp_eq_u32 vcc, 4, v5
    s_nop 1
    v_cndmask_b32 v223, v223, v10, vcc
    v_add_u32 v5, 4, v3
    v_mul_u32_u24 v7, 52, v5
    v_lshrrev_b32 v7, 8, v7
    v_mul_u32_u24 v8, 5, v7
    v_sub_u32 v5, v5, v8
    v_add_u32 v7, s12, v7
    v_lshrrev_b32 v224, 1, v5
    v_lshl_add_u32 v224, v224, 5, v9
    v_lshlrev_b32 v224, 4, v224
    v_lshl_add_u32 v224, v7, 10, v224
    v_and_b32 v10, 1, v5
    v_lshl_add_u32 v224, v10, 3, v224
    v_lshlrev_b32 v10, 3, v9
    v_lshl_add_u32 v10, v7, 9, v10
    v_add_u32 v10, 10240, v10
    v_cmp_eq_u32 vcc, 4, v5
    s_nop 1
    v_cndmask_b32 v224, v224, v10, vcc
    v_add_u32 v5, 8, v3
    v_mul_u32_u24 v7, 52, v5
    v_lshrrev_b32 v7, 8, v7
    v_mul_u32_u24 v8, 5, v7
    v_sub_u32 v5, v5, v8
    v_add_u32 v7, s12, v7
    v_lshrrev_b32 v225, 1, v5
    v_lshl_add_u32 v225, v225, 5, v9
    v_lshlrev_b32 v225, 4, v225
    v_lshl_add_u32 v225, v7, 10, v225
    v_and_b32 v10, 1, v5
    v_lshl_add_u32 v225, v10, 3, v225
    v_lshlrev_b32 v10, 3, v9
    v_lshl_add_u32 v10, v7, 9, v10
    v_add_u32 v10, 10240, v10
    v_cmp_eq_u32 vcc, 4, v5
    s_nop 1
    v_cndmask_b32 v225, v225, v10, vcc
    v_add_u32 v5, 12, v3
    v_mul_u32_u24 v7, 52, v5
    v_lshrrev_b32 v7, 8, v7
    v_mul_u32_u24 v8, 5, v7
    v_sub_u32 v5, v5, v8
    v_add_u32 v7, s12, v7
    v_lshrrev_b32 v226, 1, v5
    v_lshl_add_u32 v226, v226, 5, v9
    v_lshlrev_b32 v226, 4, v226
    v_lshl_add_u32 v226, v7, 10, v226
    v_and_b32 v10, 1, v5
    v_lshl_add_u32 v226, v10, 3, v226
    v_lshlrev_b32 v10, 3, v9
    v_lshl_add_u32 v10, v7, 9, v10
    v_add_u32 v10, 10240, v10
    v_cmp_eq_u32 vcc, 4, v5
    s_nop 1
    v_cndmask_b32 v226, v226, v10, vcc
    v_add_u32 v5, 16, v3
    v_mul_u32_u24 v7, 52, v5
    v_lshrrev_b32 v7, 8, v7
    v_mul_u32_u24 v8, 5, v7
    v_sub_u32 v5, v5, v8
    v_add_u32 v7, s12, v7
    v_lshrrev_b32 v227, 1, v5
    v_lshl_add_u32 v227, v227, 5, v9
    v_lshlrev_b32 v227, 4, v227
    v_lshl_add_u32 v227, v7, 10, v227
    v_and_b32 v10, 1, v5
    v_lshl_add_u32 v227, v10, 3, v227
    v_lshlrev_b32 v10, 3, v9
    v_lshl_add_u32 v10, v7, 9, v10
    v_add_u32 v10, 10240, v10
    v_cmp_eq_u32 vcc, 4, v5
    s_nop 1
    v_cndmask_b32 v227, v227, v10, vcc
    s_lshl_b32 s12, s84, 12
    s_add_u32 s12, s12, 14464
    v_lshl_add_u32 v5, v2, 7, s12
    v_lshrrev_b32 v8, 1, v2
    v_add_u32 v7, 0, v3
    v_xor_b32 v7, v7, v8
    v_lshl_add_u32 v56, v7, 4, v5
    v_add_u32 v58, 65536, v56
    v_add_u32 v7, 4, v3
    v_xor_b32 v7, v7, v8
    v_lshl_add_u32 v57, v7, 4, v5
    v_add_u32 v59, 65536, v57
    v_lshrrev_b32 v5, 2, v1
    v_and_b32 v7, 3, v1
    v_lshlrev_b32 v7, 3, v7
    v_lshl_add_u32 v7, v5, 8, v7
    v_add_u32 v7, 30848, v7
    v_and_b32 v5, 7, v5
    v_xor_b32 v8, 0, v5
    v_lshl_add_u32 v32, v8, 5, v7
    v_add_u32 v40, 65536, v32
    v_xor_b32 v8, 1, v5
    v_lshl_add_u32 v33, v8, 5, v7
    v_add_u32 v41, 65536, v33
    v_xor_b32 v8, 2, v5
    v_lshl_add_u32 v34, v8, 5, v7
    v_add_u32 v42, 65536, v34
    v_xor_b32 v8, 3, v5
    v_lshl_add_u32 v35, v8, 5, v7
    v_add_u32 v43, 65536, v35
    v_xor_b32 v8, 4, v5
    v_lshl_add_u32 v36, v8, 5, v7
    v_add_u32 v44, 65536, v36
    v_xor_b32 v8, 5, v5
    v_lshl_add_u32 v37, v8, 5, v7
    v_add_u32 v45, 65536, v37
    v_xor_b32 v8, 6, v5
    v_lshl_add_u32 v38, v8, 5, v7
    v_add_u32 v46, 65536, v38
    v_xor_b32 v8, 7, v5
    v_lshl_add_u32 v39, v8, 5, v7
    v_add_u32 v47, 65536, v39
    v_add_u32 v6, 0, v0
    v_mul_u32_u24 v7, 6554, v6
    v_lshrrev_b32 v7, 16, v7
    v_mul_u32_u24 v8, 10, v7
    v_sub_u32 v5, v6, v8
    v_lshlrev_b32 v5, 4, v5
    s_lshl_b32 s12, s4, 5
    v_add_u32 v9, s12, v7
    v_mul_u32_u24 v8, 52429, v9
    v_lshrrev_b32 v8, 21, v8
    v_mul_u32_u24 v8, 40, v8
    v_sub_u32 v10, v9, v8
    v_and_b32 v11, 3, v10
    v_add_u32 v8, v8, v11
    v_bfe_u32 v11, v10, 2, 1
    v_mul_u32_u24 v11, 20, v11
    v_lshrrev_b32 v10, 3, v10
    v_lshl_add_u32 v10, v10, 2, v11
    v_add_u32 v8, v8, v10
    v_mul_u32_u24 v18, 1280, v8
    v_add_u32 v18, v18, v5
    v_mul_u32_u24 v8, 52429, v9
    v_lshrrev_b32 v8, 22, v8
    v_mul_u32_u24 v8, 80, v8
    v_sub_u32 v10, v9, v8
    v_and_b32 v11, 3, v10
    v_add_u32 v8, v8, v11
    v_bfe_u32 v11, v10, 2, 1
    v_bfe_u32 v12, v10, 3, 1
    v_lshrrev_b32 v13, 4, v10
    v_mul_u32_u24 v13, 20, v13
    v_lshl_add_u32 v13, v12, 2, v13
    v_lshl_add_u32 v13, v11, 3, v13
    v_lshl_add_u32 v12, v12, 1, v11
    v_mul_u32_u24 v12, 20, v12
    v_add_u32 v12, 16, v12
    v_cmp_le_u32 vcc, 64, v10
    s_nop 1
    v_cndmask_b32 v13, v13, v12, vcc
    v_add_u32 v13, v13, v8
    v_mul_u32_u24 v13, 1280, v13
    v_add_u32 v16, v13, v5
    v_add_u32 v6, 256, v0
    v_mul_u32_u24 v7, 6554, v6
    v_lshrrev_b32 v7, 16, v7
    v_mul_u32_u24 v8, 10, v7
    v_sub_u32 v5, v6, v8
    v_lshlrev_b32 v5, 4, v5
    s_lshl_b32 s12, s4, 5
    v_add_u32 v9, s12, v7
    v_mul_u32_u24 v8, 52429, v9
    v_lshrrev_b32 v8, 21, v8
    v_mul_u32_u24 v8, 40, v8
    v_sub_u32 v10, v9, v8
    v_and_b32 v11, 3, v10
    v_add_u32 v8, v8, v11
    v_bfe_u32 v11, v10, 2, 1
    v_mul_u32_u24 v11, 20, v11
    v_lshrrev_b32 v10, 3, v10
    v_lshl_add_u32 v10, v10, 2, v11
    v_add_u32 v8, v8, v10
    v_mul_u32_u24 v19, 1280, v8
    v_add_u32 v19, v19, v5
    v_mul_u32_u24 v8, 52429, v9
    v_lshrrev_b32 v8, 22, v8
    v_mul_u32_u24 v8, 80, v8
    v_sub_u32 v10, v9, v8
    v_and_b32 v11, 3, v10
    v_add_u32 v8, v8, v11
    v_bfe_u32 v11, v10, 2, 1
    v_bfe_u32 v12, v10, 3, 1
    v_lshrrev_b32 v13, 4, v10
    v_mul_u32_u24 v13, 20, v13
    v_lshl_add_u32 v13, v12, 2, v13
    v_lshl_add_u32 v13, v11, 3, v13
    v_lshl_add_u32 v12, v12, 1, v11
    v_mul_u32_u24 v12, 20, v12
    v_add_u32 v12, 16, v12
    v_cmp_le_u32 vcc, 64, v10
    s_nop 1
    v_cndmask_b32 v13, v13, v12, vcc
    v_add_u32 v13, v13, v8
    v_mul_u32_u24 v13, 1280, v13
    v_add_u32 v17, v13, v5
    v_lshrrev_b32 v5, 3, v1
    v_add_u32 v5, 0, v5
    v_bfe_u32 v7, v5, 1, 3
    v_and_b32 v8, 7, v1
    v_xor_b32 v7, v7, v8
    v_mul_u32_u24 v5, 1280, v5
    v_lshl_add_u32 v60, v7, 4, v5
    v_lshrrev_b32 v5, 3, v1
    v_add_u32 v5, 8, v5
    v_bfe_u32 v7, v5, 1, 3
    v_and_b32 v8, 7, v1
    v_xor_b32 v7, v7, v8
    v_mul_u32_u24 v5, 1280, v5
    v_lshl_add_u32 v61, v7, 4, v5
    s_mul_i32 s97, s7, 80
    s_xor_b32 s98, s7, 1
    s_mul_i32 s98, s98, 80
    v_add_u32 v7, 0, v3
    v_lshlrev_b32 v7, 1, v7
    v_xor_b32 v7, v7, v2
    v_min_u32 v7, 14, v7
    v_mul_u32_u24 v8, 52, v7
    v_lshrrev_b32 v8, 8, v8
    v_mul_u32_u24 v9, 5, v8
    v_sub_u32 v7, v7, v9
    v_add_u32 v8, 1, v8
    v_cmp_eq_u32 vcc, 3, v8
    v_mul_u32_u24 v8, 1280, v8
    v_add_u32 v8, s97, v8
    v_mov_b32 v9, s98
    v_cndmask_b32 v8, v8, v9, vcc
    v_lshl_add_u32 v7, v7, 4, v8
    v_add_u32 v8, 0, v3
    v_mul_u32_u24 v8, 3840, v8
    v_add_u32 v62, v7, v8
    v_add_u32 v7, 4, v3
    v_lshlrev_b32 v7, 1, v7
    v_xor_b32 v7, v7, v2
    v_min_u32 v7, 14, v7
    v_mul_u32_u24 v8, 52, v7
    v_lshrrev_b32 v8, 8, v8
    v_mul_u32_u24 v9, 5, v8
    v_sub_u32 v7, v7, v9
    v_add_u32 v8, 1, v8
    v_cmp_eq_u32 vcc, 3, v8
    v_mul_u32_u24 v8, 1280, v8
    v_add_u32 v8, s97, v8
    v_mov_b32 v9, s98
    v_cndmask_b32 v8, v8, v9, vcc
    v_lshl_add_u32 v7, v7, 4, v8
    v_add_u32 v8, 8, v3
    v_mul_u32_u24 v8, 3840, v8
    v_add_u32 v63, v7, v8
    s_and_b32 s12, s4, 3
    s_mul_i32 s88, s12, 3
    s_add_u32 s88, s88, s5
    s_sub_u32 s12, s88, 10
    s_cmp_ge_u32 s88, 10
    s_cselect_b32 s88, s12, s88
    s_lshl_b32 s12, s6, 2
    s_add_u32 s12, s12, s84
    s_mul_i32 s90, s12, 40960
    s_lshr_b32 s12, s84, 1
    s_lshl_b32 s12, s12, 3
    s_and_b32 s15, s84, 1
    s_add_u32 s12, s12, s15
    s_mul_i32 s15, s12, 15360
    s_and_b32 s97, s84, 1
    s_mul_i32 s98, s5, 10
    s_lshl_b32 s52, s97, 2
    s_add_u32 s52, s52, s98
    s_add_u32 s51, s52, 2
    s_add_u32 s53, s98, s97
    s_add_u32 s53, s53, 8
    s_mul_i32 s98, s4, 81920
    s_and_b32 s97, s84, 2
    s_lshl_b32 s97, s97, 10
    s_add_u32 s98, s98, s97
    s_add_u32 s98, s98, 2097152
    s_and_b32 s97, s52, 3
    s_lshl_b32 s97, s97, 8
    s_lshr_b32 s52, s52, 2
    s_lshl_b32 s52, s52, 12
    s_add_u32 s52, s52, s97
    s_add_u32 s52, s52, s98
    s_and_b32 s97, s51, 3
    s_lshl_b32 s97, s97, 8
    s_lshr_b32 s51, s51, 2
    s_lshl_b32 s51, s51, 12
    s_add_u32 s51, s51, s97
    s_add_u32 s51, s51, s98
    s_and_b32 s97, s53, 3
    s_lshl_b32 s97, s97, 8
    s_lshr_b32 s53, s53, 2
    s_lshl_b32 s53, s53, 12
    s_add_u32 s53, s53, s97
    s_add_u32 s53, s53, s98
    v_lshrrev_b32 v55, 1, v3
    v_lshlrev_b32 v55, 8, v55
    v_and_b32 v5, 1, v3
    v_lshl_add_u32 v55, v5, 10, v55
    v_lshl_add_u32 v55, v2, 4, v55
    s_lshl_b32 s44, s6, 1
    s_lshr_b32 s98, s84, 1
    s_add_u32 s44, s44, s98
    s_mul_i32 s44, s44, 81920
    s_and_b32 s98, s84, 1
    s_lshl_b32 s98, s98, 11
    s_add_u32 s44, s44, s98
    s_add_u32 s44, s44, 5242880
    s_xor_b32 s98, s7, 1
    s_mul_i32 s98, s98, 5
    v_add_u32 v7, s98, v3
    v_lshrrev_b32 v49, 2, v7
    v_mul_u32_u24 v49, 3072, v49
    v_lshl_add_u32 v49, v7, 8, v49
    v_lshl_add_u32 v49, v2, 4, v49
    s_add_u32 s98, s98, 4
    s_lshr_b32 s45, s98, 2
    s_mul_i32 s45, s45, 3072
    s_lshl_b32 s98, s98, 8
    s_add_u32 s45, s45, s98
    s_add_u32 s45, s45, s44
    buffer_load_dword v48, v4, s[60:63], 0 offen sc1
    s_barrier
    s_cmp_ge_u32 s3, 2
    s_cbranch_scc1 Lw_3
    s_bfe_u32 s9, s5, 0x10001
    s_lshl_b32 s10, s4, 1
    s_add_u32 s10, s10, s9
    s_mul_i32 s10, s10, 2640
    s_add_u32 s10, s10, 1310720
    s_and_b32 s9, s5, 1
    s_lshr_b32 s13, s5, 2
    s_lshl_b32 s13, s13, 1
    s_add_u32 s13, s13, s84
    v_mov_b32 v5, 0
    s_cmp_ge_u32 s13, 2
    s_cbranch_scc1 LkvV_5
    s_and_b32 s12, s5, 3
    s_lshl_b32 s12, s12, 12
    s_add_u32 s12, s12, 14464
    v_add_u32 v232, s12, v216
    v_add_u32 v233, s12, v217
    v_add_u32 v234, s12, v218
    v_add_u32 v235, s12, v219
    ds_read_b128 v[96:99], v232 offset:0
    ds_read_b64_tr_b16 v[176:177], v222 offset:0
    ds_read_b64_tr_b16 v[178:179], v222 offset:160
    ds_read_b128 v[100:103], v233 offset:0
    ds_read_b64_tr_b16 v[180:181], v222 offset:1280
    ds_read_b64_tr_b16 v[182:183], v222 offset:1440
    ds_read_b128 v[104:107], v234 offset:0
    ds_read_b64_tr_b16 v[184:185], v222 offset:2560
    ds_read_b64_tr_b16 v[186:187], v222 offset:2720
    ds_read_b128 v[108:111], v235 offset:0
    ds_read_b64_tr_b16 v[188:189], v222 offset:3840
    ds_read_b64_tr_b16 v[190:191], v222 offset:4000
    ds_read_b128 v[112:115], v232 offset:16384
    ds_read_b64_tr_b16 v[192:193], v222 offset:5120
    ds_read_b64_tr_b16 v[194:195], v222 offset:5280
    s_waitcnt lgkmcnt(12)
    v_mfma_f32_16x16x32_bf16 v[84:87], v[176:179], v[96:99], 0
    ds_read_b128 v[116:119], v233 offset:16384
    ds_read_b64_tr_b16 v[196:197], v222 offset:6400
    ds_read_b64_tr_b16 v[198:199], v222 offset:6560
    s_waitcnt lgkmcnt(12)
    v_mfma_f32_16x16x32_bf16 v[84:87], v[180:183], v[100:103], v[84:87]
    ds_read_b128 v[120:123], v234 offset:16384
    ds_read_b64_tr_b16 v[200:201], v222 offset:7680
    ds_read_b64_tr_b16 v[202:203], v222 offset:7840
    s_waitcnt lgkmcnt(12)
    v_mfma_f32_16x16x32_bf16 v[84:87], v[184:187], v[104:107], v[84:87]
    ds_read_b128 v[124:127], v235 offset:16384
    ds_read_b64_tr_b16 v[204:205], v222 offset:8960
    ds_read_b64_tr_b16 v[206:207], v222 offset:9120
    s_waitcnt lgkmcnt(12)
    v_mfma_f32_16x16x32_bf16 v[84:87], v[188:191], v[108:111], v[84:87]
    ds_read_b128 v[128:131], v232 offset:32768
    ds_read_b64_tr_b16 v[208:209], v222 offset:10240
    ds_read_b64_tr_b16 v[210:211], v222 offset:10400
    s_waitcnt lgkmcnt(12)
    v_mfma_f32_16x16x32_bf16 v[84:87], v[192:195], v[112:115], v[84:87]
    ds_read_b128 v[132:135], v233 offset:32768
    ds_read_b64_tr_b16 v[212:213], v222 offset:11520
    ds_read_b64_tr_b16 v[214:215], v222 offset:11680
    s_waitcnt lgkmcnt(12)
    v_mfma_f32_16x16x32_bf16 v[84:87], v[196:199], v[116:119], v[84:87]
    ds_read_b128 v[136:139], v234 offset:32768
    ds_read_b64_tr_b16 v[176:177], v222 offset:12800
    ds_read_b64_tr_b16 v[178:179], v222 offset:12960
    s_waitcnt lgkmcnt(12)
    v_mfma_f32_16x16x32_bf16 v[84:87], v[200:203], v[120:123], v[84:87]
    ds_read_b128 v[140:143], v235 offset:32768
    ds_read_b64_tr_b16 v[180:181], v222 offset:14080
    ds_read_b64_tr_b16 v[182:183], v222 offset:14240
    s_waitcnt lgkmcnt(12)
    v_mfma_f32_16x16x32_bf16 v[84:87], v[204:207], v[124:127], v[84:87]
    ds_read_b128 v[144:147], v232 offset:49152
    ds_read_b64_tr_b16 v[184:185], v222 offset:15360
    ds_read_b64_tr_b16 v[186:187], v222 offset:15520
    s_waitcnt lgkmcnt(12)
    v_mfma_f32_16x16x32_bf16 v[84:87], v[208:211], v[128:131], v[84:87]
    ds_read_b128 v[148:151], v233 offset:49152
    ds_read_b64_tr_b16 v[188:189], v222 offset:16640
    ds_read_b64_tr_b16 v[190:191], v222 offset:16800
    s_waitcnt lgkmcnt(12)
    v_mfma_f32_16x16x32_bf16 v[84:87], v[212:215], v[132:135], v[84:87]
    ds_read_b128 v[152:155], v234 offset:49152
    ds_read_b64_tr_b16 v[192:193], v222 offset:17920
    ds_read_b64_tr_b16 v[194:195], v222 offset:18080
    s_waitcnt lgkmcnt(12)
    v_mfma_f32_16x16x32_bf16 v[84:87], v[176:179], v[136:139], v[84:87]
    ds_read_b128 v[156:159], v235 offset:49152
    ds_read_b64_tr_b16 v[196:197], v222 offset:19200
    ds_read_b64_tr_b16 v[198:199], v222 offset:19360
    s_waitcnt lgkmcnt(12)
    v_mfma_f32_16x16x32_bf16 v[84:87], v[180:183], v[140:143], v[84:87]
    v_add_u32 v232, 65536, v232
    v_add_u32 v233, 65536, v233
    v_add_u32 v234, 65536, v234
    v_add_u32 v235, 65536, v235
    ds_read_b128 v[160:163], v232 offset:0
    ds_read_b64_tr_b16 v[200:201], v222 offset:20480
    ds_read_b64_tr_b16 v[202:203], v222 offset:20640
    s_waitcnt lgkmcnt(12)
    v_mfma_f32_16x16x32_bf16 v[84:87], v[184:187], v[144:147], v[84:87]
    ds_read_b128 v[164:167], v233 offset:0
    ds_read_b64_tr_b16 v[204:205], v222 offset:21760
    ds_read_b64_tr_b16 v[206:207], v222 offset:21920
    s_waitcnt lgkmcnt(12)
    v_mfma_f32_16x16x32_bf16 v[84:87], v[188:191], v[148:151], v[84:87]
    ds_read_b128 v[168:171], v234 offset:0
    ds_read_b64_tr_b16 v[208:209], v222 offset:23040
    ds_read_b64_tr_b16 v[210:211], v222 offset:23200
    s_waitcnt lgkmcnt(12)
    v_mfma_f32_16x16x32_bf16 v[84:87], v[192:195], v[152:155], v[84:87]
    ds_read_b128 v[172:175], v235 offset:0
    ds_read_b64_tr_b16 v[212:213], v222 offset:24320
    ds_read_b64_tr_b16 v[214:215], v222 offset:24480
    s_waitcnt lgkmcnt(12)
    v_mfma_f32_16x16x32_bf16 v[84:87], v[196:199], v[156:159], v[84:87]
    s_waitcnt lgkmcnt(9)
    v_mfma_f32_16x16x32_bf16 v[84:87], v[200:203], v[160:163], v[84:87]
    s_waitcnt lgkmcnt(6)
    v_mfma_f32_16x16x32_bf16 v[84:87], v[204:207], v[164:167], v[84:87]
    s_waitcnt lgkmcnt(3)
    v_mfma_f32_16x16x32_bf16 v[84:87], v[208:211], v[168:171], v[84:87]
    s_waitcnt lgkmcnt(0)
    v_mfma_f32_16x16x32_bf16 v[84:87], v[212:215], v[172:175], v[84:87]
    s_nop 7
    v_mul_f32 v84, 0x3ea52b5c, v84
    v_mul_f32 v85, 0x3ea52b5c, v85
    v_mul_f32 v86, 0x3ea52b5c, v86
    v_mul_f32 v87, 0x3ea52b5c, v87
    v_cvt_pk_bf16_f32 v84, v84, v85
    v_cvt_pk_bf16_f32 v85, v86, v87
    s_lshl_b32 s9, s9, 4
    v_add_u32 v9, s9, v2
    s_cmp_eq_u32 s13, 1
    s_cbranch_scc1 LKhi_6
    v_lshrrev_b32 v7, 1, v3
    v_lshl_add_u32 v7, v7, 5, v9
    v_lshlrev_b32 v7, 4, v7
    v_and_b32 v8, 1, v3
    v_lshl_add_u32 v7, v8, 3, v7
    s_branch LKst_7
LKhi_6:
    s_add_u32 s10, s10, 1024
    v_mov_b32 v7, 256
    v_mov_b32 v92, 0x3f80
    v_mov_b32 v93, 0
    s_mov_b64 exec, 0x1
    buffer_store_dwordx2 v[92:93], v7, s[56:59], s10 offen sc1
    s_mov_b32 exec_lo, 0x0
    s_mov_b32 exec_hi, 0xffff0000
    v_lshlrev_b32 v7, 3, v9
LKst_7:
    buffer_store_dwordx2 v[84:85], v7, s[56:59], s10 offen sc1
    v_dot2_f32_bf16 v5, v84, v84, v5
    v_dot2_f32_bf16 v5, v85, v85, v5
    s_mov_b64 exec, -1
    s_nop 1
    v_mov_b32 v8, v5
    s_nop 1
    v_permlane32_swap_b32 v8, v5
    v_add_f32 v5, v5, v8
    v_mov_b32 v8, v5
    s_nop 1
    v_permlane16_swap_b32 v8, v5
    v_add_f32 v5, v5, v8
    s_nop 1
    v_max_u32_dpp v5, v5, v5 row_ror:8 row_mask:0xf bank_mask:0xf
    s_nop 1
    v_max_u32_dpp v5, v5, v5 row_ror:4 row_mask:0xf bank_mask:0xf
    s_nop 1
    v_max_u32_dpp v5, v5, v5 row_ror:2 row_mask:0xf bank_mask:0xf
    s_nop 1
    v_max_u32_dpp v5, v5, v5 row_ror:1 row_mask:0xf bank_mask:0xf
    s_branch Lkvskip_4
LkvV_5:
    s_and_b32 s12, s5, 3
    s_lshl_b32 s12, s12, 12
    s_add_u32 s12, s12, 14464
    v_add_u32 v232, s12, v216
    v_add_u32 v233, s12, v217
    v_add_u32 v234, s12, v218
    v_add_u32 v235, s12, v219
    ds_read_b128 v[96:99], v232 offset:0
    ds_read_b64_tr_b16 v[176:177], v222 offset:0
    ds_read_b64_tr_b16 v[178:179], v222 offset:160
    ds_read_b128 v[100:103], v233 offset:0
    ds_read_b64_tr_b16 v[180:181], v222 offset:1280
    ds_read_b64_tr_b16 v[182:183], v222 offset:1440
    ds_read_b128 v[104:107], v234 offset:0
    ds_read_b64_tr_b16 v[184:185], v222 offset:2560
    ds_read_b64_tr_b16 v[186:187], v222 offset:2720
    ds_read_b128 v[108:111], v235 offset:0
    ds_read_b64_tr_b16 v[188:189], v222 offset:3840
    ds_read_b64_tr_b16 v[190:191], v222 offset:4000
    ds_read_b128 v[112:115], v232 offset:16384
    ds_read_b64_tr_b16 v[192:193], v222 offset:5120
    ds_read_b64_tr_b16 v[194:195], v222 offset:5280
    s_waitcnt lgkmcnt(12)
    v_mfma_f32_16x16x32_bf16 v[84:87], v[96:99], v[176:179], 0
    ds_read_b128 v[116:119], v233 offset:16384
    ds_read_b64_tr_b16 v[196:197], v222 offset:6400
    ds_read_b64_tr_b16 v[198:199], v222 offset:6560
    s_waitcnt lgkmcnt(12)
    v_mfma_f32_16x16x32_bf16 v[84:87], v[100:103], v[180:183], v[84:87]
    ds_read_b128 v[120:123], v234 offset:16384
    ds_read_b64_tr_b16 v[200:201], v222 offset:7680
    ds_read_b64_tr_b16 v[202:203], v222 offset:7840
    s_waitcnt lgkmcnt(12)
    v_mfma_f32_16x16x32_bf16 v[84:87], v[104:107], v[184:187], v[84:87]
    ds_read_b128 v[124:127], v235 offset:16384
    ds_read_b64_tr_b16 v[204:205], v222 offset:8960
    ds_read_b64_tr_b16 v[206:207], v222 offset:9120
    s_waitcnt lgkmcnt(12)
    v_mfma_f32_16x16x32_bf16 v[84:87], v[108:111], v[188:191], v[84:87]
    ds_read_b128 v[128:131], v232 offset:32768
    ds_read_b64_tr_b16 v[208:209], v222 offset:10240
    ds_read_b64_tr_b16 v[210:211], v222 offset:10400
    s_waitcnt lgkmcnt(12)
    v_mfma_f32_16x16x32_bf16 v[84:87], v[112:115], v[192:195], v[84:87]
    ds_read_b128 v[132:135], v233 offset:32768
    ds_read_b64_tr_b16 v[212:213], v222 offset:11520
    ds_read_b64_tr_b16 v[214:215], v222 offset:11680
    s_waitcnt lgkmcnt(12)
    v_mfma_f32_16x16x32_bf16 v[84:87], v[116:119], v[196:199], v[84:87]
    ds_read_b128 v[136:139], v234 offset:32768
    ds_read_b64_tr_b16 v[176:177], v222 offset:12800
    ds_read_b64_tr_b16 v[178:179], v222 offset:12960
    s_waitcnt lgkmcnt(12)
    v_mfma_f32_16x16x32_bf16 v[84:87], v[120:123], v[200:203], v[84:87]
    ds_read_b128 v[140:143], v235 offset:32768
    ds_read_b64_tr_b16 v[180:181], v222 offset:14080
    ds_read_b64_tr_b16 v[182:183], v222 offset:14240
    s_waitcnt lgkmcnt(12)
    v_mfma_f32_16x16x32_bf16 v[84:87], v[124:127], v[204:207], v[84:87]
    ds_read_b128 v[144:147], v232 offset:49152
    ds_read_b64_tr_b16 v[184:185], v222 offset:15360
    ds_read_b64_tr_b16 v[186:187], v222 offset:15520
    s_waitcnt lgkmcnt(12)
    v_mfma_f32_16x16x32_bf16 v[84:87], v[128:131], v[208:211], v[84:87]
    ds_read_b128 v[148:151], v233 offset:49152
    ds_read_b64_tr_b16 v[188:189], v222 offset:16640
    ds_read_b64_tr_b16 v[190:191], v222 offset:16800
    s_waitcnt lgkmcnt(12)
    v_mfma_f32_16x16x32_bf16 v[84:87], v[132:135], v[212:215], v[84:87]
    ds_read_b128 v[152:155], v234 offset:49152
    ds_read_b64_tr_b16 v[192:193], v222 offset:17920
    ds_read_b64_tr_b16 v[194:195], v222 offset:18080
    s_waitcnt lgkmcnt(12)
    v_mfma_f32_16x16x32_bf16 v[84:87], v[136:139], v[176:179], v[84:87]
    ds_read_b128 v[156:159], v235 offset:49152
    ds_read_b64_tr_b16 v[196:197], v222 offset:19200
    ds_read_b64_tr_b16 v[198:199], v222 offset:19360
    s_waitcnt lgkmcnt(12)
    v_mfma_f32_16x16x32_bf16 v[84:87], v[140:143], v[180:183], v[84:87]
    v_add_u32 v232, 65536, v232
    v_add_u32 v233, 65536, v233
    v_add_u32 v234, 65536, v234
    v_add_u32 v235, 65536, v235
    ds_read_b128 v[160:163], v232 offset:0
    ds_read_b64_tr_b16 v[200:201], v222 offset:20480
    ds_read_b64_tr_b16 v[202:203], v222 offset:20640
    s_waitcnt lgkmcnt(12)
    v_mfma_f32_16x16x32_bf16 v[84:87], v[144:147], v[184:187], v[84:87]
    ds_read_b128 v[164:167], v233 offset:0
    ds_read_b64_tr_b16 v[204:205], v222 offset:21760
    ds_read_b64_tr_b16 v[206:207], v222 offset:21920
    s_waitcnt lgkmcnt(12)
    v_mfma_f32_16x16x32_bf16 v[84:87], v[148:151], v[188:191], v[84:87]
    ds_read_b128 v[168:171], v234 offset:0
    ds_read_b64_tr_b16 v[208:209], v222 offset:23040
    ds_read_b64_tr_b16 v[210:211], v222 offset:23200
    s_waitcnt lgkmcnt(12)
    v_mfma_f32_16x16x32_bf16 v[84:87], v[152:155], v[192:195], v[84:87]
    ds_read_b128 v[172:175], v235 offset:0
    ds_read_b64_tr_b16 v[212:213], v222 offset:24320
    ds_read_b64_tr_b16 v[214:215], v222 offset:24480
    s_waitcnt lgkmcnt(12)
    v_mfma_f32_16x16x32_bf16 v[84:87], v[156:159], v[196:199], v[84:87]
    s_waitcnt lgkmcnt(9)
    v_mfma_f32_16x16x32_bf16 v[84:87], v[160:163], v[200:203], v[84:87]
    s_waitcnt lgkmcnt(6)
    v_mfma_f32_16x16x32_bf16 v[84:87], v[164:167], v[204:207], v[84:87]
    s_waitcnt lgkmcnt(3)
    v_mfma_f32_16x16x32_bf16 v[84:87], v[168:171], v[208:211], v[84:87]
    s_waitcnt lgkmcnt(0)
    v_mfma_f32_16x16x32_bf16 v[84:87], v[172:175], v[212:215], v[84:87]
    s_nop 7
    v_cvt_pk_bf16_f32 v84, v84, v85
    v_cvt_pk_bf16_f32 v85, v86, v87
    s_mul_i32 s9, s9, 672
    s_add_u32 s10, s10, s9
    s_add_u32 s10, s10, 1296
    v_and_b32 v7, 1, v3
    v_mul_u32_u24 v7, 336, v7
    v_lshl_add_u32 v7, v2, 4, v7
    v_lshrrev_b32 v8, 1, v3
    v_lshl_add_u32 v7, v8, 3, v7
    s_cmp_eq_u32 s13, 2
    s_cbranch_scc1 LVst_8
    s_add_u32 s10, s10, 64
    s_mov_b32 exec_lo, 0x8000800
    s_mov_b32 exec_hi, 0x8000800
    v_add_u32 v7, 80, v7
    v_mov_b32 v84, 0x3f803f80
    v_mov_b32 v85, 0x3f803f80
    s_mov_b32 exec_lo, 0x8000000
    s_mov_b32 exec_hi, 0x8000000
    v_mov_b32 v84, 0
    v_mov_b32 v85, 0
    s_mov_b32 exec_lo, 0xf800f800
    s_mov_b32 exec_hi, 0xf800f800
LVst_8:
    buffer_store_dwordx2 v[84:85], v7, s[56:59], s10 offen sc1
    s_mov_b64 exec, -1
Lkvskip_4:
    v_mov_b32 v95, v5
Lw_3:
    s_barrier
    s_lshl_b32 s13, s84, 12
    s_add_u32 s13, s13, 14464
    s_lshl_b32 s12, s87, 14
    s_add_u32 s12, s12, s13
    s_add_u32 s87, s87, 1
    s_cmp_eq_u32 s87, 5
    s_cselect_b32 s87, 0, s87
    v_add_u32 v232, s12, v216
    ds_read_b128 v[96:99], v232
    v_add_u32 v233, s12, v217
    ds_read_b128 v[100:103], v233
    v_add_u32 v234, s12, v218
    ds_read_b128 v[104:107], v234
    v_add_u32 v235, s12, v219
    ds_read_b128 v[108:111], v235
    s_lshl_b32 s12, s87, 14
    s_add_u32 s12, s12, s13
    s_add_u32 s87, s87, 1
    s_cmp_eq_u32 s87, 5
    s_cselect_b32 s87, 0, s87
    v_add_u32 v232, s12, v216
    ds_read_b128 v[112:115], v232
    v_add_u32 v233, s12, v217
    ds_read_b128 v[116:119], v233
    v_add_u32 v234, s12, v218
    ds_read_b128 v[120:123], v234
    v_add_u32 v235, s12, v219
    ds_read_b128 v[124:127], v235
    s_lshl_b32 s12, s87, 14
    s_add_u32 s12, s12, s13
    s_add_u32 s87, s87, 1
    s_cmp_eq_u32 s87, 5
    s_cselect_b32 s87, 0, s87
    v_add_u32 v232, s12, v216
    ds_read_b128 v[128:131], v232
    v_add_u32 v233, s12, v217
    ds_read_b128 v[132:135], v233
    v_add_u32 v234, s12, v218
    ds_read_b128 v[136:139], v234
    v_add_u32 v235, s12, v219
    ds_read_b128 v[140:143], v235
    s_lshl_b32 s12, s87, 14
    s_add_u32 s12, s12, s13
    s_add_u32 s87, s87, 1
    s_cmp_eq_u32 s87, 5
    s_cselect_b32 s87, 0, s87
    v_add_u32 v232, s12, v216
    ds_read_b128 v[144:147], v232
    v_add_u32 v233, s12, v217
    ds_read_b128 v[148:151], v233
    v_add_u32 v234, s12, v218
    ds_read_b128 v[152:155], v234
    v_add_u32 v235, s12, v219
    ds_read_b128 v[156:159], v235
    s_lshl_b32 s12, s87, 14
    s_add_u32 s12, s12, s13
    s_add_u32 s87, s87, 1
    s_cmp_eq_u32 s87, 5
    s_cselect_b32 s87, 0, s87
    v_add_u32 v232, s12, v216
    ds_read_b128 v[160:163], v232
    v_add_u32 v233, s12, v217
    ds_read_b128 v[164:167], v233
    v_add_u32 v234, s12, v218
    ds_read_b128 v[168:171], v234
    v_add_u32 v235, s12, v219
    ds_read_b128 v[172:175], v235
    v_add_u32 v221, 122112, v220
    s_waitcnt vmcnt(0)
    v_cmp_eq_u32 vcc, 0, v48
    s_cbranch_vccz Lok_tok_9
    s_mov_b32 s96, 400000
Lre_tok_10:
    s_sleep 2
    buffer_load_dword v48, v4, s[60:63], 0 offen sc1
    s_waitcnt vmcnt(0)
    v_cmp_eq_u32 vcc, 0, v48
    s_sub_u32 s96, s96, 1
    s_cmp_eq_u32 s96, 0
    s_cbranch_scc1 Lok_tok_9
    s_cbranch_vccnz Lre_tok_10
Lok_tok_9:
    v_readfirstlane_b32 s8, v48
    s_cmp_ge_u32 s3, 2
    s_cbranch_scc1 Lw_11
    v_mov_b32 v94, s8
    s_lshl_b32 s97, s4, 3
    s_add_u32 s97, s97, s5
    s_lshl_b32 s97, s97, 1
    s_add_u32 s97, s97, s84
    s_lshl_b32 s97, s97, 3
    s_add_u32 s97, s97, 159744
    s_mov_b64 exec, 0x1
    buffer_store_dwordx2 v[94:95], v4, s[56:59], s97 offen sc1
    s_mov_b64 exec, -1
Lw_11:
    s_waitcnt lgkmcnt(0)
    s_barrier
    ds_read_b64_tr_b16 v[176:177], v221 offset:0
    ds_read_b64_tr_b16 v[178:179], v221 offset:2560
    ds_read_b64_tr_b16 v[180:181], v221 offset:32
    ds_read_b64_tr_b16 v[182:183], v221 offset:2592
    ds_read_b64_tr_b16 v[184:185], v221 offset:64
    ds_read_b64_tr_b16 v[186:187], v221 offset:2624
    ds_read_b64_tr_b16 v[188:189], v221 offset:96
    ds_read_b64_tr_b16 v[190:191], v221 offset:2656
    ds_read_b64_tr_b16 v[192:193], v221 offset:128
    ds_read_b64_tr_b16 v[194:195], v221 offset:2688
    s_waitcnt lgkmcnt(4)
    v_mfma_f32_16x16x32_bf16 v[64:67], v[176:179], v[96:99], 0
    ds_read_b64_tr_b16 v[196:197], v221 offset:5120
    ds_read_b64_tr_b16 v[198:199], v221 offset:7680
    v_mfma_f32_16x16x32_bf16 v[68:71], v[180:183], v[96:99], 0
    ds_read_b64_tr_b16 v[200:201], v221 offset:5152
    ds_read_b64_tr_b16 v[202:203], v221 offset:7712
    v_mfma_f32_16x16x32_bf16 v[72:75], v[184:187], v[96:99], 0
    ds_read_b64_tr_b16 v[204:205], v221 offset:5184
    ds_read_b64_tr_b16 v[206:207], v221 offset:7744
    s_waitcnt lgkmcnt(6)
    v_mfma_f32_16x16x32_bf16 v[76:79], v[188:191], v[96:99], 0
    ds_read_b64_tr_b16 v[208:209], v221 offset:5216
    ds_read_b64_tr_b16 v[210:211], v221 offset:7776
    v_mfma_f32_16x16x32_bf16 v[80:83], v[192:195], v[96:99], 0
    ds_read_b64_tr_b16 v[212:213], v221 offset:5248
    ds_read_b64_tr_b16 v[214:215], v221 offset:7808
    s_waitcnt lgkmcnt(4)
    v_mfma_f32_16x16x32_bf16 v[64:67], v[196:199], v[100:103], v[64:67]
    ds_read_b64_tr_b16 v[176:177], v221 offset:10240
    ds_read_b64_tr_b16 v[178:179], v221 offset:12800
    v_mfma_f32_16x16x32_bf16 v[68:71], v[200:203], v[100:103], v[68:71]
    ds_read_b64_tr_b16 v[180:181], v221 offset:10272
    ds_read_b64_tr_b16 v[182:183], v221 offset:12832
    v_mfma_f32_16x16x32_bf16 v[72:75], v[204:207], v[100:103], v[72:75]
    ds_read_b64_tr_b16 v[184:185], v221 offset:10304
    ds_read_b64_tr_b16 v[186:187], v221 offset:12864
    s_waitcnt lgkmcnt(6)
    v_mfma_f32_16x16x32_bf16 v[76:79], v[208:211], v[100:103], v[76:79]
    ds_read_b64_tr_b16 v[188:189], v221 offset:10336
    ds_read_b64_tr_b16 v[190:191], v221 offset:12896
    v_mfma_f32_16x16x32_bf16 v[80:83], v[212:215], v[100:103], v[80:83]
    ds_read_b64_tr_b16 v[192:193], v221 offset:10368
    ds_read_b64_tr_b16 v[194:195], v221 offset:12928
    s_waitcnt lgkmcnt(4)
    v_mfma_f32_16x16x32_bf16 v[64:67], v[176:179], v[104:107], v[64:67]
    ds_read_b64_tr_b16 v[196:197], v221 offset:15360
    ds_read_b64_tr_b16 v[198:199], v221 offset:17920
    v_mfma_f32_16x16x32_bf16 v[68:71], v[180:183], v[104:107], v[68:71]
    ds_read_b64_tr_b16 v[200:201], v221 offset:15392
    ds_read_b64_tr_b16 v[202:203], v221 offset:17952
    v_mfma_f32_16x16x32_bf16 v[72:75], v[184:187], v[104:107], v[72:75]
    ds_read_b64_tr_b16 v[204:205], v221 offset:15424
    ds_read_b64_tr_b16 v[206:207], v221 offset:17984
    s_waitcnt lgkmcnt(6)
    v_mfma_f32_16x16x32_bf16 v[76:79], v[188:191], v[104:107], v[76:79]
    ds_read_b64_tr_b16 v[208:209], v221 offset:15456
    ds_read_b64_tr_b16 v[210:211], v221 offset:18016
    v_mfma_f32_16x16x32_bf16 v[80:83], v[192:195], v[104:107], v[80:83]
    ds_read_b64_tr_b16 v[212:213], v221 offset:15488
    ds_read_b64_tr_b16 v[214:215], v221 offset:18048
    v_add_u32 v221, 142720, v220
    s_waitcnt lgkmcnt(0)
    s_barrier
    v_mfma_f32_16x16x32_bf16 v[64:67], v[196:199], v[108:111], v[64:67]
    ds_read_b64_tr_b16 v[176:177], v221 offset:0
    ds_read_b64_tr_b16 v[178:179], v221 offset:2560
    v_mfma_f32_16x16x32_bf16 v[68:71], v[200:203], v[108:111], v[68:71]
    ds_read_b64_tr_b16 v[180:181], v221 offset:32
    ds_read_b64_tr_b16 v[182:183], v221 offset:2592
    v_mfma_f32_16x16x32_bf16 v[72:75], v[204:207], v[108:111], v[72:75]
    ds_read_b64_tr_b16 v[184:185], v221 offset:64
    ds_read_b64_tr_b16 v[186:187], v221 offset:2624
    v_mfma_f32_16x16x32_bf16 v[76:79], v[208:211], v[108:111], v[76:79]
    ds_read_b64_tr_b16 v[188:189], v221 offset:96
    ds_read_b64_tr_b16 v[190:191], v221 offset:2656
    v_mfma_f32_16x16x32_bf16 v[80:83], v[212:215], v[108:111], v[80:83]
    ds_read_b64_tr_b16 v[192:193], v221 offset:128
    ds_read_b64_tr_b16 v[194:195], v221 offset:2688
    s_waitcnt lgkmcnt(4)
    v_mfma_f32_16x16x32_bf16 v[64:67], v[176:179], v[112:115], v[64:67]
    ds_read_b64_tr_b16 v[196:197], v221 offset:5120
    ds_read_b64_tr_b16 v[198:199], v221 offset:7680
    v_mfma_f32_16x16x32_bf16 v[68:71], v[180:183], v[112:115], v[68:71]
    ds_read_b64_tr_b16 v[200:201], v221 offset:5152
    ds_read_b64_tr_b16 v[202:203], v221 offset:7712
    v_mfma_f32_16x16x32_bf16 v[72:75], v[184:187], v[112:115], v[72:75]
    ds_read_b64_tr_b16 v[204:205], v221 offset:5184
    ds_read_b64_tr_b16 v[206:207], v221 offset:7744
    s_waitcnt lgkmcnt(6)
    v_mfma_f32_16x16x32_bf16 v[76:79], v[188:191], v[112:115], v[76:79]
    ds_read_b64_tr_b16 v[208:209], v221 offset:5216
    ds_read_b64_tr_b16 v[210:211], v221 offset:7776
    v_mfma_f32_16x16x32_bf16 v[80:83], v[192:195], v[112:115], v[80:83]
    ds_read_b64_tr_b16 v[212:213], v221 offset:5248
    ds_read_b64_tr_b16 v[214:215], v221 offset:7808
    s_waitcnt lgkmcnt(4)
    v_mfma_f32_16x16x32_bf16 v[64:67], v[196:199], v[116:119], v[64:67]
    ds_read_b64_tr_b16 v[176:177], v221 offset:10240
    ds_read_b64_tr_b16 v[178:179], v221 offset:12800
    v_mfma_f32_16x16x32_bf16 v[68:71], v[200:203], v[116:119], v[68:71]
    ds_read_b64_tr_b16 v[180:181], v221 offset:10272
    ds_read_b64_tr_b16 v[182:183], v221 offset:12832
    v_mfma_f32_16x16x32_bf16 v[72:75], v[204:207], v[116:119], v[72:75]
    ds_read_b64_tr_b16 v[184:185], v221 offset:10304
    ds_read_b64_tr_b16 v[186:187], v221 offset:12864
    s_waitcnt lgkmcnt(6)
    v_mfma_f32_16x16x32_bf16 v[76:79], v[208:211], v[116:119], v[76:79]
    ds_read_b64_tr_b16 v[188:189], v221 offset:10336
    ds_read_b64_tr_b16 v[190:191], v221 offset:12896
    v_mfma_f32_16x16x32_bf16 v[80:83], v[212:215], v[116:119], v[80:83]
    ds_read_b64_tr_b16 v[192:193], v221 offset:10368
    ds_read_b64_tr_b16 v[194:195], v221 offset:12928
    s_waitcnt lgkmcnt(4)
    v_mfma_f32_16x16x32_bf16 v[64:67], v[176:179], v[120:123], v[64:67]
    ds_read_b64_tr_b16 v[196:197], v221 offset:15360
    ds_read_b64_tr_b16 v[198:199], v221 offset:17920
    v_mfma_f32_16x16x32_bf16 v[68:71], v[180:183], v[120:123], v[68:71]
    ds_read_b64_tr_b16 v[200:201], v221 offset:15392
    ds_read_b64_tr_b16 v[202:203], v221 offset:17952
    v_mfma_f32_16x16x32_bf16 v[72:75], v[184:187], v[120:123], v[72:75]
    ds_read_b64_tr_b16 v[204:205], v221 offset:15424
    ds_read_b64_tr_b16 v[206:207], v221 offset:17984
    s_waitcnt lgkmcnt(6)
    v_mfma_f32_16x16x32_bf16 v[76:79], v[188:191], v[120:123], v[76:79]
    ds_read_b64_tr_b16 v[208:209], v221 offset:15456
    ds_read_b64_tr_b16 v[210:211], v221 offset:18016
    v_mfma_f32_16x16x32_bf16 v[80:83], v[192:195], v[120:123], v[80:83]
    ds_read_b64_tr_b16 v[212:213], v221 offset:15488
    ds_read_b64_tr_b16 v[214:215], v221 offset:18048
    v_add_u32 v221, 100480, v220
    s_waitcnt lgkmcnt(0)
    s_barrier
    v_mfma_f32_16x16x32_bf16 v[64:67], v[196:199], v[124:127], v[64:67]
    ds_read_b64_tr_b16 v[176:177], v221 offset:0
    ds_read_b64_tr_b16 v[178:179], v221 offset:2560
    v_mfma_f32_16x16x32_bf16 v[68:71], v[200:203], v[124:127], v[68:71]
    ds_read_b64_tr_b16 v[180:181], v221 offset:32
    ds_read_b64_tr_b16 v[182:183], v221 offset:2592
    v_mfma_f32_16x16x32_bf16 v[72:75], v[204:207], v[124:127], v[72:75]
    ds_read_b64_tr_b16 v[184:185], v221 offset:64
    ds_read_b64_tr_b16 v[186:187], v221 offset:2624
    v_mfma_f32_16x16x32_bf16 v[76:79], v[208:211], v[124:127], v[76:79]
    ds_read_b64_tr_b16 v[188:189], v221 offset:96
    ds_read_b64_tr_b16 v[190:191], v221 offset:2656
    v_mfma_f32_16x16x32_bf16 v[80:83], v[212:215], v[124:127], v[80:83]
    ds_read_b64_tr_b16 v[192:193], v221 offset:128
    ds_read_b64_tr_b16 v[194:195], v221 offset:2688
    s_waitcnt lgkmcnt(4)
    v_mfma_f32_16x16x32_bf16 v[64:67], v[176:179], v[128:131], v[64:67]
    ds_read_b64_tr_b16 v[196:197], v221 offset:5120
    ds_read_b64_tr_b16 v[198:199], v221 offset:7680
    v_mfma_f32_16x16x32_bf16 v[68:71], v[180:183], v[128:131], v[68:71]
    ds_read_b64_tr_b16 v[200:201], v221 offset:5152
    ds_read_b64_tr_b16 v[202:203], v221 offset:7712
    v_mfma_f32_16x16x32_bf16 v[72:75], v[184:187], v[128:131], v[72:75]
    ds_read_b64_tr_b16 v[204:205], v221 offset:5184
    ds_read_b64_tr_b16 v[206:207], v221 offset:7744
    s_waitcnt lgkmcnt(6)
    v_mfma_f32_16x16x32_bf16 v[76:79], v[188:191], v[128:131], v[76:79]
    ds_read_b64_tr_b16 v[208:209], v221 offset:5216
    ds_read_b64_tr_b16 v[210:211], v221 offset:7776
    v_mfma_f32_16x16x32_bf16 v[80:83], v[192:195], v[128:131], v[80:83]
    ds_read_b64_tr_b16 v[212:213], v221 offset:5248
    ds_read_b64_tr_b16 v[214:215], v221 offset:7808
    s_waitcnt lgkmcnt(4)
    v_mfma_f32_16x16x32_bf16 v[64:67], v[196:199], v[132:135], v[64:67]
    ds_read_b64_tr_b16 v[176:177], v221 offset:10240
    ds_read_b64_tr_b16 v[178:179], v221 offset:12800
    v_mfma_f32_16x16x32_bf16 v[68:71], v[200:203], v[132:135], v[68:71]
    ds_read_b64_tr_b16 v[180:181], v221 offset:10272
    ds_read_b64_tr_b16 v[182:183], v221 offset:12832
    v_mfma_f32_16x16x32_bf16 v[72:75], v[204:207], v[132:135], v[72:75]
    ds_read_b64_tr_b16 v[184:185], v221 offset:10304
    ds_read_b64_tr_b16 v[186:187], v221 offset:12864
    s_waitcnt lgkmcnt(6)
    v_mfma_f32_16x16x32_bf16 v[76:79], v[208:211], v[132:135], v[76:79]
    ds_read_b64_tr_b16 v[188:189], v221 offset:10336
    ds_read_b64_tr_b16 v[190:191], v221 offset:12896
    v_mfma_f32_16x16x32_bf16 v[80:83], v[212:215], v[132:135], v[80:83]
    ds_read_b64_tr_b16 v[192:193], v221 offset:10368
    ds_read_b64_tr_b16 v[194:195], v221 offset:12928
    s_waitcnt lgkmcnt(4)
    v_mfma_f32_16x16x32_bf16 v[64:67], v[176:179], v[136:139], v[64:67]
    ds_read_b64_tr_b16 v[196:197], v221 offset:15360
    ds_read_b64_tr_b16 v[198:199], v221 offset:17920
    v_mfma_f32_16x16x32_bf16 v[68:71], v[180:183], v[136:139], v[68:71]
    ds_read_b64_tr_b16 v[200:201], v221 offset:15392
    ds_read_b64_tr_b16 v[202:203], v221 offset:17952
    v_mfma_f32_16x16x32_bf16 v[72:75], v[184:187], v[136:139], v[72:75]
    ds_read_b64_tr_b16 v[204:205], v221 offset:15424
    ds_read_b64_tr_b16 v[206:207], v221 offset:17984
    s_waitcnt lgkmcnt(6)
    v_mfma_f32_16x16x32_bf16 v[76:79], v[188:191], v[136:139], v[76:79]
    ds_read_b64_tr_b16 v[208:209], v221 offset:15456
    ds_read_b64_tr_b16 v[210:211], v221 offset:18016
    v_mfma_f32_16x16x32_bf16 v[80:83], v[192:195], v[136:139], v[80:83]
    ds_read_b64_tr_b16 v[212:213], v221 offset:15488
    ds_read_b64_tr_b16 v[214:215], v221 offset:18048
    v_add_u32 v221, 80000, v220
    s_waitcnt lgkmcnt(0)
    s_barrier
    v_mfma_f32_16x16x32_bf16 v[64:67], v[196:199], v[140:143], v[64:67]
    ds_read_b64_tr_b16 v[176:177], v221 offset:0
    ds_read_b64_tr_b16 v[178:179], v221 offset:2560
    v_mfma_f32_16x16x32_bf16 v[68:71], v[200:203], v[140:143], v[68:71]
    ds_read_b64_tr_b16 v[180:181], v221 offset:32
    ds_read_b64_tr_b16 v[182:183], v221 offset:2592
    v_mfma_f32_16x16x32_bf16 v[72:75], v[204:207], v[140:143], v[72:75]
    ds_read_b64_tr_b16 v[184:185], v221 offset:64
    ds_read_b64_tr_b16 v[186:187], v221 offset:2624
    v_mfma_f32_16x16x32_bf16 v[76:79], v[208:211], v[140:143], v[76:79]
    ds_read_b64_tr_b16 v[188:189], v221 offset:96
    ds_read_b64_tr_b16 v[190:191], v221 offset:2656
    v_mfma_f32_16x16x32_bf16 v[80:83], v[212:215], v[140:143], v[80:83]
    ds_read_b64_tr_b16 v[192:193], v221 offset:128
    ds_read_b64_tr_b16 v[194:195], v221 offset:2688
    s_waitcnt lgkmcnt(4)
    v_mfma_f32_16x16x32_bf16 v[64:67], v[176:179], v[144:147], v[64:67]
    ds_read_b64_tr_b16 v[196:197], v221 offset:5120
    ds_read_b64_tr_b16 v[198:199], v221 offset:7680
    v_mfma_f32_16x16x32_bf16 v[68:71], v[180:183], v[144:147], v[68:71]
    ds_read_b64_tr_b16 v[200:201], v221 offset:5152
    ds_read_b64_tr_b16 v[202:203], v221 offset:7712
    v_mfma_f32_16x16x32_bf16 v[72:75], v[184:187], v[144:147], v[72:75]
    ds_read_b64_tr_b16 v[204:205], v221 offset:5184
    ds_read_b64_tr_b16 v[206:207], v221 offset:7744
    s_waitcnt lgkmcnt(6)
    v_mfma_f32_16x16x32_bf16 v[76:79], v[188:191], v[144:147], v[76:79]
    ds_read_b64_tr_b16 v[208:209], v221 offset:5216
    ds_read_b64_tr_b16 v[210:211], v221 offset:7776
    v_mfma_f32_16x16x32_bf16 v[80:83], v[192:195], v[144:147], v[80:83]
    ds_read_b64_tr_b16 v[212:213], v221 offset:5248
    ds_read_b64_tr_b16 v[214:215], v221 offset:7808
    s_waitcnt lgkmcnt(4)
    v_mfma_f32_16x16x32_bf16 v[64:67], v[196:199], v[148:151], v[64:67]
    ds_read_b64_tr_b16 v[176:177], v221 offset:10240
    ds_read_b64_tr_b16 v[178:179], v221 offset:12800
    v_mfma_f32_16x16x32_bf16 v[68:71], v[200:203], v[148:151], v[68:71]
    ds_read_b64_tr_b16 v[180:181], v221 offset:10272
    ds_read_b64_tr_b16 v[182:183], v221 offset:12832
    v_mfma_f32_16x16x32_bf16 v[72:75], v[204:207], v[148:151], v[72:75]
    ds_read_b64_tr_b16 v[184:185], v221 offset:10304
    ds_read_b64_tr_b16 v[186:187], v221 offset:12864
    s_waitcnt lgkmcnt(6)
    v_mfma_f32_16x16x32_bf16 v[76:79], v[208:211], v[148:151], v[76:79]
    ds_read_b64_tr_b16 v[188:189], v221 offset:10336
    ds_read_b64_tr_b16 v[190:191], v221 offset:12896
    v_mfma_f32_16x16x32_bf16 v[80:83], v[212:215], v[148:151], v[80:83]
    ds_read_b64_tr_b16 v[192:193], v221 offset:10368
    ds_read_b64_tr_b16 v[194:195], v221 offset:12928
    s_waitcnt lgkmcnt(4)
    v_mfma_f32_16x16x32_bf16 v[64:67], v[176:179], v[152:155], v[64:67]
    ds_read_b64_tr_b16 v[196:197], v221 offset:15360
    ds_read_b64_tr_b16 v[198:199], v221 offset:17920
    v_mfma_f32_16x16x32_bf16 v[68:71], v[180:183], v[152:155], v[68:71]
    ds_read_b64_tr_b16 v[200:201], v221 offset:15392
    ds_read_b64_tr_b16 v[202:203], v221 offset:17952
    v_mfma_f32_16x16x32_bf16 v[72:75], v[184:187], v[152:155], v[72:75]
    ds_read_b64_tr_b16 v[204:205], v221 offset:15424
    ds_read_b64_tr_b16 v[206:207], v221 offset:17984
    s_waitcnt lgkmcnt(6)
    v_mfma_f32_16x16x32_bf16 v[76:79], v[188:191], v[152:155], v[76:79]
    ds_read_b64_tr_b16 v[208:209], v221 offset:15456
    ds_read_b64_tr_b16 v[210:211], v221 offset:18016
    v_mfma_f32_16x16x32_bf16 v[80:83], v[192:195], v[152:155], v[80:83]
    ds_read_b64_tr_b16 v[212:213], v221 offset:15488
    ds_read_b64_tr_b16 v[214:215], v221 offset:18048
    v_add_u32 v221, 59520, v220
    s_waitcnt lgkmcnt(0)
    s_barrier
    v_mfma_f32_16x16x32_bf16 v[64:67], v[196:199], v[156:159], v[64:67]
    ds_read_b64_tr_b16 v[176:177], v221 offset:0
    ds_read_b64_tr_b16 v[178:179], v221 offset:2560
    v_mfma_f32_16x16x32_bf16 v[68:71], v[200:203], v[156:159], v[68:71]
    ds_read_b64_tr_b16 v[180:181], v221 offset:32
    ds_read_b64_tr_b16 v[182:183], v221 offset:2592
    v_mfma_f32_16x16x32_bf16 v[72:75], v[204:207], v[156:159], v[72:75]
    ds_read_b64_tr_b16 v[184:185], v221 offset:64
    ds_read_b64_tr_b16 v[186:187], v221 offset:2624
    v_mfma_f32_16x16x32_bf16 v[76:79], v[208:211], v[156:159], v[76:79]
    ds_read_b64_tr_b16 v[188:189], v221 offset:96
    ds_read_b64_tr_b16 v[190:191], v221 offset:2656
    v_mfma_f32_16x16x32_bf16 v[80:83], v[212:215], v[156:159], v[80:83]
    ds_read_b64_tr_b16 v[192:193], v221 offset:128
    ds_read_b64_tr_b16 v[194:195], v221 offset:2688
    s_waitcnt lgkmcnt(4)
    v_mfma_f32_16x16x32_bf16 v[64:67], v[176:179], v[160:163], v[64:67]
    ds_read_b64_tr_b16 v[196:197], v221 offset:5120
    ds_read_b64_tr_b16 v[198:199], v221 offset:7680
    v_mfma_f32_16x16x32_bf16 v[68:71], v[180:183], v[160:163], v[68:71]
    ds_read_b64_tr_b16 v[200:201], v221 offset:5152
    ds_read_b64_tr_b16 v[202:203], v221 offset:7712
    v_mfma_f32_16x16x32_bf16 v[72:75], v[184:187], v[160:163], v[72:75]
    ds_read_b64_tr_b16 v[204:205], v221 offset:5184
    ds_read_b64_tr_b16 v[206:207], v221 offset:7744
    s_waitcnt lgkmcnt(6)
    v_mfma_f32_16x16x32_bf16 v[76:79], v[188:191], v[160:163], v[76:79]
    ds_read_b64_tr_b16 v[208:209], v221 offset:5216
    ds_read_b64_tr_b16 v[210:211], v221 offset:7776
    v_mfma_f32_16x16x32_bf16 v[80:83], v[192:195], v[160:163], v[80:83]
    ds_read_b64_tr_b16 v[212:213], v221 offset:5248
    ds_read_b64_tr_b16 v[214:215], v221 offset:7808
    s_waitcnt lgkmcnt(4)
    v_mfma_f32_16x16x32_bf16 v[64:67], v[196:199], v[164:167], v[64:67]
    ds_read_b64_tr_b16 v[176:177], v221 offset:10240
    ds_read_b64_tr_b16 v[178:179], v221 offset:12800
    v_mfma_f32_16x16x32_bf16 v[68:71], v[200:203], v[164:167], v[68:71]
    ds_read_b64_tr_b16 v[180:181], v221 offset:10272
    ds_read_b64_tr_b16 v[182:183], v221 offset:12832
    v_mfma_f32_16x16x32_bf16 v[72:75], v[204:207], v[164:167], v[72:75]
    ds_read_b64_tr_b16 v[184:185], v221 offset:10304
    ds_read_b64_tr_b16 v[186:187], v221 offset:12864
    s_waitcnt lgkmcnt(6)
    v_mfma_f32_16x16x32_bf16 v[76:79], v[208:211], v[164:167], v[76:79]
    ds_read_b64_tr_b16 v[188:189], v221 offset:10336
    ds_read_b64_tr_b16 v[190:191], v221 offset:12896
    v_mfma_f32_16x16x32_bf16 v[80:83], v[212:215], v[164:167], v[80:83]
    ds_read_b64_tr_b16 v[192:193], v221 offset:10368
    ds_read_b64_tr_b16 v[194:195], v221 offset:12928
    s_waitcnt lgkmcnt(4)
    v_mfma_f32_16x16x32_bf16 v[64:67], v[176:179], v[168:171], v[64:67]
    ds_read_b64_tr_b16 v[196:197], v221 offset:15360
    ds_read_b64_tr_b16 v[198:199], v221 offset:17920
    v_mfma_f32_16x16x32_bf16 v[68:71], v[180:183], v[168:171], v[68:71]
    ds_read_b64_tr_b16 v[200:201], v221 offset:15392
    ds_read_b64_tr_b16 v[202:203], v221 offset:17952
    v_mfma_f32_16x16x32_bf16 v[72:75], v[184:187], v[168:171], v[72:75]
    ds_read_b64_tr_b16 v[204:205], v221 offset:15424
    ds_read_b64_tr_b16 v[206:207], v221 offset:17984
    s_waitcnt lgkmcnt(6)
    v_mfma_f32_16x16x32_bf16 v[76:79], v[188:191], v[168:171], v[76:79]
    ds_read_b64_tr_b16 v[208:209], v221 offset:15456
    ds_read_b64_tr_b16 v[210:211], v221 offset:18016
    v_mfma_f32_16x16x32_bf16 v[80:83], v[192:195], v[168:171], v[80:83]
    ds_read_b64_tr_b16 v[212:213], v221 offset:15488
    ds_read_b64_tr_b16 v[214:215], v221 offset:18048
    s_waitcnt lgkmcnt(4)
    v_mfma_f32_16x16x32_bf16 v[64:67], v[196:199], v[172:175], v[64:67]
    v_mfma_f32_16x16x32_bf16 v[68:71], v[200:203], v[172:175], v[68:71]
    v_mfma_f32_16x16x32_bf16 v[72:75], v[204:207], v[172:175], v[72:75]
    s_waitcnt lgkmcnt(0)
    v_mfma_f32_16x16x32_bf16 v[76:79], v[208:211], v[172:175], v[76:79]
    v_mfma_f32_16x16x32_bf16 v[80:83], v[212:215], v[172:175], v[80:83]
    s_nop 2
    v_cvt_pk_bf16_f32 v64, v64, v65
    v_cvt_pk_bf16_f32 v65, v66, v67
    ds_write_b64 v223, v[64:65]
    v_cvt_pk_bf16_f32 v68, v68, v69
    v_cvt_pk_bf16_f32 v69, v70, v71
    ds_write_b64 v224, v[68:69]
    v_cvt_pk_bf16_f32 v72, v72, v73
    v_cvt_pk_bf16_f32 v73, v74, v75
    ds_write_b64 v225, v[72:73]
    v_cvt_pk_bf16_f32 v76, v76, v77
    v_cvt_pk_bf16_f32 v77, v78, v79
    ds_write_b64 v226, v[76:77]
    v_cvt_pk_bf16_f32 v80, v80, v81
    v_cvt_pk_bf16_f32 v81, v82, v83
    ds_write_b64 v227, v[80:81]
    s_waitcnt lgkmcnt(0)
    s_barrier
    s_mov_b32 s55, 1
    s_call_b64 s[46:47], F_issue
    s_lshl_b32 s9, s88, 7
    s_add_u32 s9, s9, s90
    s_add_u32 m0, s91, 14464
    s_nop 0
    buffer_load_dwordx4 v60, s[68:71], s9 offen lds
    s_mul_i32 s10, s88, 245760
    s_add_u32 s10, s10, s15
    s_add_u32 m0, s91, 30848
    s_nop 0
    buffer_load_dwordx4 v62, s[72:75], s10 offen lds
    s_add_u32 m0, s91, 15488
    s_nop 0
    buffer_load_dwordx4 v61, s[68:71], s9 offen lds
    s_add_u32 m0, s91, 31872
    s_nop 0
    buffer_load_dwordx4 v63, s[72:75], s10 offen lds
    s_waitcnt vmcnt(4)
    s_cmp_eq_u32 s93, 0
    s_cbranch_scc1 Lpub_12
    s_call_b64 s[46:47], F_publish
Lpub_12:
    s_add_u32 s9, s9, 20480
    s_add_u32 m0, s91, 16512
    s_nop 0
    buffer_load_dwordx4 v60, s[68:71], s9 offen lds
    s_add_u32 s10, s10, 61440
    s_add_u32 m0, s91, 32896
    s_nop 0
    buffer_load_dwordx4 v62, s[72:75], s10 offen lds
    s_add_u32 m0, s91, 17536
    s_nop 0
    buffer_load_dwordx4 v61, s[68:71], s9 offen lds
    s_add_u32 m0, s91, 33920
    s_nop 0
    buffer_load_dwordx4 v63, s[72:75], s10 offen lds
    s_add_u32 s88, s88, 1
    s_cmp_eq_u32 s88, 10
    s_cselect_b32 s88, 0, s88
    s_lshl_b32 s9, s88, 7
    s_add_u32 s9, s9, s90
    s_add_u32 m0, s91, 47232
    s_nop 0
    buffer_load_dwordx4 v60, s[68:71], s9 offen lds
    s_mul_i32 s10, s88, 245760
    s_add_u32 s10, s10, s15
    s_add_u32 m0, s91, 63616
    s_nop 0
    buffer_load_dwordx4 v62, s[72:75], s10 offen lds
    s_add_u32 m0, s91, 48256
    s_nop 0
    buffer_load_dwordx4 v61, s[68:71], s9 offen lds
    s_add_u32 m0, s91, 64640
    s_nop 0
    buffer_load_dwordx4 v63, s[72:75], s10 offen lds
    s_add_u32 s9, s9, 20480
    s_add_u32 m0, s91, 49280
    s_nop 0
    buffer_load_dwordx4 v60, s[68:71], s9 offen lds
    s_add_u32 s10, s10, 61440
    s_add_u32 m0, s91, 65664
    s_nop 0
    buffer_load_dwordx4 v62, s[72:75], s10 offen lds
    s_add_u32 m0, s91, 50304
    s_nop 0
    buffer_load_dwordx4 v61, s[68:71], s9 offen lds
    s_add_u32 m0, s91, 66688
    s_nop 0
    buffer_load_dwordx4 v63, s[72:75], s10 offen lds
    s_add_u32 s88, s88, 1
    s_cmp_eq_u32 s88, 10
    s_cselect_b32 s88, 0, s88
    s_cmp_ge_u32 s4, 20
    s_cbranch_scc1 Lpk_13
    s_mov_b32 s96, 4000000
Lw8_14:
    ds_read_b32 v252, v4 offset:14380
    s_sub_u32 s96, s96, 1
    s_cmp_eq_u32 s96, 0
    s_waitcnt lgkmcnt(0)
    s_cbranch_scc1 Lw8o_15
    v_cmp_gt_u32 vcc, 4, v252
    s_cbranch_vccz Lw8o_15
    s_sleep 1
    s_branch Lw8_14
Lw8o_15:
    s_mul_i32 s97, s5, 160
    s_lshl_b32 s98, s84, 10
    s_add_u32 m0, s98, 0
    s_nop 0
    buffer_load_dwordx4 v16, s[76:79], s97 offen lds
    s_add_u32 m0, s98, 5120
    s_nop 0
    buffer_load_dwordx4 v18, s[80:83], s97 offen lds
    s_cmp_lg_u32 s3, 0
    s_cbranch_scc1 Lw_16
    s_add_u32 m0, s98, 4096
    s_nop 0
    buffer_load_dwordx4 v17, s[76:79], s97 offen lds
    s_add_u32 m0, s98, 9216
    s_nop 0
    buffer_load_dwordx4 v19, s[80:83], s97 offen lds
Lw_16:
Lpk_13:
    s_setprio 3
    s_waitcnt vmcnt(8) lgkmcnt(0)
    s_mov_b64 exec, 0x1
    ds_add_u32 v4, v53 offset:14344
    s_mov_b64 exec, -1
    s_cmp_eq_u32 s93, 0
    s_cbranch_scc1 Lpub_17
    s_call_b64 s[46:47], F_publish
Lpub_17:
    ds_read_b64 v[252:253], v4 offset:14344
    s_setprio 3
    s_mov_b32 s97, 4
    s_waitcnt lgkmcnt(0)
    v_cmp_gt_u32 vcc, s97, v252
    s_cbranch_vccz Lsbo_19
    s_call_b64 s[46:47], F_swspin
Lsbo_19:
    v_cmp_gt_u32 vcc, s48, v253
    s_cbranch_vccnz Lti_20
    s_call_b64 s[46:47], F_issue
Lti_20:
    ds_read_b128 v[172:175], v56 offset:0
    ds_read_b128 v[176:179], v56 offset:2048
    ds_read_b64_tr_b16 v[96:97], v32 offset:0
    ds_read_b64_tr_b16 v[98:99], v32 offset:4096
    ds_read_b64_tr_b16 v[100:101], v33 offset:0
    ds_read_b64_tr_b16 v[102:103], v33 offset:4096
    ds_read_b64_tr_b16 v[104:105], v34 offset:0
    ds_read_b64_tr_b16 v[106:107], v34 offset:4096
    ds_read_b64_tr_b16 v[108:109], v35 offset:0
    ds_read_b64_tr_b16 v[110:111], v35 offset:4096
    ds_read_b64_tr_b16 v[112:113], v36 offset:0
    ds_read_b64_tr_b16 v[114:115], v36 offset:4096
    ds_read_b64_tr_b16 v[116:117], v37 offset:0
    ds_read_b64_tr_b16 v[118:119], v37 offset:4096
    ds_read_b64_tr_b16 v[120:121], v38 offset:0
    ds_read_b64_tr_b16 v[122:123], v38 offset:4096
    ds_read_b64_tr_b16 v[124:125], v39 offset:0
    ds_read_b64_tr_b16 v[126:127], v39 offset:4096
    s_lshl_b32 s9, s88, 7
    s_add_u32 s9, s9, s90
    s_add_u32 m0, s91, 80000
    s_nop 0
    buffer_load_dwordx4 v60, s[68:71], s9 offen lds
    s_mul_i32 s10, s88, 245760
    s_add_u32 s10, s10, s15
    s_add_u32 m0, s91, 96384
    s_nop 0
    buffer_load_dwordx4 v62, s[72:75], s10 offen lds
    s_add_u32 m0, s91, 81024
    s_nop 0
    buffer_load_dwordx4 v61, s[68:71], s9 offen lds
    s_setprio 0
    s_waitcnt lgkmcnt(12)
    v_mfma_f32_16x16x32_bf16 v[188:191], v[172:175], v[96:99], 0
    ds_read_b128 v[180:183], v57 offset:0
    ds_read_b128 v[184:187], v57 offset:2048
    v_mfma_f32_16x16x32_bf16 v[220:223], v[176:179], v[96:99], 0
    ds_read_b64_tr_b16 v[128:129], v32 offset:8192
    ds_read_b64_tr_b16 v[130:131], v32 offset:12288
    v_mfma_f32_16x16x32_bf16 v[192:195], v[172:175], v[100:103], 0
    ds_read_b64_tr_b16 v[132:133], v33 offset:8192
    ds_read_b64_tr_b16 v[134:135], v33 offset:12288
    s_add_u32 m0, s91, 97408
    s_nop 0
    buffer_load_dwordx4 v63, s[72:75], s10 offen lds
    v_mfma_f32_16x16x32_bf16 v[224:227], v[176:179], v[100:103], 0
    ds_read_b64_tr_b16 v[136:137], v34 offset:8192
    ds_read_b64_tr_b16 v[138:139], v34 offset:12288
    s_waitcnt lgkmcnt(15)
    v_mfma_f32_16x16x32_bf16 v[196:199], v[172:175], v[104:107], 0
    ds_read_b64_tr_b16 v[140:141], v35 offset:8192
    ds_read_b64_tr_b16 v[142:143], v35 offset:12288
    v_mfma_f32_16x16x32_bf16 v[228:231], v[176:179], v[104:107], 0
    ds_read_b64_tr_b16 v[144:145], v36 offset:8192
    ds_read_b64_tr_b16 v[146:147], v36 offset:12288
    s_add_u32 s9, s9, 20480
    s_add_u32 m0, s91, 82048
    s_nop 0
    buffer_load_dwordx4 v60, s[68:71], s9 offen lds
    v_mfma_f32_16x16x32_bf16 v[200:203], v[172:175], v[108:111], 0
    ds_read_b64_tr_b16 v[148:149], v37 offset:8192
    v_mfma_f32_16x16x32_bf16 v[232:235], v[176:179], v[108:111], 0
    ds_read_b64_tr_b16 v[150:151], v37 offset:12288
    s_waitcnt lgkmcnt(15)
    v_mfma_f32_16x16x32_bf16 v[204:207], v[172:175], v[112:115], 0
    ds_read_b64_tr_b16 v[152:153], v38 offset:8192
    s_add_u32 s10, s10, 61440
    s_add_u32 m0, s91, 98432
    s_nop 0
    buffer_load_dwordx4 v62, s[72:75], s10 offen lds
    v_mfma_f32_16x16x32_bf16 v[236:239], v[176:179], v[112:115], 0
    ds_read_b64_tr_b16 v[154:155], v38 offset:12288
    v_mfma_f32_16x16x32_bf16 v[208:211], v[116:119], v[172:175], 0
    ds_read_b64_tr_b16 v[156:157], v39 offset:8192
    v_mfma_f32_16x16x32_bf16 v[240:243], v[116:119], v[176:179], 0
    ds_read_b64_tr_b16 v[158:159], v39 offset:12288
    s_add_u32 m0, s91, 83072
    s_nop 0
    buffer_load_dwordx4 v61, s[68:71], s9 offen lds
    s_waitcnt lgkmcnt(15)
    v_mfma_f32_16x16x32_bf16 v[212:215], v[120:123], v[172:175], 0
    v_mfma_f32_16x16x32_bf16 v[244:247], v[120:123], v[176:179], 0
    v_mfma_f32_16x16x32_bf16 v[216:219], v[124:127], v[172:175], 0
    s_add_u32 m0, s91, 99456
    s_nop 0
    buffer_load_dwordx4 v63, s[72:75], s10 offen lds
    s_add_u32 s88, s88, 1
    s_cmp_eq_u32 s88, 10
    s_cselect_b32 s88, 0, s88
    v_mfma_f32_16x16x32_bf16 v[248:251], v[124:127], v[176:179], 0
    s_waitcnt vmcnt(8) lgkmcnt(0)
    s_mov_b64 exec, 0x1
    ds_add_u32 v4, v53 offset:14344
    s_mov_b64 exec, -1
    s_cmp_eq_u32 s93, 0
    s_cbranch_scc1 Lpub_21
    s_call_b64 s[46:47], F_publish
Lpub_21:
    s_setprio 0
    v_mfma_f32_16x16x32_bf16 v[188:191], v[180:183], v[128:131], v[188:191]
    v_mfma_f32_16x16x32_bf16 v[220:223], v[184:187], v[128:131], v[220:223]
    v_mfma_f32_16x16x32_bf16 v[192:195], v[180:183], v[132:135], v[192:195]
    v_mfma_f32_16x16x32_bf16 v[224:227], v[184:187], v[132:135], v[224:227]
    v_mfma_f32_16x16x32_bf16 v[196:199], v[180:183], v[136:139], v[196:199]
    v_mfma_f32_16x16x32_bf16 v[228:231], v[184:187], v[136:139], v[228:231]
    ds_read_b64 v[252:253], v4 offset:14344
    v_mfma_f32_16x16x32_bf16 v[200:203], v[180:183], v[140:143], v[200:203]
    v_mfma_f32_16x16x32_bf16 v[232:235], v[184:187], v[140:143], v[232:235]
    s_setprio 3
    s_mov_b32 s97, 8
    s_waitcnt lgkmcnt(0)
    v_cmp_gt_u32 vcc, s97, v252
    s_cbranch_vccz Lsbo_23
    s_call_b64 s[46:47], F_swspin
Lsbo_23:
    v_cmp_gt_u32 vcc, s48, v253
    s_cbranch_vccnz Lti_24
    s_call_b64 s[46:47], F_issue
Lti_24:
    s_setprio 0
    v_mfma_f32_16x16x32_bf16 v[204:207], v[180:183], v[144:147], v[204:207]
    ds_read_b128 v[172:175], v56 offset:32768
    ds_read_b128 v[176:179], v56 offset:34816
    ds_read_b64_tr_b16 v[96:97], v32 offset:32768
    v_mfma_f32_16x16x32_bf16 v[236:239], v[184:187], v[144:147], v[236:239]
    ds_read_b64_tr_b16 v[98:99], v32 offset:36864
    ds_read_b64_tr_b16 v[100:101], v33 offset:32768
    ds_read_b64_tr_b16 v[102:103], v33 offset:36864
    s_lshl_b32 s9, s88, 7
    s_add_u32 s9, s9, s90
    s_add_u32 m0, s91, 14464
    s_nop 0
    buffer_load_dwordx4 v60, s[68:71], s9 offen lds
    v_mfma_f32_16x16x32_bf16 v[208:211], v[148:151], v[180:183], v[208:211]
    ds_read_b64_tr_b16 v[104:105], v34 offset:32768
    ds_read_b64_tr_b16 v[106:107], v34 offset:36864
    v_mfma_f32_16x16x32_bf16 v[240:243], v[148:151], v[184:187], v[240:243]
    ds_read_b64_tr_b16 v[108:109], v35 offset:32768
    ds_read_b64_tr_b16 v[110:111], v35 offset:36864
    v_mfma_f32_16x16x32_bf16 v[212:215], v[152:155], v[180:183], v[212:215]
    ds_read_b64_tr_b16 v[112:113], v36 offset:32768
    ds_read_b64_tr_b16 v[114:115], v36 offset:36864
    s_mul_i32 s10, s88, 245760
    s_add_u32 s10, s10, s15
    s_add_u32 m0, s91, 30848
    s_nop 0
    buffer_load_dwordx4 v62, s[72:75], s10 offen lds
    v_mfma_f32_16x16x32_bf16 v[244:247], v[152:155], v[184:187], v[244:247]
    ds_read_b64_tr_b16 v[116:117], v37 offset:32768
    ds_read_b64_tr_b16 v[118:119], v37 offset:36864
    v_mfma_f32_16x16x32_bf16 v[216:219], v[156:159], v[180:183], v[216:219]
    ds_read_b64_tr_b16 v[120:121], v38 offset:32768
    ds_read_b64_tr_b16 v[122:123], v38 offset:36864
    v_mfma_f32_16x16x32_bf16 v[248:251], v[156:159], v[184:187], v[248:251]
    ds_read_b64_tr_b16 v[124:125], v39 offset:32768
    ds_read_b64_tr_b16 v[126:127], v39 offset:36864
    s_add_u32 m0, s91, 15488
    s_nop 0
    buffer_load_dwordx4 v61, s[68:71], s9 offen lds
    s_setprio 0
    s_waitcnt lgkmcnt(12)
    v_mfma_f32_16x16x32_bf16 v[188:191], v[172:175], v[96:99], v[188:191]
    ds_read_b128 v[180:183], v57 offset:32768
    ds_read_b128 v[184:187], v57 offset:34816
    v_mfma_f32_16x16x32_bf16 v[220:223], v[176:179], v[96:99], v[220:223]
    ds_read_b64_tr_b16 v[128:129], v32 offset:40960
    ds_read_b64_tr_b16 v[130:131], v32 offset:45056
    v_mfma_f32_16x16x32_bf16 v[192:195], v[172:175], v[100:103], v[192:195]
    ds_read_b64_tr_b16 v[132:133], v33 offset:40960
    ds_read_b64_tr_b16 v[134:135], v33 offset:45056
    s_add_u32 m0, s91, 31872
    s_nop 0
    buffer_load_dwordx4 v63, s[72:75], s10 offen lds
    v_mfma_f32_16x16x32_bf16 v[224:227], v[176:179], v[100:103], v[224:227]
    ds_read_b64_tr_b16 v[136:137], v34 offset:40960
    ds_read_b64_tr_b16 v[138:139], v34 offset:45056
    s_waitcnt lgkmcnt(15)
    v_mfma_f32_16x16x32_bf16 v[196:199], v[172:175], v[104:107], v[196:199]
    ds_read_b64_tr_b16 v[140:141], v35 offset:40960
    ds_read_b64_tr_b16 v[142:143], v35 offset:45056
    v_mfma_f32_16x16x32_bf16 v[228:231], v[176:179], v[104:107], v[228:231]
    ds_read_b64_tr_b16 v[144:145], v36 offset:40960
    ds_read_b64_tr_b16 v[146:147], v36 offset:45056
    s_add_u32 s9, s9, 20480
    s_add_u32 m0, s91, 16512
    s_nop 0
    buffer_load_dwordx4 v60, s[68:71], s9 offen lds
    v_mfma_f32_16x16x32_bf16 v[200:203], v[172:175], v[108:111], v[200:203]
    ds_read_b64_tr_b16 v[148:149], v37 offset:40960
    v_mfma_f32_16x16x32_bf16 v[232:235], v[176:179], v[108:111], v[232:235]
    ds_read_b64_tr_b16 v[150:151], v37 offset:45056
    s_waitcnt lgkmcnt(15)
    v_mfma_f32_16x16x32_bf16 v[204:207], v[172:175], v[112:115], v[204:207]
    ds_read_b64_tr_b16 v[152:153], v38 offset:40960
    s_add_u32 s10, s10, 61440
    s_add_u32 m0, s91, 32896
    s_nop 0
    buffer_load_dwordx4 v62, s[72:75], s10 offen lds
    v_mfma_f32_16x16x32_bf16 v[236:239], v[176:179], v[112:115], v[236:239]
    ds_read_b64_tr_b16 v[154:155], v38 offset:45056
    v_mfma_f32_16x16x32_bf16 v[208:211], v[116:119], v[172:175], v[208:211]
    ds_read_b64_tr_b16 v[156:157], v39 offset:40960
    v_mfma_f32_16x16x32_bf16 v[240:243], v[116:119], v[176:179], v[240:243]
    ds_read_b64_tr_b16 v[158:159], v39 offset:45056
    s_add_u32 m0, s91, 17536
    s_nop 0
    buffer_load_dwordx4 v61, s[68:71], s9 offen lds
    s_waitcnt lgkmcnt(15)
    v_mfma_f32_16x16x32_bf16 v[212:215], v[120:123], v[172:175], v[212:215]
    v_mfma_f32_16x16x32_bf16 v[244:247], v[120:123], v[176:179], v[244:247]
    v_mfma_f32_16x16x32_bf16 v[216:219], v[124:127], v[172:175], v[216:219]
    s_add_u32 m0, s91, 33920
    s_nop 0
    buffer_load_dwordx4 v63, s[72:75], s10 offen lds
    s_add_u32 s88, s88, 1
    s_cmp_eq_u32 s88, 10
    s_cselect_b32 s88, 0, s88
    v_mfma_f32_16x16x32_bf16 v[248:251], v[124:127], v[176:179], v[248:251]
    s_waitcnt vmcnt(8) lgkmcnt(0)
    s_mov_b64 exec, 0x1
    ds_add_u32 v4, v53 offset:14344
    s_mov_b64 exec, -1
    s_cmp_eq_u32 s93, 0
    s_cbranch_scc1 Lpub_25
    s_call_b64 s[46:47], F_publish
Lpub_25:
    s_setprio 0
    v_mfma_f32_16x16x32_bf16 v[188:191], v[180:183], v[128:131], v[188:191]
    v_mfma_f32_16x16x32_bf16 v[220:223], v[184:187], v[128:131], v[220:223]
    v_mfma_f32_16x16x32_bf16 v[192:195], v[180:183], v[132:135], v[192:195]
    v_mfma_f32_16x16x32_bf16 v[224:227], v[184:187], v[132:135], v[224:227]
    v_mfma_f32_16x16x32_bf16 v[196:199], v[180:183], v[136:139], v[196:199]
    v_mfma_f32_16x16x32_bf16 v[228:231], v[184:187], v[136:139], v[228:231]
    ds_read_b64 v[252:253], v4 offset:14344
    v_mfma_f32_16x16x32_bf16 v[200:203], v[180:183], v[140:143], v[200:203]
    v_mfma_f32_16x16x32_bf16 v[232:235], v[184:187], v[140:143], v[232:235]
    s_setprio 3
    s_mov_b32 s97, 12
    s_waitcnt lgkmcnt(0)
    v_cmp_gt_u32 vcc, s97, v252
    s_cbranch_vccz Lsbo_27
    s_call_b64 s[46:47], F_swspin
Lsbo_27:
    v_cmp_gt_u32 vcc, s48, v253
    s_cbranch_vccnz Lti_28
    s_call_b64 s[46:47], F_issue
Lti_28:
    s_cmp_ge_u32 s4, 20
    s_cbranch_scc1 Lpk_29
    v_lshrrev_b32 v5, 2, v2
    v_lshl_add_u32 v5, v3, 3, v5
    v_mul_u32_u24 v5, 160, v5
    v_and_b32 v6, 3, v1
    v_lshl_add_u32 v5, v6, 3, v5
    s_lshl_b32 s98, s84, 5
    v_add_u32 v5, s98, v5
    s_mul_i32 s97, s5, 102400
    s_mul_i32 s98, s4, 5120
    s_add_u32 s97, s97, s98
    s_lshl_b32 s98, s84, 10
    s_add_u32 s97, s97, s98
    ds_read_b64_tr_b16 v[20:21], v5 offset:0
    ds_read_b64_tr_b16 v[22:23], v5 offset:640
    ds_read_b64_tr_b16 v[24:25], v5 offset:5120
    ds_read_b64_tr_b16 v[26:27], v5 offset:5760
    s_add_u32 s98, s97, 12582912
    s_add_u32 s99, s97, 13402112
    s_waitcnt lgkmcnt(0)
    buffer_store_dwordx4 v[20:23], v15, s[56:59], s98 offen sc1
    buffer_store_dwordx4 v[24:27], v15, s[56:59], s99 offen sc1
    s_cmp_lg_u32 s3, 0
    s_cbranch_scc1 Lw_30
    ds_read_b64_tr_b16 v[20:21], v5 offset:128
    ds_read_b64_tr_b16 v[22:23], v5 offset:768
    ds_read_b64_tr_b16 v[24:25], v5 offset:5248
    ds_read_b64_tr_b16 v[26:27], v5 offset:5888
    s_add_u32 s98, s97, 12587008
    s_add_u32 s99, s97, 13406208
    s_waitcnt lgkmcnt(0)
    buffer_store_dwordx4 v[20:23], v15, s[56:59], s98 offen sc1
    buffer_store_dwordx4 v[24:27], v15, s[56:59], s99 offen sc1
Lw_30:
Lpk_29:
    v_mov_b32 v168, -1
    v_mov_b32 v169, -1
    v_mov_b32 v170, -1
    v_mov_b32 v171, -1
    buffer_store_dwordx4 v[168:171], v55, s[56:59], s52 offen sc1
    buffer_store_dwordx4 v[168:171], v55, s[56:59], s51 offen sc1
    s_mov_b32 exec_lo, 0xffffffff
    s_mov_b32 exec_hi, 0x0
    buffer_store_dwordx4 v[168:171], v55, s[56:59], s53 offen sc1
    s_mov_b64 exec, -1
    v_min_u32 v52, 214, v0
    v_lshlrev_b32 v52, 4, v52
    s_lshl_b32 s97, s7, 4
    s_add_u32 s97, s97, s6
    s_mul_i32 s97, s97, 3456
    s_add_u32 s97, s97, 262144
    buffer_store_dwordx4 v[168:171], v52, s[56:59], s97 offen sc1
    buffer_store_dwordx4 v[168:171], v49, s[56:59], s44 offen sc1
    s_mov_b64 exec, 0xffff
    buffer_store_dwordx4 v[168:171], v15, s[56:59], s45 offen sc1
    s_mov_b64 exec, -1
    buffer_store_dwordx4 v[168:171], v49, s[56:59], s44 offen offset:1024 sc1
    s_mov_b64 exec, 0xffff
    buffer_store_dwordx4 v[168:171], v15, s[56:59], s45 offen offset:1024 sc1
    s_mov_b64 exec, -1
    s_setprio 0
    v_mfma_f32_16x16x32_bf16 v[204:207], v[180:183], v[144:147], v[204:207]
    ds_read_b128 v[172:175], v58 offset:0
    ds_read_b128 v[176:179], v58 offset:2048
    ds_read_b64_tr_b16 v[96:97], v40 offset:0
    v_mfma_f32_16x16x32_bf16 v[236:239], v[184:187], v[144:147], v[236:239]
    ds_read_b64_tr_b16 v[98:99], v40 offset:4096
    ds_read_b64_tr_b16 v[100:101], v41 offset:0
    ds_read_b64_tr_b16 v[102:103], v41 offset:4096
    s_lshl_b32 s9, s88, 7
    s_add_u32 s9, s9, s90
    s_add_u32 m0, s91, 47232
    s_nop 0
    buffer_load_dwordx4 v60, s[68:71], s9 offen lds
    v_mfma_f32_16x16x32_bf16 v[208:211], v[148:151], v[180:183], v[208:211]
    ds_read_b64_tr_b16 v[104:105], v42 offset:0
    ds_read_b64_tr_b16 v[106:107], v42 offset:4096
    v_mfma_f32_16x16x32_bf16 v[240:243], v[148:151], v[184:187], v[240:243]
    ds_read_b64_tr_b16 v[108:109], v43 offset:0
    ds_read_b64_tr_b16 v[110:111], v43 offset:4096
    v_mfma_f32_16x16x32_bf16 v[212:215], v[152:155], v[180:183], v[212:215]
    ds_read_b64_tr_b16 v[112:113], v44 offset:0
    ds_read_b64_tr_b16 v[114:115], v44 offset:4096
    s_mul_i32 s10, s88, 245760
    s_add_u32 s10, s10, s15
    s_add_u32 m0, s91, 63616
    s_nop 0
    buffer_load_dwordx4 v62, s[72:75], s10 offen lds
    v_mfma_f32_16x16x32_bf16 v[244:247], v[152:155], v[184:187], v[244:247]
    ds_read_b64_tr_b16 v[116:117], v45 offset:0
    ds_read_b64_tr_b16 v[118:119], v45 offset:4096
    v_mfma_f32_16x16x32_bf16 v[216:219], v[156:159], v[180:183], v[216:219]
    ds_read_b64_tr_b16 v[120:121], v46 offset:0
    ds_read_b64_tr_b16 v[122:123], v46 offset:4096
    v_mfma_f32_16x16x32_bf16 v[248:251], v[156:159], v[184:187], v[248:251]
    ds_read_b64_tr_b16 v[124:125], v47 offset:0
    ds_read_b64_tr_b16 v[126:127], v47 offset:4096
    s_add_u32 m0, s91, 48256
    s_nop 0
    buffer_load_dwordx4 v61, s[68:71], s9 offen lds
    s_setprio 0
    s_waitcnt lgkmcnt(12)
    v_mfma_f32_16x16x32_bf16 v[188:191], v[172:175], v[96:99], v[188:191]
    ds_read_b128 v[180:183], v59 offset:0
    ds_read_b128 v[184:187], v59 offset:2048
    v_mfma_f32_16x16x32_bf16 v[220:223], v[176:179], v[96:99], v[220:223]
    ds_read_b64_tr_b16 v[128:129], v40 offset:8192
    ds_read_b64_tr_b16 v[130:131], v40 offset:12288
    v_mfma_f32_16x16x32_bf16 v[192:195], v[172:175], v[100:103], v[192:195]
    ds_read_b64_tr_b16 v[132:133], v41 offset:8192
    ds_read_b64_tr_b16 v[134:135], v41 offset:12288
    s_add_u32 m0, s91, 64640
    s_nop 0
    buffer_load_dwordx4 v63, s[72:75], s10 offen lds
    v_mfma_f32_16x16x32_bf16 v[224:227], v[176:179], v[100:103], v[224:227]
    ds_read_b64_tr_b16 v[136:137], v42 offset:8192
    ds_read_b64_tr_b16 v[138:139], v42 offset:12288
    s_waitcnt lgkmcnt(15)
    v_mfma_f32_16x16x32_bf16 v[196:199], v[172:175], v[104:107], v[196:199]
    ds_read_b64_tr_b16 v[140:141], v43 offset:8192
    ds_read_b64_tr_b16 v[142:143], v43 offset:12288
    v_mfma_f32_16x16x32_bf16 v[228:231], v[176:179], v[104:107], v[228:231]
    ds_read_b64_tr_b16 v[144:145], v44 offset:8192
    ds_read_b64_tr_b16 v[146:147], v44 offset:12288
    s_add_u32 s9, s9, 20480
    s_add_u32 m0, s91, 49280
    s_nop 0
    buffer_load_dwordx4 v60, s[68:71], s9 offen lds
    v_mfma_f32_16x16x32_bf16 v[200:203], v[172:175], v[108:111], v[200:203]
    ds_read_b64_tr_b16 v[148:149], v45 offset:8192
    v_mfma_f32_16x16x32_bf16 v[232:235], v[176:179], v[108:111], v[232:235]
    ds_read_b64_tr_b16 v[150:151], v45 offset:12288
    s_waitcnt lgkmcnt(15)
    v_mfma_f32_16x16x32_bf16 v[204:207], v[172:175], v[112:115], v[204:207]
    ds_read_b64_tr_b16 v[152:153], v46 offset:8192
    s_add_u32 s10, s10, 61440
    s_add_u32 m0, s91, 65664
    s_nop 0
    buffer_load_dwordx4 v62, s[72:75], s10 offen lds
    v_mfma_f32_16x16x32_bf16 v[236:239], v[176:179], v[112:115], v[236:239]
    ds_read_b64_tr_b16 v[154:155], v46 offset:12288
    v_mfma_f32_16x16x32_bf16 v[208:211], v[116:119], v[172:175], v[208:211]
    ds_read_b64_tr_b16 v[156:157], v47 offset:8192
    v_mfma_f32_16x16x32_bf16 v[240:243], v[116:119], v[176:179], v[240:243]
    ds_read_b64_tr_b16 v[158:159], v47 offset:12288
    s_add_u32 m0, s91, 50304
    s_nop 0
    buffer_load_dwordx4 v61, s[68:71], s9 offen lds
    s_waitcnt lgkmcnt(15)
    v_mfma_f32_16x16x32_bf16 v[212:215], v[120:123], v[172:175], v[212:215]
    v_mfma_f32_16x16x32_bf16 v[244:247], v[120:123], v[176:179], v[244:247]
    v_mfma_f32_16x16x32_bf16 v[216:219], v[124:127], v[172:175], v[216:219]
    s_add_u32 m0, s91, 66688
    s_nop 0
    buffer_load_dwordx4 v63, s[72:75], s10 offen lds
    s_add_u32 s88, s88, 1
    s_cmp_eq_u32 s88, 10
    s_cselect_b32 s88, 0, s88
    v_mfma_f32_16x16x32_bf16 v[248:251], v[124:127], v[176:179], v[248:251]
    s_waitcnt vmcnt(16) lgkmcnt(0)
    s_mov_b64 exec, 0x1
    ds_add_u32 v4, v53 offset:14344
    s_mov_b64 exec, -1
    s_cmp_eq_u32 s93, 0
    s_cbranch_scc1 Lpub_31
    s_call_b64 s[46:47], F_publish
Lpub_31:
    s_setprio 0
    v_mfma_f32_16x16x32_bf16 v[188:191], v[180:183], v[128:131], v[188:191]
    v_mfma_f32_16x16x32_bf16 v[220:223], v[184:187], v[128:131], v[220:223]
    v_mfma_f32_16x16x32_bf16 v[192:195], v[180:183], v[132:135], v[192:195]
    v_mfma_f32_16x16x32_bf16 v[224:227], v[184:187], v[132:135], v[224:227]
    v_mfma_f32_16x16x32_bf16 v[196:199], v[180:183], v[136:139], v[196:199]
    v_mfma_f32_16x16x32_bf16 v[228:231], v[184:187], v[136:139], v[228:231]
    ds_read_b64 v[252:253], v4 offset:14344
    v_mfma_f32_16x16x32_bf16 v[200:203], v[180:183], v[140:143], v[200:203]
    v_mfma_f32_16x16x32_bf16 v[232:235], v[184:187], v[140:143], v[232:235]
    s_setprio 3
    s_mov_b32 s97, 16
    s_waitcnt lgkmcnt(0)
    v_cmp_gt_u32 vcc, s97, v252
    s_cbranch_vccz Lsbo_33
    s_call_b64 s[46:47], F_swspin
Lsbo_33:
    v_cmp_gt_u32 vcc, s48, v253
    s_cbranch_vccnz Lti_34
    s_call_b64 s[46:47], F_issue
Lti_34:
    s_setprio 0
    v_mfma_f32_16x16x32_bf16 v[204:207], v[180:183], v[144:147], v[204:207]
    ds_read_b128 v[172:175], v56 offset:0
    ds_read_b128 v[176:179], v56 offset:2048
    ds_read_b64_tr_b16 v[96:97], v32 offset:0
    v_mfma_f32_16x16x32_bf16 v[236:239], v[184:187], v[144:147], v[236:239]
    ds_read_b64_tr_b16 v[98:99], v32 offset:4096
    ds_read_b64_tr_b16 v[100:101], v33 offset:0
    ds_read_b64_tr_b16 v[102:103], v33 offset:4096
    s_lshl_b32 s9, s88, 7
    s_add_u32 s9, s9, s90
    s_add_u32 m0, s91, 80000
    s_nop 0
    buffer_load_dwordx4 v60, s[68:71], s9 offen lds
    v_mfma_f32_16x16x32_bf16 v[208:211], v[148:151], v[180:183], v[208:211]
    ds_read_b64_tr_b16 v[104:105], v34 offset:0
    ds_read_b64_tr_b16 v[106:107], v34 offset:4096
    v_mfma_f32_16x16x32_bf16 v[240:243], v[148:151], v[184:187], v[240:243]
    ds_read_b64_tr_b16 v[108:109], v35 offset:0
    ds_read_b64_tr_b16 v[110:111], v35 offset:4096
    v_mfma_f32_16x16x32_bf16 v[212:215], v[152:155], v[180:183], v[212:215]
    ds_read_b64_tr_b16 v[112:113], v36 offset:0
    ds_read_b64_tr_b16 v[114:115], v36 offset:4096
    s_mul_i32 s10, s88, 245760
    s_add_u32 s10, s10, s15
    s_add_u32 m0, s91, 96384
    s_nop 0
    buffer_load_dwordx4 v62, s[72:75], s10 offen lds
    v_mfma_f32_16x16x32_bf16 v[244:247], v[152:155], v[184:187], v[244:247]
    ds_read_b64_tr_b16 v[116:117], v37 offset:0
    ds_read_b64_tr_b16 v[118:119], v37 offset:4096
    v_mfma_f32_16x16x32_bf16 v[216:219], v[156:159], v[180:183], v[216:219]
    ds_read_b64_tr_b16 v[120:121], v38 offset:0
    ds_read_b64_tr_b16 v[122:123], v38 offset:4096
    v_mfma_f32_16x16x32_bf16 v[248:251], v[156:159], v[184:187], v[248:251]
    ds_read_b64_tr_b16 v[124:125], v39 offset:0
    ds_read_b64_tr_b16 v[126:127], v39 offset:4096
    s_add_u32 m0, s91, 81024
    s_nop 0
    buffer_load_dwordx4 v61, s[68:71], s9 offen lds
    s_setprio 0
    s_waitcnt lgkmcnt(12)
    v_mfma_f32_16x16x32_bf16 v[188:191], v[172:175], v[96:99], v[188:191]
    ds_read_b128 v[180:183], v57 offset:0
    ds_read_b128 v[184:187], v57 offset:2048
    v_mfma_f32_16x16x32_bf16 v[220:223], v[176:179], v[96:99], v[220:223]
    ds_read_b64_tr_b16 v[128:129], v32 offset:8192
    ds_read_b64_tr_b16 v[130:131], v32 offset:12288
    v_mfma_f32_16x16x32_bf16 v[192:195], v[172:175], v[100:103], v[192:195]
    ds_read_b64_tr_b16 v[132:133], v33 offset:8192
    ds_read_b64_tr_b16 v[134:135], v33 offset:12288
    s_add_u32 m0, s91, 97408
    s_nop 0
    buffer_load_dwordx4 v63, s[72:75], s10 offen lds
    v_mfma_f32_16x16x32_bf16 v[224:227], v[176:179], v[100:103], v[224:227]
    ds_read_b64_tr_b16 v[136:137], v34 offset:8192
    ds_read_b64_tr_b16 v[138:139], v34 offset:12288
    s_waitcnt lgkmcnt(15)
    v_mfma_f32_16x16x32_bf16 v[196:199], v[172:175], v[104:107], v[196:199]
    ds_read_b64_tr_b16 v[140:141], v35 offset:8192
    ds_read_b64_tr_b16 v[142:143], v35 offset:12288
    v_mfma_f32_16x16x32_bf16 v[228:231], v[176:179], v[104:107], v[228:231]
    ds_read_b64_tr_b16 v[144:145], v36 offset:8192
    ds_read_b64_tr_b16 v[146:147], v36 offset:12288
    s_add_u32 s9, s9, 20480
    s_add_u32 m0, s91, 82048
    s_nop 0
    buffer_load_dwordx4 v60, s[68:71], s9 offen lds
    v_mfma_f32_16x16x32_bf16 v[200:203], v[172:175], v[108:111], v[200:203]
    ds_read_b64_tr_b16 v[148:149], v37 offset:8192
    v_mfma_f32_16x16x32_bf16 v[232:235], v[176:179], v[108:111], v[232:235]
    ds_read_b64_tr_b16 v[150:151], v37 offset:12288
    s_waitcnt lgkmcnt(15)
    v_mfma_f32_16x16x32_bf16 v[204:207], v[172:175], v[112:115], v[204:207]
    ds_read_b64_tr_b16 v[152:153], v38 offset:8192
    s_add_u32 s10, s10, 61440
    s_add_u32 m0, s91, 98432
    s_nop 0
    buffer_load_dwordx4 v62, s[72:75], s10 offen lds
    v_mfma_f32_16x16x32_bf16 v[236:239], v[176:179], v[112:115], v[236:239]
    ds_read_b64_tr_b16 v[154:155], v38 offset:12288
    v_mfma_f32_16x16x32_bf16 v[208:211], v[116:119], v[172:175], v[208:211]
    ds_read_b64_tr_b16 v[156:157], v39 offset:8192
    v_mfma_f32_16x16x32_bf16 v[240:243], v[116:119], v[176:179], v[240:243]
    ds_read_b64_tr_b16 v[158:159], v39 offset:12288
    s_add_u32 m0, s91, 83072
    s_nop 0
    buffer_load_dwordx4 v61, s[68:71], s9 offen lds
    s_waitcnt lgkmcnt(15)
    v_mfma_f32_16x16x32_bf16 v[212:215], v[120:123], v[172:175], v[212:215]
    v_mfma_f32_16x16x32_bf16 v[244:247], v[120:123], v[176:179], v[244:247]
    v_mfma_f32_16x16x32_bf16 v[216:219], v[124:127], v[172:175], v[216:219]
    s_add_u32 m0, s91, 99456
    s_nop 0
    buffer_load_dwordx4 v63, s[72:75], s10 offen lds
    s_add_u32 s88, s88, 1
    s_cmp_eq_u32 s88, 10
    s_cselect_b32 s88, 0, s88
    v_mfma_f32_16x16x32_bf16 v[248:251], v[124:127], v[176:179], v[248:251]
    s_waitcnt vmcnt(8) lgkmcnt(0)
    s_mov_b64 exec, 0x1
    ds_add_u32 v4, v53 offset:14344
    s_mov_b64 exec, -1
    s_cmp_eq_u32 s93, 0
    s_cbranch_scc1 Lpub_35
    s_call_b64 s[46:47], F_publish
Lpub_35:
    s_setprio 0
    v_mfma_f32_16x16x32_bf16 v[188:191], v[180:183], v[128:131], v[188:191]
    v_mfma_f32_16x16x32_bf16 v[220:223], v[184:187], v[128:131], v[220:223]
    v_mfma_f32_16x16x32_bf16 v[192:195], v[180:183], v[132:135], v[192:195]
    v_mfma_f32_16x16x32_bf16 v[224:227], v[184:187], v[132:135], v[224:227]
    v_mfma_f32_16x16x32_bf16 v[196:199], v[180:183], v[136:139], v[196:199]
    v_mfma_f32_16x16x32_bf16 v[228:231], v[184:187], v[136:139], v[228:231]
    ds_read_b64 v[252:253], v4 offset:14344
    v_mfma_f32_16x16x32_bf16 v[200:203], v[180:183], v[140:143], v[200:203]
    v_mfma_f32_16x16x32_bf16 v[232:235], v[184:187], v[140:143], v[232:235]
    s_setprio 3
    s_mov_b32 s97, 20
    s_waitcnt lgkmcnt(0)
    v_cmp_gt_u32 vcc, s97, v252
    s_cbranch_vccz Lsbo_37
    s_call_b64 s[46:47], F_swspin
Lsbo_37:
    v_cmp_gt_u32 vcc, s48, v253
    s_cbranch_vccnz Lti_38
    s_call_b64 s[46:47], F_issue
Lti_38:
    s_cmp_lg_u32 s3, 0
    s_cbranch_scc1 Lw_39
    s_lshl_b32 s97, s2, 2
    s_add_u32 s97, s97, 208896
    v_mov_b32 v13, s8
    s_mov_b64 exec, 0x1
    buffer_store_dword v13, v4, s[56:59], s97 offen sc1
    s_mov_b64 exec, -1
Lw_39:
    s_setprio 0
    v_mfma_f32_16x16x32_bf16 v[204:207], v[180:183], v[144:147], v[204:207]
    ds_read_b128 v[172:175], v56 offset:32768
    ds_read_b128 v[176:179], v56 offset:34816
    ds_read_b64_tr_b16 v[96:97], v32 offset:32768
    v_mfma_f32_16x16x32_bf16 v[236:239], v[184:187], v[144:147], v[236:239]
    ds_read_b64_tr_b16 v[98:99], v32 offset:36864
    ds_read_b64_tr_b16 v[100:101], v33 offset:32768
    ds_read_b64_tr_b16 v[102:103], v33 offset:36864
    s_lshl_b32 s9, s88, 7
    s_add_u32 s9, s9, s90
    s_add_u32 m0, s91, 14464
    s_nop 0
    buffer_load_dwordx4 v60, s[68:71], s9 offen lds
    v_mfma_f32_16x16x32_bf16 v[208:211], v[148:151], v[180:183], v[208:211]
    ds_read_b64_tr_b16 v[104:105], v34 offset:32768
    ds_read_b64_tr_b16 v[106:107], v34 offset:36864
    v_mfma_f32_16x16x32_bf16 v[240:243], v[148:151], v[184:187], v[240:243]
    ds_read_b64_tr_b16 v[108:109], v35 offset:32768
    ds_read_b64_tr_b16 v[110:111], v35 offset:36864
    v_mfma_f32_16x16x32_bf16 v[212:215], v[152:155], v[180:183], v[212:215]
    ds_read_b64_tr_b16 v[112:113], v36 offset:32768
    ds_read_b64_tr_b16 v[114:115], v36 offset:36864
    s_mul_i32 s10, s88, 245760
    s_add_u32 s10, s10, s15
    s_add_u32 m0, s91, 30848
    s_nop 0
    buffer_load_dwordx4 v62, s[72:75], s10 offen lds
    v_mfma_f32_16x16x32_bf16 v[244:247], v[152:155], v[184:187], v[244:247]
    ds_read_b64_tr_b16 v[116:117], v37 offset:32768
    ds_read_b64_tr_b16 v[118:119], v37 offset:36864
    v_mfma_f32_16x16x32_bf16 v[216:219], v[156:159], v[180:183], v[216:219]
    ds_read_b64_tr_b16 v[120:121], v38 offset:32768
    ds_read_b64_tr_b16 v[122:123], v38 offset:36864
    v_mfma_f32_16x16x32_bf16 v[248:251], v[156:159], v[184:187], v[248:251]
    ds_read_b64_tr_b16 v[124:125], v39 offset:32768
    ds_read_b64_tr_b16 v[126:127], v39 offset:36864
    s_add_u32 m0, s91, 15488
    s_nop 0
    buffer_load_dwordx4 v61, s[68:71], s9 offen lds
    s_setprio 0
    s_waitcnt lgkmcnt(12)
    v_mfma_f32_16x16x32_bf16 v[188:191], v[172:175], v[96:99], v[188:191]
    ds_read_b128 v[180:183], v57 offset:32768
    ds_read_b128 v[184:187], v57 offset:34816
    v_mfma_f32_16x16x32_bf16 v[220:223], v[176:179], v[96:99], v[220:223]
    ds_read_b64_tr_b16 v[128:129], v32 offset:40960
    ds_read_b64_tr_b16 v[130:131], v32 offset:45056
    v_mfma_f32_16x16x32_bf16 v[192:195], v[172:175], v[100:103], v[192:195]
    ds_read_b64_tr_b16 v[132:133], v33 offset:40960
    ds_read_b64_tr_b16 v[134:135], v33 offset:45056
    s_add_u32 m0, s91, 31872
    s_nop 0
    buffer_load_dwordx4 v63, s[72:75], s10 offen lds
    v_mfma_f32_16x16x32_bf16 v[224:227], v[176:179], v[100:103], v[224:227]
    ds_read_b64_tr_b16 v[136:137], v34 offset:40960
    ds_read_b64_tr_b16 v[138:139], v34 offset:45056
    s_waitcnt lgkmcnt(15)
    v_mfma_f32_16x16x32_bf16 v[196:199], v[172:175], v[104:107], v[196:199]
    ds_read_b64_tr_b16 v[140:141], v35 offset:40960
    ds_read_b64_tr_b16 v[142:143], v35 offset:45056
    v_mfma_f32_16x16x32_bf16 v[228:231], v[176:179], v[104:107], v[228:231]
    ds_read_b64_tr_b16 v[144:145], v36 offset:40960
    ds_read_b64_tr_b16 v[146:147], v36 offset:45056
    s_add_u32 s9, s9, 20480
    s_add_u32 m0, s91, 16512
    s_nop 0
    buffer_load_dwordx4 v60, s[68:71], s9 offen lds
    v_mfma_f32_16x16x32_bf16 v[200:203], v[172:175], v[108:111], v[200:203]
    ds_read_b64_tr_b16 v[148:149], v37 offset:40960
    v_mfma_f32_16x16x32_bf16 v[232:235], v[176:179], v[108:111], v[232:235]
    ds_read_b64_tr_b16 v[150:151], v37 offset:45056
    s_waitcnt lgkmcnt(15)
    v_mfma_f32_16x16x32_bf16 v[204:207], v[172:175], v[112:115], v[204:207]
    ds_read_b64_tr_b16 v[152:153], v38 offset:40960
    s_add_u32 s10, s10, 61440
    s_add_u32 m0, s91, 32896
    s_nop 0
    buffer_load_dwordx4 v62, s[72:75], s10 offen lds
    v_mfma_f32_16x16x32_bf16 v[236:239], v[176:179], v[112:115], v[236:239]
    ds_read_b64_tr_b16 v[154:155], v38 offset:45056
    v_mfma_f32_16x16x32_bf16 v[208:211], v[116:119], v[172:175], v[208:211]
    ds_read_b64_tr_b16 v[156:157], v39 offset:40960
    v_mfma_f32_16x16x32_bf16 v[240:243], v[116:119], v[176:179], v[240:243]
    ds_read_b64_tr_b16 v[158:159], v39 offset:45056
    s_add_u32 m0, s91, 17536
    s_nop 0
    buffer_load_dwordx4 v61, s[68:71], s9 offen lds
    s_waitcnt lgkmcnt(15)
    v_mfma_f32_16x16x32_bf16 v[212:215], v[120:123], v[172:175], v[212:215]
    v_mfma_f32_16x16x32_bf16 v[244:247], v[120:123], v[176:179], v[244:247]
    v_mfma_f32_16x16x32_bf16 v[216:219], v[124:127], v[172:175], v[216:219]
    s_add_u32 m0, s91, 33920
    s_nop 0
    buffer_load_dwordx4 v63, s[72:75], s10 offen lds
    s_add_u32 s88, s88, 1
    s_cmp_eq_u32 s88, 10
    s_cselect_b32 s88, 0, s88
    v_mfma_f32_16x16x32_bf16 v[248:251], v[124:127], v[176:179], v[248:251]
    s_waitcnt vmcnt(8) lgkmcnt(0)
    s_mov_b64 exec, 0x1
    ds_add_u32 v4, v53 offset:14344
    s_mov_b64 exec, -1
    s_cmp_eq_u32 s93, 0
    s_cbranch_scc1 Lpub_40
    s_call_b64 s[46:47], F_publish
Lpub_40:
    s_setprio 0
    v_mfma_f32_16x16x32_bf16 v[188:191], v[180:183], v[128:131], v[188:191]
    v_mfma_f32_16x16x32_bf16 v[220:223], v[184:187], v[128:131], v[220:223]
    v_mfma_f32_16x16x32_bf16 v[192:195], v[180:183], v[132:135], v[192:195]
    v_mfma_f32_16x16x32_bf16 v[224:227], v[184:187], v[132:135], v[224:227]
    v_mfma_f32_16x16x32_bf16 v[196:199], v[180:183], v[136:139], v[196:199]
    v_mfma_f32_16x16x32_bf16 v[228:231], v[184:187], v[136:139], v[228:231]
    ds_read_b64 v[252:253], v4 offset:14344
    v_mfma_f32_16x16x32_bf16 v[200:203], v[180:183], v[140:143], v[200:203]
    v_mfma_f32_16x16x32_bf16 v[232:235], v[184:187], v[140:143], v[232:235]
    s_setprio 3
    s_mov_b32 s97, 24
    s_waitcnt lgkmcnt(0)
    v_cmp_gt_u32 vcc, s97, v252
    s_cbranch_vccz Lsbo_42
    s_call_b64 s[46:47], F_swspin
Lsbo_42:
    v_cmp_gt_u32 vcc, s48, v253
    s_cbranch_vccnz Lti_43
    s_call_b64 s[46:47], F_issue
Lti_43:
    s_setprio 0
    v_mfma_f32_16x16x32_bf16 v[204:207], v[180:183], v[144:147], v[204:207]
    ds_read_b128 v[172:175], v58 offset:0
    ds_read_b128 v[176:179], v58 offset:2048
    ds_read_b64_tr_b16 v[96:97], v40 offset:0
    v_mfma_f32_16x16x32_bf16 v[236:239], v[184:187], v[144:147], v[236:239]
    ds_read_b64_tr_b16 v[98:99], v40 offset:4096
    ds_read_b64_tr_b16 v[100:101], v41 offset:0
    ds_read_b64_tr_b16 v[102:103], v41 offset:4096
    s_lshl_b32 s9, s88, 7
    s_add_u32 s9, s9, s90
    s_add_u32 m0, s91, 47232
    s_nop 0
    buffer_load_dwordx4 v60, s[68:71], s9 offen lds
    v_mfma_f32_16x16x32_bf16 v[208:211], v[148:151], v[180:183], v[208:211]
    ds_read_b64_tr_b16 v[104:105], v42 offset:0
    ds_read_b64_tr_b16 v[106:107], v42 offset:4096
    v_mfma_f32_16x16x32_bf16 v[240:243], v[148:151], v[184:187], v[240:243]
    ds_read_b64_tr_b16 v[108:109], v43 offset:0
    ds_read_b64_tr_b16 v[110:111], v43 offset:4096
    v_mfma_f32_16x16x32_bf16 v[212:215], v[152:155], v[180:183], v[212:215]
    ds_read_b64_tr_b16 v[112:113], v44 offset:0
    ds_read_b64_tr_b16 v[114:115], v44 offset:4096
    s_mul_i32 s10, s88, 245760
    s_add_u32 s10, s10, s15
    s_add_u32 m0, s91, 63616
    s_nop 0
    buffer_load_dwordx4 v62, s[72:75], s10 offen lds
    v_mfma_f32_16x16x32_bf16 v[244:247], v[152:155], v[184:187], v[244:247]
    ds_read_b64_tr_b16 v[116:117], v45 offset:0
    ds_read_b64_tr_b16 v[118:119], v45 offset:4096
    v_mfma_f32_16x16x32_bf16 v[216:219], v[156:159], v[180:183], v[216:219]
    ds_read_b64_tr_b16 v[120:121], v46 offset:0
    ds_read_b64_tr_b16 v[122:123], v46 offset:4096
    v_mfma_f32_16x16x32_bf16 v[248:251], v[156:159], v[184:187], v[248:251]
    ds_read_b64_tr_b16 v[124:125], v47 offset:0
    ds_read_b64_tr_b16 v[126:127], v47 offset:4096
    s_add_u32 m0, s91, 48256
    s_nop 0
    buffer_load_dwordx4 v61, s[68:71], s9 offen lds
    s_setprio 0
    s_waitcnt lgkmcnt(12)
    v_mfma_f32_16x16x32_bf16 v[188:191], v[172:175], v[96:99], v[188:191]
    ds_read_b128 v[180:183], v59 offset:0
    ds_read_b128 v[184:187], v59 offset:2048
    v_mfma_f32_16x16x32_bf16 v[220:223], v[176:179], v[96:99], v[220:223]
    ds_read_b64_tr_b16 v[128:129], v40 offset:8192
    ds_read_b64_tr_b16 v[130:131], v40 offset:12288
    v_mfma_f32_16x16x32_bf16 v[192:195], v[172:175], v[100:103], v[192:195]
    ds_read_b64_tr_b16 v[132:133], v41 offset:8192
    ds_read_b64_tr_b16 v[134:135], v41 offset:12288
    s_add_u32 m0, s91, 64640
    s_nop 0
    buffer_load_dwordx4 v63, s[72:75], s10 offen lds
    v_mfma_f32_16x16x32_bf16 v[224:227], v[176:179], v[100:103], v[224:227]
    ds_read_b64_tr_b16 v[136:137], v42 offset:8192
    ds_read_b64_tr_b16 v[138:139], v42 offset:12288
    s_waitcnt lgkmcnt(15)
    v_mfma_f32_16x16x32_bf16 v[196:199], v[172:175], v[104:107], v[196:199]
    ds_read_b64_tr_b16 v[140:141], v43 offset:8192
    ds_read_b64_tr_b16 v[142:143], v43 offset:12288
    v_mfma_f32_16x16x32_bf16 v[228:231], v[176:179], v[104:107], v[228:231]
    ds_read_b64_tr_b16 v[144:145], v44 offset:8192
    ds_read_b64_tr_b16 v[146:147], v44 offset:12288
    s_add_u32 s9, s9, 20480
    s_add_u32 m0, s91, 49280
    s_nop 0
    buffer_load_dwordx4 v60, s[68:71], s9 offen lds
    v_mfma_f32_16x16x32_bf16 v[200:203], v[172:175], v[108:111], v[200:203]
    ds_read_b64_tr_b16 v[148:149], v45 offset:8192
    v_mfma_f32_16x16x32_bf16 v[232:235], v[176:179], v[108:111], v[232:235]
    ds_read_b64_tr_b16 v[150:151], v45 offset:12288
    s_waitcnt lgkmcnt(15)
    v_mfma_f32_16x16x32_bf16 v[204:207], v[172:175], v[112:115], v[204:207]
    ds_read_b64_tr_b16 v[152:153], v46 offset:8192
    s_add_u32 s10, s10, 61440
    s_add_u32 m0, s91, 65664
    s_nop 0
    buffer_load_dwordx4 v62, s[72:75], s10 offen lds
    v_mfma_f32_16x16x32_bf16 v[236:239], v[176:179], v[112:115], v[236:239]
    ds_read_b64_tr_b16 v[154:155], v46 offset:12288
    v_mfma_f32_16x16x32_bf16 v[208:211], v[116:119], v[172:175], v[208:211]
    ds_read_b64_tr_b16 v[156:157], v47 offset:8192
    v_mfma_f32_16x16x32_bf16 v[240:243], v[116:119], v[176:179], v[240:243]
    ds_read_b64_tr_b16 v[158:159], v47 offset:12288
    s_add_u32 m0, s91, 50304
    s_nop 0
    buffer_load_dwordx4 v61, s[68:71], s9 offen lds
    s_waitcnt lgkmcnt(15)
    v_mfma_f32_16x16x32_bf16 v[212:215], v[120:123], v[172:175], v[212:215]
    v_mfma_f32_16x16x32_bf16 v[244:247], v[120:123], v[176:179], v[244:247]
    v_mfma_f32_16x16x32_bf16 v[216:219], v[124:127], v[172:175], v[216:219]
    s_add_u32 m0, s91, 66688
    s_nop 0
    buffer_load_dwordx4 v63, s[72:75], s10 offen lds
    s_add_u32 s88, s88, 1
    s_cmp_eq_u32 s88, 10
    s_cselect_b32 s88, 0, s88
    v_mfma_f32_16x16x32_bf16 v[248:251], v[124:127], v[176:179], v[248:251]
    s_waitcnt vmcnt(8) lgkmcnt(0)
    s_mov_b64 exec, 0x1
    ds_add_u32 v4, v53 offset:14344
    s_mov_b64 exec, -1
    s_cmp_eq_u32 s93, 0
    s_cbranch_scc1 Lpub_44
    s_call_b64 s[46:47], F_publish
Lpub_44:
    s_setprio 0
    v_mfma_f32_16x16x32_bf16 v[188:191], v[180:183], v[128:131], v[188:191]
    v_mfma_f32_16x16x32_bf16 v[220:223], v[184:187], v[128:131], v[220:223]
    v_mfma_f32_16x16x32_bf16 v[192:195], v[180:183], v[132:135], v[192:195]
    v_mfma_f32_16x16x32_bf16 v[224:227], v[184:187], v[132:135], v[224:227]
    v_mfma_f32_16x16x32_bf16 v[196:199], v[180:183], v[136:139], v[196:199]
    v_mfma_f32_16x16x32_bf16 v[228:231], v[184:187], v[136:139], v[228:231]
    ds_read_b64 v[252:253], v4 offset:14344
    v_mfma_f32_16x16x32_bf16 v[200:203], v[180:183], v[140:143], v[200:203]
    v_mfma_f32_16x16x32_bf16 v[232:235], v[184:187], v[140:143], v[232:235]
    s_setprio 3
    s_mov_b32 s97, 28
    s_waitcnt lgkmcnt(0)
    v_cmp_gt_u32 vcc, s97, v252
    s_cbranch_vccz Lsbo_46
    s_call_b64 s[46:47], F_swspin
Lsbo_46:
    v_cmp_gt_u32 vcc, s48, v253
    s_cbranch_vccnz Lti_47
    s_call_b64 s[46:47], F_issue
Lti_47:
    s_mov_b32 s97, 208896
    buffer_load_dwordx4 v[20:23], v15, s[56:59], s97 offen sc1
    s_setprio 0
    v_mfma_f32_16x16x32_bf16 v[204:207], v[180:183], v[144:147], v[204:207]
    ds_read_b128 v[172:175], v56 offset:0
    ds_read_b128 v[176:179], v56 offset:2048
    ds_read_b64_tr_b16 v[96:97], v32 offset:0
    v_mfma_f32_16x16x32_bf16 v[236:239], v[184:187], v[144:147], v[236:239]
    ds_read_b64_tr_b16 v[98:99], v32 offset:4096
    ds_read_b64_tr_b16 v[100:101], v33 offset:0
    ds_read_b64_tr_b16 v[102:103], v33 offset:4096
    s_lshl_b32 s9, s88, 7
    s_add_u32 s9, s9, s90
    s_add_u32 m0, s91, 80000
    s_nop 0
    buffer_load_dwordx4 v60, s[68:71], s9 offen lds
    v_mfma_f32_16x16x32_bf16 v[208:211], v[148:151], v[180:183], v[208:211]
    ds_read_b64_tr_b16 v[104:105], v34 offset:0
    ds_read_b64_tr_b16 v[106:107], v34 offset:4096
    v_mfma_f32_16x16x32_bf16 v[240:243], v[148:151], v[184:187], v[240:243]
    ds_read_b64_tr_b16 v[108:109], v35 offset:0
    ds_read_b64_tr_b16 v[110:111], v35 offset:4096
    v_mfma_f32_16x16x32_bf16 v[212:215], v[152:155], v[180:183], v[212:215]
    ds_read_b64_tr_b16 v[112:113], v36 offset:0
    ds_read_b64_tr_b16 v[114:115], v36 offset:4096
    s_mul_i32 s10, s88, 245760
    s_add_u32 s10, s10, s15
    s_add_u32 m0, s91, 96384
    s_nop 0
    buffer_load_dwordx4 v62, s[72:75], s10 offen lds
    v_mfma_f32_16x16x32_bf16 v[244:247], v[152:155], v[184:187], v[244:247]
    ds_read_b64_tr_b16 v[116:117], v37 offset:0
    ds_read_b64_tr_b16 v[118:119], v37 offset:4096
    v_mfma_f32_16x16x32_bf16 v[216:219], v[156:159], v[180:183], v[216:219]
    ds_read_b64_tr_b16 v[120:121], v38 offset:0
    ds_read_b64_tr_b16 v[122:123], v38 offset:4096
    v_mfma_f32_16x16x32_bf16 v[248:251], v[156:159], v[184:187], v[248:251]
    ds_read_b64_tr_b16 v[124:125], v39 offset:0
    ds_read_b64_tr_b16 v[126:127], v39 offset:4096
    s_add_u32 m0, s91, 81024
    s_nop 0
    buffer_load_dwordx4 v61, s[68:71], s9 offen lds
    s_setprio 0
    s_waitcnt lgkmcnt(12)
    v_mfma_f32_16x16x32_bf16 v[188:191], v[172:175], v[96:99], v[188:191]
    ds_read_b128 v[180:183], v57 offset:0
    ds_read_b128 v[184:187], v57 offset:2048
    v_mfma_f32_16x16x32_bf16 v[220:223], v[176:179], v[96:99], v[220:223]
    ds_read_b64_tr_b16 v[128:129], v32 offset:8192
    ds_read_b64_tr_b16 v[130:131], v32 offset:12288
    v_mfma_f32_16x16x32_bf16 v[192:195], v[172:175], v[100:103], v[192:195]
    ds_read_b64_tr_b16 v[132:133], v33 offset:8192
    ds_read_b64_tr_b16 v[134:135], v33 offset:12288
    s_add_u32 m0, s91, 97408
    s_nop 0
    buffer_load_dwordx4 v63, s[72:75], s10 offen lds
    v_mfma_f32_16x16x32_bf16 v[224:227], v[176:179], v[100:103], v[224:227]
    ds_read_b64_tr_b16 v[136:137], v34 offset:8192
    ds_read_b64_tr_b16 v[138:139], v34 offset:12288
    s_waitcnt lgkmcnt(15)
    v_mfma_f32_16x16x32_bf16 v[196:199], v[172:175], v[104:107], v[196:199]
    ds_read_b64_tr_b16 v[140:141], v35 offset:8192
    ds_read_b64_tr_b16 v[142:143], v35 offset:12288
    v_mfma_f32_16x16x32_bf16 v[228:231], v[176:179], v[104:107], v[228:231]
    ds_read_b64_tr_b16 v[144:145], v36 offset:8192
    ds_read_b64_tr_b16 v[146:147], v36 offset:12288
    s_add_u32 s9, s9, 20480
    s_add_u32 m0, s91, 82048
    s_nop 0
    buffer_load_dwordx4 v60, s[68:71], s9 offen lds
    v_mfma_f32_16x16x32_bf16 v[200:203], v[172:175], v[108:111], v[200:203]
    ds_read_b64_tr_b16 v[148:149], v37 offset:8192
    v_mfma_f32_16x16x32_bf16 v[232:235], v[176:179], v[108:111], v[232:235]
    ds_read_b64_tr_b16 v[150:151], v37 offset:12288
    s_waitcnt lgkmcnt(15)
    v_mfma_f32_16x16x32_bf16 v[204:207], v[172:175], v[112:115], v[204:207]
    ds_read_b64_tr_b16 v[152:153], v38 offset:8192
    s_add_u32 s10, s10, 61440
    s_add_u32 m0, s91, 98432
    s_nop 0
    buffer_load_dwordx4 v62, s[72:75], s10 offen lds
    v_mfma_f32_16x16x32_bf16 v[236:239], v[176:179], v[112:115], v[236:239]
    ds_read_b64_tr_b16 v[154:155], v38 offset:12288
    v_mfma_f32_16x16x32_bf16 v[208:211], v[116:119], v[172:175], v[208:211]
    ds_read_b64_tr_b16 v[156:157], v39 offset:8192
    v_mfma_f32_16x16x32_bf16 v[240:243], v[116:119], v[176:179], v[240:243]
    ds_read_b64_tr_b16 v[158:159], v39 offset:12288
    s_add_u32 m0, s91, 83072
    s_nop 0
    buffer_load_dwordx4 v61, s[68:71], s9 offen lds
    s_waitcnt lgkmcnt(15)
    v_mfma_f32_16x16x32_bf16 v[212:215], v[120:123], v[172:175], v[212:215]
    v_mfma_f32_16x16x32_bf16 v[244:247], v[120:123], v[176:179], v[244:247]
    v_mfma_f32_16x16x32_bf16 v[216:219], v[124:127], v[172:175], v[216:219]
    s_add_u32 m0, s91, 99456
    s_nop 0
    buffer_load_dwordx4 v63, s[72:75], s10 offen lds
    s_add_u32 s88, s88, 1
    s_cmp_eq_u32 s88, 10
    s_cselect_b32 s88, 0, s88
    v_mfma_f32_16x16x32_bf16 v[248:251], v[124:127], v[176:179], v[248:251]
    s_waitcnt vmcnt(9) lgkmcnt(0)
    s_mov_b64 exec, 0x1
    ds_add_u32 v4, v53 offset:14344
    s_mov_b64 exec, -1
    s_cmp_eq_u32 s93, 0
    s_cbranch_scc1 Lpub_48
    s_call_b64 s[46:47], F_publish
Lpub_48:
    s_setprio 0
    v_mfma_f32_16x16x32_bf16 v[188:191], v[180:183], v[128:131], v[188:191]
    v_mfma_f32_16x16x32_bf16 v[220:223], v[184:187], v[128:131], v[220:223]
    v_mfma_f32_16x16x32_bf16 v[192:195], v[180:183], v[132:135], v[192:195]
    v_mfma_f32_16x16x32_bf16 v[224:227], v[184:187], v[132:135], v[224:227]
    v_mfma_f32_16x16x32_bf16 v[196:199], v[180:183], v[136:139], v[196:199]
    v_mfma_f32_16x16x32_bf16 v[228:231], v[184:187], v[136:139], v[228:231]
    ds_read_b64 v[252:253], v4 offset:14344
    v_mfma_f32_16x16x32_bf16 v[200:203], v[180:183], v[140:143], v[200:203]
    v_mfma_f32_16x16x32_bf16 v[232:235], v[184:187], v[140:143], v[232:235]
    s_setprio 3
    s_mov_b32 s97, 32
    s_waitcnt lgkmcnt(0)
    v_cmp_gt_u32 vcc, s97, v252
    s_cbranch_vccz Lsbo_50
    s_call_b64 s[46:47], F_swspin
Lsbo_50:
    v_cmp_gt_u32 vcc, s48, v253
    s_cbranch_vccnz Lti_51
    s_call_b64 s[46:47], F_issue
Lti_51:
    s_cmp_lg_u32 s3, 1
    s_cbranch_scc1 Lw_52
    s_lshr_b32 s97, s2, 3
    s_lshl_b32 s97, s97, 11
    v_lshl_add_u32 v54, v1, 5, s97
    v_min_u32 v54, CODE_BYTES-64, v54
    global_load_dword v54, v54, s[94:95]
Lw_52:
    s_setprio 0
    v_mfma_f32_16x16x32_bf16 v[204:207], v[180:183], v[144:147], v[204:207]
    ds_read_b128 v[172:175], v56 offset:32768
    ds_read_b128 v[176:179], v56 offset:34816
    ds_read_b64_tr_b16 v[96:97], v32 offset:32768
    v_mfma_f32_16x16x32_bf16 v[236:239], v[184:187], v[144:147], v[236:239]
    ds_read_b64_tr_b16 v[98:99], v32 offset:36864
    ds_read_b64_tr_b16 v[100:101], v33 offset:32768
    ds_read_b64_tr_b16 v[102:103], v33 offset:36864
    s_lshl_b32 s9, s88, 7
    s_add_u32 s9, s9, s90
    s_add_u32 m0, s91, 14464
    s_nop 0
    buffer_load_dwordx4 v60, s[68:71], s9 offen lds
    v_mfma_f32_16x16x32_bf16 v[208:211], v[148:151], v[180:183], v[208:211]
    ds_read_b64_tr_b16 v[104:105], v34 offset:32768
    ds_read_b64_tr_b16 v[106:107], v34 offset:36864
    v_mfma_f32_16x16x32_bf16 v[240:243], v[148:151], v[184:187], v[240:243]
    ds_read_b64_tr_b16 v[108:109], v35 offset:32768
    ds_read_b64_tr_b16 v[110:111], v35 offset:36864
    v_mfma_f32_16x16x32_bf16 v[212:215], v[152:155], v[180:183], v[212:215]
    ds_read_b64_tr_b16 v[112:113], v36 offset:32768
    ds_read_b64_tr_b16 v[114:115], v36 offset:36864
    s_mul_i32 s10, s88, 245760
    s_add_u32 s10, s10, s15
    s_add_u32 m0, s91, 30848
    s_nop 0
    buffer_load_dwordx4 v62, s[72:75], s10 offen lds
    v_mfma_f32_16x16x32_bf16 v[244:247], v[152:155], v[184:187], v[244:247]
    ds_read_b64_tr_b16 v[116:117], v37 offset:32768
    ds_read_b64_tr_b16 v[118:119], v37 offset:36864
    v_mfma_f32_16x16x32_bf16 v[216:219], v[156:159], v[180:183], v[216:219]
    ds_read_b64_tr_b16 v[120:121], v38 offset:32768
    ds_read_b64_tr_b16 v[122:123], v38 offset:36864
    v_mfma_f32_16x16x32_bf16 v[248:251], v[156:159], v[184:187], v[248:251]
    ds_read_b64_tr_b16 v[124:125], v39 offset:32768
    ds_read_b64_tr_b16 v[126:127], v39 offset:36864
    s_add_u32 m0, s91, 15488
    s_nop 0
    buffer_load_dwordx4 v61, s[68:71], s9 offen lds
    s_setprio 0
    s_waitcnt lgkmcnt(12)
    v_mfma_f32_16x16x32_bf16 v[188:191], v[172:175], v[96:99], v[188:191]
    ds_read_b128 v[180:183], v57 offset:32768
    ds_read_b128 v[184:187], v57 offset:34816
    v_mfma_f32_16x16x32_bf16 v[220:223], v[176:179], v[96:99], v[220:223]
    ds_read_b64_tr_b16 v[128:129], v32 offset:40960
    ds_read_b64_tr_b16 v[130:131], v32 offset:45056
    v_mfma_f32_16x16x32_bf16 v[192:195], v[172:175], v[100:103], v[192:195]
    ds_read_b64_tr_b16 v[132:133], v33 offset:40960
    ds_read_b64_tr_b16 v[134:135], v33 offset:45056
    s_add_u32 m0, s91, 31872
    s_nop 0
    buffer_load_dwordx4 v63, s[72:75], s10 offen lds
    v_mfma_f32_16x16x32_bf16 v[224:227], v[176:179], v[100:103], v[224:227]
    ds_read_b64_tr_b16 v[136:137], v34 offset:40960
    ds_read_b64_tr_b16 v[138:139], v34 offset:45056
    s_waitcnt lgkmcnt(15)
    v_mfma_f32_16x16x32_bf16 v[196:199], v[172:175], v[104:107], v[196:199]
    ds_read_b64_tr_b16 v[140:141], v35 offset:40960
    ds_read_b64_tr_b16 v[142:143], v35 offset:45056
    v_mfma_f32_16x16x32_bf16 v[228:231], v[176:179], v[104:107], v[228:231]
    ds_read_b64_tr_b16 v[144:145], v36 offset:40960
    ds_read_b64_tr_b16 v[146:147], v36 offset:45056
    s_add_u32 s9, s9, 20480
    s_add_u32 m0, s91, 16512
    s_nop 0
    buffer_load_dwordx4 v60, s[68:71], s9 offen lds
    v_mfma_f32_16x16x32_bf16 v[200:203], v[172:175], v[108:111], v[200:203]
    ds_read_b64_tr_b16 v[148:149], v37 offset:40960
    v_mfma_f32_16x16x32_bf16 v[232:235], v[176:179], v[108:111], v[232:235]
    ds_read_b64_tr_b16 v[150:151], v37 offset:45056
    s_waitcnt lgkmcnt(15)
    v_mfma_f32_16x16x32_bf16 v[204:207], v[172:175], v[112:115], v[204:207]
    ds_read_b64_tr_b16 v[152:153], v38 offset:40960
    s_add_u32 s10, s10, 61440
    s_add_u32 m0, s91, 32896
    s_nop 0
    buffer_load_dwordx4 v62, s[72:75], s10 offen lds
    v_mfma_f32_16x16x32_bf16 v[236:239], v[176:179], v[112:115], v[236:239]
    ds_read_b64_tr_b16 v[154:155], v38 offset:45056
    v_mfma_f32_16x16x32_bf16 v[208:211], v[116:119], v[172:175], v[208:211]
    ds_read_b64_tr_b16 v[156:157], v39 offset:40960
    v_mfma_f32_16x16x32_bf16 v[240:243], v[116:119], v[176:179], v[240:243]
    ds_read_b64_tr_b16 v[158:159], v39 offset:45056
    s_add_u32 m0, s91, 17536
    s_nop 0
    buffer_load_dwordx4 v61, s[68:71], s9 offen lds
    s_waitcnt lgkmcnt(15)
    v_mfma_f32_16x16x32_bf16 v[212:215], v[120:123], v[172:175], v[212:215]
    v_mfma_f32_16x16x32_bf16 v[244:247], v[120:123], v[176:179], v[244:247]
    v_mfma_f32_16x16x32_bf16 v[216:219], v[124:127], v[172:175], v[216:219]
    s_add_u32 m0, s91, 33920
    s_nop 0
    buffer_load_dwordx4 v63, s[72:75], s10 offen lds
    s_add_u32 s88, s88, 1
    s_cmp_eq_u32 s88, 10
    s_cselect_b32 s88, 0, s88
    v_mfma_f32_16x16x32_bf16 v[248:251], v[124:127], v[176:179], v[248:251]
    s_waitcnt vmcnt(8) lgkmcnt(0)
    s_mov_b64 exec, 0x1
    ds_add_u32 v4, v53 offset:14344
    s_mov_b64 exec, -1
    s_cmp_eq_u32 s93, 0
    s_cbranch_scc1 Lpub_53
    s_call_b64 s[46:47], F_publish
Lpub_53:
    s_setprio 0
    v_mfma_f32_16x16x32_bf16 v[188:191], v[180:183], v[128:131], v[188:191]
    v_mfma_f32_16x16x32_bf16 v[220:223], v[184:187], v[128:131], v[220:223]
    v_mfma_f32_16x16x32_bf16 v[192:195], v[180:183], v[132:135], v[192:195]
    v_mfma_f32_16x16x32_bf16 v[224:227], v[184:187], v[132:135], v[224:227]
    v_mfma_f32_16x16x32_bf16 v[196:199], v[180:183], v[136:139], v[196:199]
    v_mfma_f32_16x16x32_bf16 v[228:231], v[184:187], v[136:139], v[228:231]
    ds_read_b64 v[252:253], v4 offset:14344
    v_mfma_f32_16x16x32_bf16 v[200:203], v[180:183], v[140:143], v[200:203]
    v_mfma_f32_16x16x32_bf16 v[232:235], v[184:187], v[140:143], v[232:235]
    s_setprio 3
    s_mov_b32 s97, 36
    s_waitcnt lgkmcnt(0)
    v_cmp_gt_u32 vcc, s97, v252
    s_cbranch_vccz Lsbo_55
    s_call_b64 s[46:47], F_swspin
Lsbo_55:
    v_cmp_gt_u32 vcc, s48, v253
    s_cbranch_vccnz Lti_56
    s_call_b64 s[46:47], F_issue
Lti_56:
    v_xor_b32 v20, s8, v20
    v_xor_b32 v21, s8, v21
    v_xor_b32 v22, s8, v22
    v_xor_b32 v23, s8, v23
    v_or3_b32 v20, v20, v21, v22
    v_or_b32 v20, v20, v23
    v_cmp_ne_u32 vcc, 0, v20
    s_cbranch_vccz Lok_s5_57
    s_mov_b32 s96, 400000
Lre_s5_58:
    s_sleep 2
    s_mov_b32 s97, 208896
    buffer_load_dwordx4 v[20:23], v15, s[56:59], s97 offen sc1
    s_waitcnt vmcnt(0)
    v_xor_b32 v20, s8, v20
    v_xor_b32 v21, s8, v21
    v_xor_b32 v22, s8, v22
    v_xor_b32 v23, s8, v23
    v_or3_b32 v20, v20, v21, v22
    v_or_b32 v20, v20, v23
    v_cmp_ne_u32 vcc, 0, v20
    s_sub_u32 s96, s96, 1
    s_cmp_eq_u32 s96, 0
    s_cbranch_scc1 Lok_s5_57
    s_cbranch_vccnz Lre_s5_58
Lok_s5_57:
    s_add_u32 s97, s5, s4
    s_mul_i32 s98, s97, 52
    s_lshr_b32 s98, s98, 8
    s_mul_i32 s98, s98, 5
    s_sub_u32 s97, s97, s98
    s_mul_i32 s99, s84, 5
    s_add_u32 s85, s97, s99
    s_add_u32 s97, s97, 1
    s_cmp_eq_u32 s97, 5
    s_cselect_b32 s97, 0, s97
    s_add_u32 s86, s97, s99
    s_add_u32 s97, s97, 1
    s_cmp_eq_u32 s97, 5
    s_cselect_b32 s97, 0, s97
    s_add_u32 s87, s97, s99
    s_add_u32 s97, s97, 1
    s_cmp_eq_u32 s97, 5
    s_cselect_b32 s97, 0, s97
    s_add_u32 s89, s97, s99
    s_add_u32 s97, s97, 1
    s_cmp_eq_u32 s97, 5
    s_cselect_b32 s97, 0, s97
    s_add_u32 s92, s97, s99
    s_add_u32 s97, s97, 1
    s_cmp_eq_u32 s97, 5
    s_cselect_b32 s97, 0, s97
    s_mul_i32 s11, s5, 102400
    s_setprio 0
    v_mfma_f32_16x16x32_bf16 v[204:207], v[180:183], v[144:147], v[204:207]
    ds_read_b128 v[172:175], v58 offset:0
    ds_read_b128 v[176:179], v58 offset:2048
    ds_read_b64_tr_b16 v[96:97], v40 offset:0
    v_mfma_f32_16x16x32_bf16 v[236:239], v[184:187], v[144:147], v[236:239]
    ds_read_b64_tr_b16 v[98:99], v40 offset:4096
    ds_read_b64_tr_b16 v[100:101], v41 offset:0
    ds_read_b64_tr_b16 v[102:103], v41 offset:4096
    s_mul_i32 s14, s85, 5120
    s_add_u32 s14, s14, s11
    s_add_u32 s14, s14, 12582912
    buffer_load_dwordx4 v[64:67], v15, s[56:59], s14 offen offset:0 sc1
    v_mfma_f32_16x16x32_bf16 v[208:211], v[148:151], v[180:183], v[208:211]
    ds_read_b64_tr_b16 v[104:105], v42 offset:0
    ds_read_b64_tr_b16 v[106:107], v42 offset:4096
    v_mfma_f32_16x16x32_bf16 v[240:243], v[148:151], v[184:187], v[240:243]
    ds_read_b64_tr_b16 v[108:109], v43 offset:0
    ds_read_b64_tr_b16 v[110:111], v43 offset:4096
    v_mfma_f32_16x16x32_bf16 v[212:215], v[152:155], v[180:183], v[212:215]
    ds_read_b64_tr_b16 v[112:113], v44 offset:0
    ds_read_b64_tr_b16 v[114:115], v44 offset:4096
    s_mul_i32 s14, s85, 5120
    s_add_u32 s14, s14, s11
    s_add_u32 s14, s14, 12582912
    buffer_load_dwordx4 v[68:71], v15, s[56:59], s14 offen offset:1024 sc1
    v_mfma_f32_16x16x32_bf16 v[244:247], v[152:155], v[184:187], v[244:247]
    ds_read_b64_tr_b16 v[116:117], v45 offset:0
    ds_read_b64_tr_b16 v[118:119], v45 offset:4096
    v_mfma_f32_16x16x32_bf16 v[216:219], v[156:159], v[180:183], v[216:219]
    ds_read_b64_tr_b16 v[120:121], v46 offset:0
    ds_read_b64_tr_b16 v[122:123], v46 offset:4096
    v_mfma_f32_16x16x32_bf16 v[248:251], v[156:159], v[184:187], v[248:251]
    ds_read_b64_tr_b16 v[124:125], v47 offset:0
    ds_read_b64_tr_b16 v[126:127], v47 offset:4096
    s_mul_i32 s14, s85, 5120
    s_add_u32 s14, s14, s11
    s_add_u32 s14, s14, 12582912
    buffer_load_dwordx4 v[72:75], v15, s[56:59], s14 offen offset:2048 sc1
    s_setprio 0
    s_waitcnt lgkmcnt(12)
    v_mfma_f32_16x16x32_bf16 v[188:191], v[172:175], v[96:99], v[188:191]
    ds_read_b128 v[180:183], v59 offset:0
    ds_read_b128 v[184:187], v59 offset:2048
    v_mfma_f32_16x16x32_bf16 v[220:223], v[176:179], v[96:99], v[220:223]
    ds_read_b64_tr_b16 v[128:129], v40 offset:8192
    ds_read_b64_tr_b16 v[130:131], v40 offset:12288
    v_mfma_f32_16x16x32_bf16 v[192:195], v[172:175], v[100:103], v[192:195]
    ds_read_b64_tr_b16 v[132:133], v41 offset:8192
    ds_read_b64_tr_b16 v[134:135], v41 offset:12288
    s_mul_i32 s14, s85, 5120
    s_add_u32 s14, s14, s11
    s_add_u32 s14, s14, 12582912
    buffer_load_dwordx4 v[76:79], v15, s[56:59], s14 offen offset:3072 sc1
    v_mfma_f32_16x16x32_bf16 v[224:227], v[176:179], v[100:103], v[224:227]
    ds_read_b64_tr_b16 v[136:137], v42 offset:8192
    ds_read_b64_tr_b16 v[138:139], v42 offset:12288
    s_waitcnt lgkmcnt(15)
    v_mfma_f32_16x16x32_bf16 v[196:199], v[172:175], v[104:107], v[196:199]
    ds_read_b64_tr_b16 v[140:141], v43 offset:8192
    ds_read_b64_tr_b16 v[142:143], v43 offset:12288
    v_mfma_f32_16x16x32_bf16 v[228:231], v[176:179], v[104:107], v[228:231]
    ds_read_b64_tr_b16 v[144:145], v44 offset:8192
    ds_read_b64_tr_b16 v[146:147], v44 offset:12288
    s_mul_i32 s14, s85, 5120
    s_add_u32 s14, s14, s11
    s_add_u32 s14, s14, 12587008
    buffer_load_dwordx4 v[80:83], v15, s[56:59], s14 offen offset:0 sc1
    v_mfma_f32_16x16x32_bf16 v[200:203], v[172:175], v[108:111], v[200:203]
    ds_read_b64_tr_b16 v[148:149], v45 offset:8192
    v_mfma_f32_16x16x32_bf16 v[232:235], v[176:179], v[108:111], v[232:235]
    ds_read_b64_tr_b16 v[150:151], v45 offset:12288
    s_waitcnt lgkmcnt(15)
    v_mfma_f32_16x16x32_bf16 v[204:207], v[172:175], v[112:115], v[204:207]
    ds_read_b64_tr_b16 v[152:153], v46 offset:8192
    s_mul_i32 s14, s86, 5120
    s_add_u32 s14, s14, s11
    s_add_u32 s14, s14, 12582912
    buffer_load_dwordx4 v[84:87], v15, s[56:59], s14 offen offset:0 sc1
    v_mfma_f32_16x16x32_bf16 v[236:239], v[176:179], v[112:115], v[236:239]
    ds_read_b64_tr_b16 v[154:155], v46 offset:12288
    v_mfma_f32_16x16x32_bf16 v[208:211], v[116:119], v[172:175], v[208:211]
    ds_read_b64_tr_b16 v[156:157], v47 offset:8192
    v_mfma_f32_16x16x32_bf16 v[240:243], v[116:119], v[176:179], v[240:243]
    ds_read_b64_tr_b16 v[158:159], v47 offset:12288
    s_mul_i32 s14, s86, 5120
    s_add_u32 s14, s14, s11
    s_add_u32 s14, s14, 12582912
    buffer_load_dwordx4 v[88:91], v15, s[56:59], s14 offen offset:1024 sc1
    s_waitcnt lgkmcnt(15)
    v_mfma_f32_16x16x32_bf16 v[212:215], v[120:123], v[172:175], v[212:215]
    v_mfma_f32_16x16x32_bf16 v[244:247], v[120:123], v[176:179], v[244:247]
    v_mfma_f32_16x16x32_bf16 v[216:219], v[124:127], v[172:175], v[216:219]
    s_mul_i32 s14, s86, 5120
    s_add_u32 s14, s14, s11
    s_add_u32 s14, s14, 12582912
    buffer_load_dwordx4 v[92:95], v15, s[56:59], s14 offen offset:2048 sc1
    v_mfma_f32_16x16x32_bf16 v[248:251], v[124:127], v[176:179], v[248:251]
    s_waitcnt vmcnt(8) lgkmcnt(0)
    s_mov_b64 exec, 0x1
    ds_add_u32 v4, v53 offset:14344
    s_mov_b64 exec, -1
    s_cmp_eq_u32 s93, 0
    s_cbranch_scc1 Lpub_59
    s_call_b64 s[46:47], F_publish
Lpub_59:
    s_setprio 0
    v_mfma_f32_16x16x32_bf16 v[188:191], v[180:183], v[128:131], v[188:191]
    v_mfma_f32_16x16x32_bf16 v[220:223], v[184:187], v[128:131], v[220:223]
    v_mfma_f32_16x16x32_bf16 v[192:195], v[180:183], v[132:135], v[192:195]
    v_mfma_f32_16x16x32_bf16 v[224:227], v[184:187], v[132:135], v[224:227]
    v_mfma_f32_16x16x32_bf16 v[196:199], v[180:183], v[136:139], v[196:199]
    v_mfma_f32_16x16x32_bf16 v[228:231], v[184:187], v[136:139], v[228:231]
    ds_read_b64 v[252:253], v4 offset:14344
    v_mfma_f32_16x16x32_bf16 v[200:203], v[180:183], v[140:143], v[200:203]
    v_mfma_f32_16x16x32_bf16 v[232:235], v[184:187], v[140:143], v[232:235]
    s_setprio 3
    s_mov_b32 s97, 40
    s_waitcnt lgkmcnt(0)
    v_cmp_gt_u32 vcc, s97, v252
    s_cbranch_vccz Lsbo_61
    s_call_b64 s[46:47], F_swspin
Lsbo_61:
    v_cmp_gt_u32 vcc, s48, v253
    s_cbranch_vccnz Lti_62
    s_call_b64 s[46:47], F_issue
Lti_62:
    s_setprio 0
    v_mfma_f32_16x16x32_bf16 v[204:207], v[180:183], v[144:147], v[204:207]
    ds_read_b128 v[172:175], v56 offset:0
    ds_read_b128 v[176:179], v56 offset:2048
    ds_read_b64_tr_b16 v[96:97], v32 offset:0
    v_mfma_f32_16x16x32_bf16 v[236:239], v[184:187], v[144:147], v[236:239]
    ds_read_b64_tr_b16 v[98:99], v32 offset:4096
    ds_read_b64_tr_b16 v[100:101], v33 offset:0
    ds_read_b64_tr_b16 v[102:103], v33 offset:4096
    s_add_u32 s13, s84, s4
    s_and_b32 s13, s13, 3
    s_mul_i32 s13, s13, 13312
    s_add_u32 s14, s13, s11
    s_add_u32 s14, s14, 13451264
    s_add_u32 m0, s13, 63616
    s_nop 0
    buffer_load_dwordx4 v15, s[56:59], s14 offen sc1 lds
    v_mfma_f32_16x16x32_bf16 v[208:211], v[148:151], v[180:183], v[208:211]
    ds_read_b64_tr_b16 v[104:105], v34 offset:0
    ds_read_b64_tr_b16 v[106:107], v34 offset:4096
    s_add_u32 s14, s13, s11
    s_add_u32 s14, s14, 13452288
    s_add_u32 m0, s13, 64640
    s_nop 0
    buffer_load_dwordx4 v15, s[56:59], s14 offen sc1 lds
    v_mfma_f32_16x16x32_bf16 v[240:243], v[148:151], v[184:187], v[240:243]
    ds_read_b64_tr_b16 v[108:109], v35 offset:0
    ds_read_b64_tr_b16 v[110:111], v35 offset:4096
    v_mfma_f32_16x16x32_bf16 v[212:215], v[152:155], v[180:183], v[212:215]
    ds_read_b64_tr_b16 v[112:113], v36 offset:0
    ds_read_b64_tr_b16 v[114:115], v36 offset:4096
    s_add_u32 s14, s13, s11
    s_add_u32 s14, s14, 13453312
    s_add_u32 m0, s13, 65664
    s_nop 0
    buffer_load_dwordx4 v15, s[56:59], s14 offen sc1 lds
    v_mfma_f32_16x16x32_bf16 v[244:247], v[152:155], v[184:187], v[244:247]
    ds_read_b64_tr_b16 v[116:117], v37 offset:0
    ds_read_b64_tr_b16 v[118:119], v37 offset:4096
    s_add_u32 s14, s13, s11
    s_add_u32 s14, s14, 13454336
    s_add_u32 m0, s13, 66688
    s_nop 0
    buffer_load_dwordx4 v15, s[56:59], s14 offen sc1 lds
    v_mfma_f32_16x16x32_bf16 v[216:219], v[156:159], v[180:183], v[216:219]
    ds_read_b64_tr_b16 v[120:121], v38 offset:0
    ds_read_b64_tr_b16 v[122:123], v38 offset:4096
    v_mfma_f32_16x16x32_bf16 v[248:251], v[156:159], v[184:187], v[248:251]
    ds_read_b64_tr_b16 v[124:125], v39 offset:0
    ds_read_b64_tr_b16 v[126:127], v39 offset:4096
    s_add_u32 s14, s13, s11
    s_add_u32 s14, s14, 13455360
    s_add_u32 m0, s13, 67712
    s_nop 0
    buffer_load_dwordx4 v15, s[56:59], s14 offen sc1 lds
    s_setprio 0
    s_waitcnt lgkmcnt(12)
    v_mfma_f32_16x16x32_bf16 v[188:191], v[172:175], v[96:99], v[188:191]
    ds_read_b128 v[180:183], v57 offset:0
    ds_read_b128 v[184:187], v57 offset:2048
    v_mfma_f32_16x16x32_bf16 v[220:223], v[176:179], v[96:99], v[220:223]
    ds_read_b64_tr_b16 v[128:129], v32 offset:8192
    ds_read_b64_tr_b16 v[130:131], v32 offset:12288
    s_add_u32 s14, s13, s11
    s_add_u32 s14, s14, 13456384
    s_add_u32 m0, s13, 68736
    s_nop 0
    buffer_load_dwordx4 v15, s[56:59], s14 offen sc1 lds
    v_mfma_f32_16x16x32_bf16 v[192:195], v[172:175], v[100:103], v[192:195]
    ds_read_b64_tr_b16 v[132:133], v33 offset:8192
    ds_read_b64_tr_b16 v[134:135], v33 offset:12288
    s_add_u32 s14, s13, s11
    s_add_u32 s14, s14, 13457408
    s_add_u32 m0, s13, 69760
    s_nop 0
    buffer_load_dwordx4 v15, s[56:59], s14 offen sc1 lds
    v_mfma_f32_16x16x32_bf16 v[224:227], v[176:179], v[100:103], v[224:227]
    ds_read_b64_tr_b16 v[136:137], v34 offset:8192
    ds_read_b64_tr_b16 v[138:139], v34 offset:12288
    s_waitcnt lgkmcnt(15)
    v_mfma_f32_16x16x32_bf16 v[196:199], v[172:175], v[104:107], v[196:199]
    ds_read_b64_tr_b16 v[140:141], v35 offset:8192
    ds_read_b64_tr_b16 v[142:143], v35 offset:12288
    s_add_u32 s14, s13, s11
    s_add_u32 s14, s14, 13458432
    s_add_u32 m0, s13, 70784
    s_nop 0
    buffer_load_dwordx4 v15, s[56:59], s14 offen sc1 lds
    v_mfma_f32_16x16x32_bf16 v[228:231], v[176:179], v[104:107], v[228:231]
    ds_read_b64_tr_b16 v[144:145], v36 offset:8192
    ds_read_b64_tr_b16 v[146:147], v36 offset:12288
    s_add_u32 s14, s13, s11
    s_add_u32 s14, s14, 13459456
    s_add_u32 m0, s13, 71808
    s_nop 0
    buffer_load_dwordx4 v15, s[56:59], s14 offen sc1 lds
    v_mfma_f32_16x16x32_bf16 v[200:203], v[172:175], v[108:111], v[200:203]
    ds_read_b64_tr_b16 v[148:149], v37 offset:8192
    v_mfma_f32_16x16x32_bf16 v[232:235], v[176:179], v[108:111], v[232:235]
    ds_read_b64_tr_b16 v[150:151], v37 offset:12288
    s_add_u32 s14, s13, s11
    s_add_u32 s14, s14, 13460480
    s_add_u32 m0, s13, 72832
    s_nop 0
    buffer_load_dwordx4 v15, s[56:59], s14 offen sc1 lds
    s_waitcnt lgkmcnt(15)
    v_mfma_f32_16x16x32_bf16 v[204:207], v[172:175], v[112:115], v[204:207]
    ds_read_b64_tr_b16 v[152:153], v38 offset:8192
    s_add_u32 s14, s13, s11
    s_add_u32 s14, s14, 13461504
    s_add_u32 m0, s13, 73856
    s_nop 0
    buffer_load_dwordx4 v15, s[56:59], s14 offen sc1 lds
    v_mfma_f32_16x16x32_bf16 v[236:239], v[176:179], v[112:115], v[236:239]
    ds_read_b64_tr_b16 v[154:155], v38 offset:12288
    v_mfma_f32_16x16x32_bf16 v[208:211], v[116:119], v[172:175], v[208:211]
    ds_read_b64_tr_b16 v[156:157], v39 offset:8192
    s_add_u32 s14, s13, s11
    s_add_u32 s14, s14, 13462528
    s_add_u32 m0, s13, 74880
    s_nop 0
    buffer_load_dwordx4 v15, s[56:59], s14 offen sc1 lds
    v_mfma_f32_16x16x32_bf16 v[240:243], v[116:119], v[176:179], v[240:243]
    ds_read_b64_tr_b16 v[158:159], v39 offset:12288
    s_add_u32 s14, s13, s11
    s_add_u32 s14, s14, 13463552
    s_add_u32 m0, s13, 75904
    s_nop 0
    buffer_load_dwordx4 v15, s[56:59], s14 offen sc1 lds
    s_waitcnt lgkmcnt(15)
    v_mfma_f32_16x16x32_bf16 v[212:215], v[120:123], v[172:175], v[212:215]
    v_mfma_f32_16x16x32_bf16 v[244:247], v[120:123], v[176:179], v[244:247]
    v_mfma_f32_16x16x32_bf16 v[216:219], v[124:127], v[172:175], v[216:219]
    v_mfma_f32_16x16x32_bf16 v[248:251], v[124:127], v[176:179], v[248:251]
    s_setprio 0
    s_waitcnt lgkmcnt(12)
    v_mfma_f32_16x16x32_bf16 v[188:191], v[180:183], v[128:131], v[188:191]
    v_mfma_f32_16x16x32_bf16 v[220:223], v[184:187], v[128:131], v[220:223]
    v_mfma_f32_16x16x32_bf16 v[192:195], v[180:183], v[132:135], v[192:195]
    v_mfma_f32_16x16x32_bf16 v[224:227], v[184:187], v[132:135], v[224:227]
    s_waitcnt lgkmcnt(8)
    v_mfma_f32_16x16x32_bf16 v[196:199], v[180:183], v[136:139], v[196:199]
    v_mfma_f32_16x16x32_bf16 v[228:231], v[184:187], v[136:139], v[228:231]
    v_mfma_f32_16x16x32_bf16 v[200:203], v[180:183], v[140:143], v[200:203]
    v_mfma_f32_16x16x32_bf16 v[232:235], v[184:187], v[140:143], v[232:235]
    s_waitcnt lgkmcnt(4)
    v_mfma_f32_16x16x32_bf16 v[204:207], v[180:183], v[144:147], v[204:207]
    v_mfma_f32_16x16x32_bf16 v[236:239], v[184:187], v[144:147], v[236:239]
    v_mfma_f32_16x16x32_bf16 v[208:211], v[148:151], v[180:183], v[208:211]
    v_mfma_f32_16x16x32_bf16 v[240:243], v[148:151], v[184:187], v[240:243]
    s_waitcnt lgkmcnt(0)
    v_mfma_f32_16x16x32_bf16 v[212:215], v[152:155], v[180:183], v[212:215]
    v_mfma_f32_16x16x32_bf16 v[244:247], v[152:155], v[184:187], v[244:247]
    v_mfma_f32_16x16x32_bf16 v[216:219], v[156:159], v[180:183], v[216:219]
    v_mfma_f32_16x16x32_bf16 v[248:251], v[156:159], v[184:187], v[248:251]
    s_setprio 3
    s_mov_b32 s96, 4000000
Lqf_63:
    ds_read_b32 v253, v4 offset:14348
    s_sub_u32 s96, s96, 1
    s_waitcnt lgkmcnt(0)
    v_readfirstlane_b32 s97, v253
    s_cmp_eq_u32 s96, 0
    s_cselect_b32 s97, 4, s97
    s_cmp_lt_u32 s97, 4
    s_cbranch_scc1 Lqf_63
    v_mov_b32 v24, 0
    v_mov_b32 v25, 0
    v_mov_b32 v26, 0
    v_mov_b32 v27, 0
    v_lshlrev_b32 v5, 4, v0
    ds_write_b128 v5, v[24:27] offset:10240
    s_mov_b32 s98, 0x3fb8aa3b
    s_mov_b32 s99, 0x3fb8aa3b
    v_mul_u32_u24 v6, 80, v2
    v_lshl_add_u32 v5, v3, 4, v6
    s_mul_i32 s12, s84, 3456
    s_add_u32 s12, s12, 46592
    v_add_u32 v5, s12, v5
    s_mul_i32 s12, s84, 2560
    v_lshl_add_u32 v6, v3, 3, v6
    v_add_u32 v6, s12, v6
    v_mov_b32 v116, 0x3f803f80
    v_mov_b32 v117, 0x3f803f80
    v_mov_b32 v118, 0x3f803f80
    v_mov_b32 v119, 0x3f803f80
    v_mul_f32 v28, s98, v188
    v_mul_f32 v29, s98, v189
    v_mul_f32 v30, s98, v190
    v_mul_f32 v31, s98, v191
    v_exp_f32 v28, v28 clamp
    v_exp_f32 v29, v29 clamp
    v_exp_f32 v30, v30 clamp
    v_exp_f32 v31, v31 clamp
    v_max_f32 v188, 0x358637bd, v188
    v_max_f32 v189, 0x358637bd, v189
    v_max_f32 v190, 0x358637bd, v190
    v_max_f32 v191, 0x358637bd, v191
    v_add_f32 v188, v188, v28
    v_add_f32 v189, v189, v29
    v_add_f32 v190, v190, v30
    v_add_f32 v191, v191, v31
    v_cvt_pk_bf16_f32 v96, v188, v189
    v_cvt_pk_bf16_f32 v97, v190, v191
    v_mul_f32 v28, s98, v220
    v_mul_f32 v29, s98, v221
    v_mul_f32 v30, s98, v222
    v_mul_f32 v31, s98, v223
    v_exp_f32 v28, v28 clamp
    v_exp_f32 v29, v29 clamp
    v_exp_f32 v30, v30 clamp
    v_exp_f32 v31, v31 clamp
    v_max_f32 v220, 0x358637bd, v220
    v_max_f32 v221, 0x358637bd, v221
    v_max_f32 v222, 0x358637bd, v222
    v_max_f32 v223, 0x358637bd, v223
    v_add_f32 v220, v220, v28
    v_add_f32 v221, v221, v29
    v_add_f32 v222, v222, v30
    v_add_f32 v223, v223, v31
    v_cvt_pk_bf16_f32 v98, v220, v221
    v_cvt_pk_bf16_f32 v99, v222, v223
    v_mul_f32 v28, s98, v192
    v_mul_f32 v29, s98, v193
    v_mul_f32 v30, s98, v194
    v_mul_f32 v31, s98, v195
    v_exp_f32 v28, v28 clamp
    v_exp_f32 v29, v29 clamp
    v_exp_f32 v30, v30 clamp
    v_exp_f32 v31, v31 clamp
    v_max_f32 v192, 0x358637bd, v192
    v_max_f32 v193, 0x358637bd, v193
    v_max_f32 v194, 0x358637bd, v194
    v_max_f32 v195, 0x358637bd, v195
    v_add_f32 v192, v192, v28
    v_add_f32 v193, v193, v29
    v_add_f32 v194, v194, v30
    v_add_f32 v195, v195, v31
    v_cvt_pk_bf16_f32 v100, v192, v193
    v_cvt_pk_bf16_f32 v101, v194, v195
    v_mul_f32 v28, s98, v224
    v_mul_f32 v29, s98, v225
    v_mul_f32 v30, s98, v226
    v_mul_f32 v31, s98, v227
    v_exp_f32 v28, v28 clamp
    v_exp_f32 v29, v29 clamp
    v_exp_f32 v30, v30 clamp
    v_exp_f32 v31, v31 clamp
    v_max_f32 v224, 0x358637bd, v224
    v_max_f32 v225, 0x358637bd, v225
    v_max_f32 v226, 0x358637bd, v226
    v_max_f32 v227, 0x358637bd, v227
    v_add_f32 v224, v224, v28
    v_add_f32 v225, v225, v29
    v_add_f32 v226, v226, v30
    v_add_f32 v227, v227, v31
    v_cvt_pk_bf16_f32 v102, v224, v225
    v_cvt_pk_bf16_f32 v103, v226, v227
    s_mov_b32 exec_lo, 0xff00ff
    s_mov_b32 exec_hi, 0xff00ff
    v_mul_f32 v28, s98, v196
    v_mul_f32 v29, s98, v197
    v_mul_f32 v30, s98, v198
    v_mul_f32 v31, s98, v199
    v_exp_f32 v28, v28 clamp
    v_exp_f32 v29, v29 clamp
    v_exp_f32 v30, v30 clamp
    v_exp_f32 v31, v31 clamp
    v_max_f32 v196, 0x358637bd, v196
    v_max_f32 v197, 0x358637bd, v197
    v_max_f32 v198, 0x358637bd, v198
    v_max_f32 v199, 0x358637bd, v199
    v_add_f32 v196, v196, v28
    v_add_f32 v197, v197, v29
    v_add_f32 v198, v198, v30
    v_add_f32 v199, v199, v31
    s_mov_b64 exec, -1
    v_cvt_pk_bf16_f32 v104, v196, v197
    v_cvt_pk_bf16_f32 v105, v198, v199
    s_mov_b32 exec_lo, 0xff00ff
    s_mov_b32 exec_hi, 0xff00ff
    v_mul_f32 v28, s98, v228
    v_mul_f32 v29, s98, v229
    v_mul_f32 v30, s98, v230
    v_mul_f32 v31, s98, v231
    v_exp_f32 v28, v28 clamp
    v_exp_f32 v29, v29 clamp
    v_exp_f32 v30, v30 clamp
    v_exp_f32 v31, v31 clamp
    v_max_f32 v228, 0x358637bd, v228
    v_max_f32 v229, 0x358637bd, v229
    v_max_f32 v230, 0x358637bd, v230
    v_max_f32 v231, 0x358637bd, v231
    v_add_f32 v228, v228, v28
    v_add_f32 v229, v229, v29
    v_add_f32 v230, v230, v30
    v_add_f32 v231, v231, v31
    s_mov_b64 exec, -1
    v_cvt_pk_bf16_f32 v106, v228, v229
    v_cvt_pk_bf16_f32 v107, v230, v231
    v_cvt_pk_bf16_f32 v108, v200, v201
    v_cvt_pk_bf16_f32 v109, v202, v203
    v_cvt_pk_bf16_f32 v110, v232, v233
    v_cvt_pk_bf16_f32 v111, v234, v235
    v_cvt_pk_bf16_f32 v112, v204, v205
    v_cvt_pk_bf16_f32 v113, v206, v207
    v_cvt_pk_bf16_f32 v114, v236, v237
    v_cvt_pk_bf16_f32 v115, v238, v239
    v_mfma_f32_16x16x32_bf16 v[188:191], v[96:99], v[116:119], 0
    v_mfma_f32_16x16x32_bf16 v[192:195], v[100:103], v[116:119], 0
    v_mfma_f32_16x16x32_bf16 v[196:199], v[104:107], v[116:119], 0
    v_mfma_f32_16x16x32_bf16 v[200:203], v[96:99], v[104:107], 0
    v_mfma_f32_16x16x32_bf16 v[204:207], v[100:103], v[104:107], 0
    v_mfma_f32_16x16x32_bf16 v[220:223], v[96:99], v[108:111], 0
    v_mfma_f32_16x16x32_bf16 v[224:227], v[100:103], v[108:111], 0
    v_mfma_f32_16x16x32_bf16 v[228:231], v[104:107], v[108:111], 0
    v_mfma_f32_16x16x32_bf16 v[232:235], v[100:103], v[112:115], 0
    v_mfma_f32_16x16x32_bf16 v[236:239], v[104:107], v[112:115], 0
    v_mul_f32 v28, s98, v208
    v_mul_f32 v29, s98, v209
    v_mul_f32 v30, s98, v210
    v_mul_f32 v31, s98, v211
    v_exp_f32 v28, v28 clamp
    v_exp_f32 v29, v29 clamp
    v_exp_f32 v30, v30 clamp
    v_exp_f32 v31, v31 clamp
    v_max_f32 v208, 0x358637bd, v208
    v_max_f32 v209, 0x358637bd, v209
    v_max_f32 v210, 0x358637bd, v210
    v_max_f32 v211, 0x358637bd, v211
    v_add_f32 v208, v208, v28
    v_add_f32 v209, v209, v29
    v_add_f32 v210, v210, v30
    v_add_f32 v211, v211, v31
    v_cvt_pk_bf16_f32 v208, v208, v209
    v_cvt_pk_bf16_f32 v209, v210, v211
    ds_write_b64 v6, v[208:209] offset:0
    s_mov_b32 exec_lo, 0x10001
    s_mov_b32 exec_hi, 0x10001
    ds_write_b128 v5, v[188:191] offset:3920
    s_mov_b32 exec_lo, 0x10001
    s_mov_b32 exec_hi, 0x10001
    ds_write_b128 v5, v[192:195] offset:3984
    s_mov_b64 exec, 0x10001
    ds_write_b128 v5, v[196:199] offset:4048
    s_mov_b32 exec_lo, 0xff00ff00
    s_mov_b32 exec_hi, 0xff00ff00
    ds_write_b128 v5, v[200:203] offset:0
    s_mov_b64 exec, 0xff00
    ds_write_b128 v5, v[204:207] offset:64
    s_mov_b32 exec_lo, 0xfff0fff
    s_mov_b32 exec_hi, 0xfff0fff
    ds_write_b128 v5, v[220:223] offset:1280
    s_mov_b32 exec_lo, 0xf0000fff
    s_mov_b32 exec_hi, 0xf000f000
    ds_write_b128 v5, v[224:227] offset:1344
    s_mov_b32 exec_lo, 0xf000f000
    s_mov_b32 exec_hi, 0x0
    ds_write_b128 v5, v[228:231] offset:1408
    s_mov_b32 exec_lo, 0xffff0000
    s_mov_b32 exec_hi, 0xffffffff
    ds_write_b128 v5, v[232:235] offset:2624
    s_mov_b32 exec_lo, 0xffffffff
    s_mov_b32 exec_hi, 0x0
    ds_write_b128 v5, v[236:239] offset:2688
    s_mov_b64 exec, -1
    v_mul_f32 v28, s98, v240
    v_mul_f32 v29, s98, v241
    v_mul_f32 v30, s98, v242
    v_mul_f32 v31, s98, v243
    v_exp_f32 v28, v28 clamp
    v_exp_f32 v29, v29 clamp
    v_exp_f32 v30, v30 clamp
    v_exp_f32 v31, v31 clamp
    v_max_f32 v240, 0x358637bd, v240
    v_max_f32 v241, 0x358637bd, v241
    v_max_f32 v242, 0x358637bd, v242
    v_max_f32 v243, 0x358637bd, v243
    v_add_f32 v240, v240, v28
    v_add_f32 v241, v241, v29
    v_add_f32 v242, v242, v30
    v_add_f32 v243, v243, v31
    v_cvt_pk_bf16_f32 v240, v240, v241
    v_cvt_pk_bf16_f32 v241, v242, v243
    ds_write_b64 v6, v[240:241] offset:1280
    s_setprio 3
    s_waitcnt vmcnt(13) lgkmcnt(0)
    s_mov_b64 exec, 0x1
    ds_add_u32 v4, v53 offset:14344
    s_mov_b64 exec, -1
    s_cmp_eq_u32 s93, 0
    s_cbranch_scc1 Lpub_64
    s_call_b64 s[46:47], F_publish
Lpub_64:
    ds_read_b64 v[252:253], v4 offset:14344
    s_setprio 3
    s_mov_b32 s97, 44
    s_waitcnt lgkmcnt(0)
    v_cmp_gt_u32 vcc, s97, v252
    s_cbranch_vccz Lsbo_66
    s_call_b64 s[46:47], F_swspin
Lsbo_66:
    v_cmp_gt_u32 vcc, s48, v253
    s_cbranch_vccnz Lti_67
    s_call_b64 s[46:47], F_issue
Lti_67:
    ds_read_b128 v[96:99], v52 offset:47232
    ds_read_b128 v[100:103], v52 offset:50688
    ds_read_b128 v[104:107], v52 offset:54144
    ds_read_b128 v[108:111], v52 offset:57600
    v_min_u32 v52, 214, v0
    v_lshlrev_b32 v52, 4, v52
    s_lshl_b32 s97, s7, 4
    s_add_u32 s97, s97, s6
    s_mul_i32 s97, s97, 3456
    s_add_u32 s97, s97, 262144
    s_waitcnt lgkmcnt(0)
    v_pk_add_f32 v[96:97], v[96:97], v[100:101]
    v_pk_add_f32 v[104:105], v[104:105], v[108:109]
    v_pk_add_f32 v[98:99], v[98:99], v[102:103]
    v_pk_add_f32 v[106:107], v[106:107], v[110:111]
    v_pk_add_f32 v[96:97], v[96:97], v[104:105]
    v_pk_add_f32 v[98:99], v[98:99], v[106:107]
    v_min_u32 v96, -2, v96
    buffer_store_dwordx4 v[96:99], v52, s[56:59], s97 offen sc1
    s_mov_b64 exec, 0x1
    ds_add_u32 v4, v53 offset:14376
    s_mov_b64 exec, -1
    s_mov_b32 s98, 0x3fb8aa3b
    s_mov_b32 s99, 0x3fb8aa3b
    v_mul_f32 v28, s98, v212
    v_mul_f32 v29, s98, v213
    v_mul_f32 v30, s98, v214
    v_mul_f32 v31, s98, v215
    v_exp_f32 v28, v28 clamp
    v_exp_f32 v29, v29 clamp
    v_exp_f32 v30, v30 clamp
    v_exp_f32 v31, v31 clamp
    v_max_f32 v212, 0x358637bd, v212
    v_max_f32 v213, 0x358637bd, v213
    v_max_f32 v214, 0x358637bd, v214
    v_max_f32 v215, 0x358637bd, v215
    v_add_f32 v212, v212, v28
    v_add_f32 v213, v213, v29
    v_add_f32 v214, v214, v30
    v_add_f32 v215, v215, v31
    v_cvt_pk_bf16_f32 v212, v212, v213
    v_cvt_pk_bf16_f32 v213, v214, v215
    ds_write_b64 v6, v[212:213] offset:32
    v_mul_f32 v28, s98, v244
    v_mul_f32 v29, s98, v245
    v_mul_f32 v30, s98, v246
    v_mul_f32 v31, s98, v247
    v_exp_f32 v28, v28 clamp
    v_exp_f32 v29, v29 clamp
    v_exp_f32 v30, v30 clamp
    v_exp_f32 v31, v31 clamp
    v_max_f32 v244, 0x358637bd, v244
    v_max_f32 v245, 0x358637bd, v245
    v_max_f32 v246, 0x358637bd, v246
    v_max_f32 v247, 0x358637bd, v247
    v_add_f32 v244, v244, v28
    v_add_f32 v245, v245, v29
    v_add_f32 v246, v246, v30
    v_add_f32 v247, v247, v31
    v_cvt_pk_bf16_f32 v244, v244, v245
    v_cvt_pk_bf16_f32 v245, v246, v247
    ds_write_b64 v6, v[244:245] offset:1312
    v_mul_f32 v28, s98, v216
    v_mul_f32 v29, s98, v217
    v_mul_f32 v30, s98, v218
    v_mul_f32 v31, s98, v219
    v_exp_f32 v28, v28 clamp
    v_exp_f32 v29, v29 clamp
    v_exp_f32 v30, v30 clamp
    v_exp_f32 v31, v31 clamp
    v_max_f32 v216, 0x358637bd, v216
    v_max_f32 v217, 0x358637bd, v217
    v_max_f32 v218, 0x358637bd, v218
    v_max_f32 v219, 0x358637bd, v219
    v_add_f32 v216, v216, v28
    v_add_f32 v217, v217, v29
    v_add_f32 v218, v218, v30
    v_add_f32 v219, v219, v31
    v_cvt_pk_bf16_f32 v216, v216, v217
    v_cvt_pk_bf16_f32 v217, v218, v219
    s_mov_b32 exec_lo, 0xffffffff
    s_mov_b32 exec_hi, 0x0
    ds_write_b64 v6, v[216:217] offset:64
    s_mov_b64 exec, -1
    v_mul_f32 v28, s98, v248
    v_mul_f32 v29, s98, v249
    v_mul_f32 v30, s98, v250
    v_mul_f32 v31, s98, v251
    v_exp_f32 v28, v28 clamp
    v_exp_f32 v29, v29 clamp
    v_exp_f32 v30, v30 clamp
    v_exp_f32 v31, v31 clamp
    v_max_f32 v248, 0x358637bd, v248
    v_max_f32 v249, 0x358637bd, v249
    v_max_f32 v250, 0x358637bd, v250
    v_max_f32 v251, 0x358637bd, v251
    v_add_f32 v248, v248, v28
    v_add_f32 v249, v249, v29
    v_add_f32 v250, v250, v30
    v_add_f32 v251, v251, v31
    v_cvt_pk_bf16_f32 v248, v248, v249
    v_cvt_pk_bf16_f32 v249, v250, v251
    s_mov_b32 exec_lo, 0xffffffff
    s_mov_b32 exec_hi, 0x0
    ds_write_b64 v6, v[248:249] offset:1344
    s_mov_b64 exec, -1
    s_waitcnt vmcnt(1)
    s_cmp_eq_u32 s93, 0
    s_cbranch_scc1 Lpub_68
    s_call_b64 s[46:47], F_publish
Lpub_68:
    ds_read_b32 v253, v4 offset:14348
    s_waitcnt lgkmcnt(0)
    v_cmp_gt_u32 vcc, s48, v253
    s_cbranch_vccnz Lti_69
    s_call_b64 s[46:47], F_issue
Lti_69:
    s_setprio 0
    s_mov_b32 s96, 4000000
Lw8_70:
    ds_read_b32 v252, v4 offset:14376
    s_sub_u32 s96, s96, 1
    s_cmp_eq_u32 s96, 0
    s_waitcnt lgkmcnt(0)
    s_cbranch_scc1 Lw8o_71
    v_cmp_gt_u32 vcc, 4, v252
    s_cbranch_vccz Lw8o_71
    s_sleep 1
    s_branch Lw8_70
Lw8o_71:
    s_add_u32 s13, s84, s4
    s_and_b32 s13, s13, 3
    s_mul_i32 s13, s13, 12288
    s_add_u32 s14, s13, s11
    s_add_u32 s14, s14, 13402112
    s_add_u32 m0, s13, 14464
    s_nop 0
    buffer_load_dwordx4 v15, s[56:59], s14 offen sc1 lds
    s_add_u32 s14, s13, s11
    s_add_u32 s14, s14, 13403136
    s_add_u32 m0, s13, 15488
    s_nop 0
    buffer_load_dwordx4 v15, s[56:59], s14 offen sc1 lds
    s_add_u32 s14, s13, s11
    s_add_u32 s14, s14, 13404160
    s_add_u32 m0, s13, 16512
    s_nop 0
    buffer_load_dwordx4 v15, s[56:59], s14 offen sc1 lds
    s_add_u32 s14, s13, s11
    s_add_u32 s14, s14, 13405184
    s_add_u32 m0, s13, 17536
    s_nop 0
    buffer_load_dwordx4 v15, s[56:59], s14 offen sc1 lds
    s_add_u32 s14, s13, s11
    s_add_u32 s14, s14, 13406208
    s_add_u32 m0, s13, 18560
    s_nop 0
    buffer_load_dwordx4 v15, s[56:59], s14 offen sc1 lds
    s_add_u32 s14, s13, s11
    s_add_u32 s14, s14, 13407232
    s_add_u32 m0, s13, 19584
    s_nop 0
    buffer_load_dwordx4 v15, s[56:59], s14 offen sc1 lds
    s_add_u32 s14, s13, s11
    s_add_u32 s14, s14, 13408256
    s_add_u32 m0, s13, 20608
    s_nop 0
    buffer_load_dwordx4 v15, s[56:59], s14 offen sc1 lds
    s_add_u32 s14, s13, s11
    s_add_u32 s14, s14, 13409280
    s_add_u32 m0, s13, 21632
    s_nop 0
    buffer_load_dwordx4 v15, s[56:59], s14 offen sc1 lds
    s_add_u32 s14, s13, s11
    s_add_u32 s14, s14, 13410304
    s_add_u32 m0, s13, 22656
    s_nop 0
    buffer_load_dwordx4 v15, s[56:59], s14 offen sc1 lds
    s_add_u32 s14, s13, s11
    s_add_u32 s14, s14, 13411328
    s_add_u32 m0, s13, 23680
    s_nop 0
    buffer_load_dwordx4 v15, s[56:59], s14 offen sc1 lds
    s_add_u32 s14, s13, s11
    s_add_u32 s14, s14, 13412352
    s_add_u32 m0, s13, 24704
    s_nop 0
    buffer_load_dwordx4 v15, s[56:59], s14 offen sc1 lds
    s_add_u32 s14, s13, s11
    s_add_u32 s14, s14, 13413376
    s_add_u32 m0, s13, 25728
    s_nop 0
    buffer_load_dwordx4 v15, s[56:59], s14 offen sc1 lds
    s_mul_i32 s14, s86, 5120
    s_add_u32 s14, s14, s11
    s_add_u32 s14, s14, 12582912
    buffer_load_dwordx4 v[120:123], v15, s[56:59], s14 offen offset:3072 sc1
    s_mul_i32 s14, s86, 5120
    s_add_u32 s14, s14, s11
    s_add_u32 s14, s14, 12587008
    buffer_load_dwordx4 v[124:127], v15, s[56:59], s14 offen offset:0 sc1
    s_mul_i32 s14, s87, 5120
    s_add_u32 s14, s14, s11
    s_add_u32 s14, s14, 12582912
    buffer_load_dwordx4 v[128:131], v15, s[56:59], s14 offen offset:0 sc1
    s_mul_i32 s14, s87, 5120
    s_add_u32 s14, s14, s11
    s_add_u32 s14, s14, 12582912
    buffer_load_dwordx4 v[132:135], v15, s[56:59], s14 offen offset:1024 sc1
    s_mul_i32 s14, s87, 5120
    s_add_u32 s14, s14, s11
    s_add_u32 s14, s14, 12582912
    buffer_load_dwordx4 v[136:139], v15, s[56:59], s14 offen offset:2048 sc1
    s_mul_i32 s14, s87, 5120
    s_add_u32 s14, s14, s11
    s_add_u32 s14, s14, 12582912
    buffer_load_dwordx4 v[140:143], v15, s[56:59], s14 offen offset:3072 sc1
    s_mul_i32 s14, s87, 5120
    s_add_u32 s14, s14, s11
    s_add_u32 s14, s14, 12587008
    buffer_load_dwordx4 v[144:147], v15, s[56:59], s14 offen offset:0 sc1
    s_mul_i32 s14, s89, 5120
    s_add_u32 s14, s14, s11
    s_add_u32 s14, s14, 12582912
    buffer_load_dwordx4 v[148:151], v15, s[56:59], s14 offen offset:0 sc1
    s_waitcnt vmcnt(20)
    s_cmp_eq_u32 s93, 0
    s_cbranch_scc1 Lpub_72
    s_call_b64 s[46:47], F_publish
Lpub_72:
    ds_read_b32 v253, v4 offset:14348
    s_waitcnt lgkmcnt(0)
    v_cmp_gt_u32 vcc, s48, v253
    s_cbranch_vccnz Lti_73
    s_call_b64 s[46:47], F_issue
Lti_73:
    v_lshrrev_b32 v5, 4, v52
    v_mul_u32_u24 v6, 205, v5
    v_lshrrev_b32 v6, 10, v6
    v_mul_u32_u24 v6, 24, v6
    v_lshl_add_u32 v5, v5, 3, v6
    s_mov_b32 s96, 200000
Lkvg_74:
    s_xor_b32 s9, s7, 1
    s_mul_i32 s9, s9, 55296
    s_add_u32 s9, s9, 262144
    buffer_load_dwordx4 v[188:191], v52, s[56:59], s9 offen sc1
    buffer_load_dwordx4 v[192:195], v52, s[56:59], s9 offen offset:3456 sc1
    s_add_u32 s9, s9, 6912
    buffer_load_dwordx4 v[196:199], v52, s[56:59], s9 offen sc1
    buffer_load_dwordx4 v[200:203], v52, s[56:59], s9 offen offset:3456 sc1
    s_add_u32 s9, s9, 6912
    buffer_load_dwordx4 v[204:207], v52, s[56:59], s9 offen sc1
    buffer_load_dwordx4 v[208:211], v52, s[56:59], s9 offen offset:3456 sc1
    s_add_u32 s9, s9, 6912
    buffer_load_dwordx4 v[212:215], v52, s[56:59], s9 offen sc1
    buffer_load_dwordx4 v[216:219], v52, s[56:59], s9 offen offset:3456 sc1
    s_add_u32 s9, s9, 6912
    buffer_load_dwordx4 v[220:223], v52, s[56:59], s9 offen sc1
    buffer_load_dwordx4 v[224:227], v52, s[56:59], s9 offen offset:3456 sc1
    s_add_u32 s9, s9, 6912
    buffer_load_dwordx4 v[228:231], v52, s[56:59], s9 offen sc1
    buffer_load_dwordx4 v[232:235], v52, s[56:59], s9 offen offset:3456 sc1
    s_add_u32 s9, s9, 6912
    buffer_load_dwordx4 v[236:239], v52, s[56:59], s9 offen sc1
    buffer_load_dwordx4 v[240:243], v52, s[56:59], s9 offen offset:3456 sc1
    s_add_u32 s9, s9, 6912
    buffer_load_dwordx4 v[244:247], v52, s[56:59], s9 offen sc1
    buffer_load_dwordx4 v[248:251], v52, s[56:59], s9 offen offset:3456 sc1
    s_add_u32 s9, s9, 6912
    s_waitcnt vmcnt(0)
    s_setprio 3
    s_cmp_eq_u32 s93, 0
    s_cbranch_scc1 Lpub_76
    s_call_b64 s[46:47], F_publish
Lpub_76:
    v_max_u32 v7, v188, v192
    v_max3_u32 v7, v196, v200, v7
    v_max3_u32 v7, v204, v208, v7
    v_max3_u32 v7, v212, v216, v7
    v_max3_u32 v7, v220, v224, v7
    v_max3_u32 v7, v228, v232, v7
    v_max3_u32 v7, v236, v240, v7
    v_max3_u32 v7, v244, v248, v7
    v_cmp_eq_u32 vcc, -1, v7
    s_cbranch_vccz Lkvgo_75
    s_setprio 0
    s_cmp_eq_u32 s93, 0
    s_cbranch_scc1 Lpub_77
    s_call_b64 s[46:47], F_publish
Lpub_77:
    ds_read_b32 v253, v4 offset:14348
    s_waitcnt lgkmcnt(0)
    v_cmp_gt_u32 vcc, s48, v253
    s_cbranch_vccnz Lti_78
    s_call_b64 s[46:47], F_issue
Lti_78:
    s_sub_u32 s96, s96, 1
    s_cmp_lg_u32 s96, 0
    s_cbranch_scc1 Lkvg_74
Lkvgo_75:
    v_pk_add_f32 v[188:189], v[188:189], v[220:221]
    v_pk_add_f32 v[190:191], v[190:191], v[222:223]
    v_pk_add_f32 v[192:193], v[192:193], v[224:225]
    v_pk_add_f32 v[194:195], v[194:195], v[226:227]
    v_pk_add_f32 v[196:197], v[196:197], v[228:229]
    v_pk_add_f32 v[198:199], v[198:199], v[230:231]
    v_pk_add_f32 v[200:201], v[200:201], v[232:233]
    v_pk_add_f32 v[202:203], v[202:203], v[234:235]
    v_pk_add_f32 v[204:205], v[204:205], v[236:237]
    v_pk_add_f32 v[206:207], v[206:207], v[238:239]
    v_pk_add_f32 v[208:209], v[208:209], v[240:241]
    v_pk_add_f32 v[210:211], v[210:211], v[242:243]
    v_pk_add_f32 v[212:213], v[212:213], v[244:245]
    v_pk_add_f32 v[214:215], v[214:215], v[246:247]
    v_pk_add_f32 v[216:217], v[216:217], v[248:249]
    v_pk_add_f32 v[218:219], v[218:219], v[250:251]
    v_pk_add_f32 v[188:189], v[188:189], v[204:205]
    v_pk_add_f32 v[190:191], v[190:191], v[206:207]
    v_pk_add_f32 v[192:193], v[192:193], v[208:209]
    v_pk_add_f32 v[194:195], v[194:195], v[210:211]
    v_pk_add_f32 v[196:197], v[196:197], v[212:213]
    v_pk_add_f32 v[198:199], v[198:199], v[214:215]
    v_pk_add_f32 v[200:201], v[200:201], v[216:217]
    v_pk_add_f32 v[202:203], v[202:203], v[218:219]
    v_pk_add_f32 v[188:189], v[188:189], v[196:197]
    v_pk_add_f32 v[190:191], v[190:191], v[198:199]
    v_pk_add_f32 v[192:193], v[192:193], v[200:201]
    v_pk_add_f32 v[194:195], v[194:195], v[202:203]
    v_pk_add_f32 v[188:189], v[188:189], v[192:193]
    v_pk_add_f32 v[190:191], v[190:191], v[194:195]
    v_cvt_pk_bf16_f32 v188, v188, v189
    v_cvt_pk_bf16_f32 v189, v190, v191
    ds_write_b64 v5, v[188:189] offset:10240
    s_setprio 3
    s_waitcnt vmcnt(0) lgkmcnt(0)
    s_mov_b64 exec, 0x1
    ds_add_u32 v4, v53 offset:14344
    s_mov_b64 exec, -1
    s_cmp_eq_u32 s93, 0
    s_cbranch_scc1 Lpub_79
    s_call_b64 s[46:47], F_publish
Lpub_79:
    ds_read_b64 v[252:253], v4 offset:14344
    s_setprio 3
    s_mov_b32 s97, 48
    s_waitcnt lgkmcnt(0)
    v_cmp_gt_u32 vcc, s97, v252
    s_cbranch_vccz Lsbo_81
    s_call_b64 s[46:47], F_swspin
Lsbo_81:
    v_cmp_gt_u32 vcc, s48, v253
    s_cbranch_vccnz Lti_82
    s_call_b64 s[46:47], F_issue
Lti_82:
    s_mul_i32 s97, s84, 2560
    v_mul_u32_u24 v5, 80, v2
    v_lshlrev_b32 v8, 4, v3
    v_add3_u32 v6, s97, v5, v8
    v_lshl_add_u32 v7, v2, 6, v8
    ds_read_b128 v[96:99], v7 offset:10240
    ds_read_b128 v[100:103], v7 offset:11264
    ds_read_b128 v[104:107], v8 offset:12864
    ds_read_b128 v[108:111], v7 offset:11584
    ds_read_b128 v[112:115], v7 offset:12608
    ds_read_b128 v[116:119], v8 offset:12928
    ds_read_b64 v[16:17], v6 offset:0
    ds_read_b64 v[18:19], v6 offset:8
    ds_read_b64 v[20:21], v6 offset:40
    ds_read_b64 v[22:23], v6 offset:48
    ds_read_b64 v[24:25], v6 offset:1280
    ds_read_b64 v[26:27], v6 offset:1288
    ds_read_b64 v[28:29], v6 offset:1320
    ds_read_b64 v[30:31], v6 offset:1328
    s_waitcnt lgkmcnt(0)
    v_mfma_f32_16x16x32_bf16 v[196:199], v[104:107], v[16:19], 0
    v_mfma_f32_16x16x32_bf16 v[208:211], v[116:119], v[20:23], 0
    v_mfma_f32_16x16x32_bf16 v[188:191], v[96:99], v[16:19], 0
    v_mfma_f32_16x16x32_bf16 v[200:203], v[108:111], v[20:23], 0
    v_mfma_f32_16x16x32_bf16 v[192:195], v[100:103], v[16:19], 0
    v_mfma_f32_16x16x32_bf16 v[204:207], v[112:115], v[20:23], 0
    v_mfma_f32_16x16x32_bf16 v[220:223], v[104:107], v[24:27], 0
    v_mfma_f32_16x16x32_bf16 v[232:235], v[116:119], v[28:31], 0
    v_mfma_f32_16x16x32_bf16 v[212:215], v[96:99], v[24:27], 0
    v_mfma_f32_16x16x32_bf16 v[224:227], v[108:111], v[28:31], 0
    v_mfma_f32_16x16x32_bf16 v[216:219], v[100:103], v[24:27], 0
    v_mfma_f32_16x16x32_bf16 v[228:231], v[112:115], v[28:31], 0
    v_add_f32 v236, 0x358637bd, v196
    v_add_f32 v238, 0x358637bd, v208
    v_rcp_f32 v236, v236
    v_rcp_f32 v238, v238
    v_pk_mul_f32 v[188:189], v[188:189], v[236:237] op_sel_hi:[1,0]
    v_pk_mul_f32 v[190:191], v[190:191], v[236:237] op_sel_hi:[1,0]
    v_pk_mul_f32 v[192:193], v[192:193], v[236:237] op_sel_hi:[1,0]
    v_pk_mul_f32 v[194:195], v[194:195], v[236:237] op_sel_hi:[1,0]
    v_cvt_pk_bf16_f32 v32, v188, v189
    v_cvt_pk_bf16_f32 v33, v190, v191
    v_cvt_pk_bf16_f32 v36, v192, v193
    v_cvt_pk_bf16_f32 v37, v194, v195
    v_pk_mul_f32 v[200:201], v[200:201], v[238:239] op_sel_hi:[1,0]
    v_pk_mul_f32 v[202:203], v[202:203], v[238:239] op_sel_hi:[1,0]
    v_pk_mul_f32 v[204:205], v[204:205], v[238:239] op_sel_hi:[1,0]
    v_pk_mul_f32 v[206:207], v[206:207], v[238:239] op_sel_hi:[1,0]
    v_cvt_pk_bf16_f32 v34, v200, v201
    v_cvt_pk_bf16_f32 v35, v202, v203
    v_cvt_pk_bf16_f32 v38, v204, v205
    v_cvt_pk_bf16_f32 v39, v206, v207
    v_min_u32 v32, -2, v32
    v_min_u32 v36, -2, v36
    buffer_store_dwordx4 v[32:35], v49, s[56:59], s44 offen sc1
    s_mov_b64 exec, 0xffff
    buffer_store_dwordx4 v[36:39], v15, s[56:59], s45 offen sc1
    s_mov_b64 exec, -1
    v_add_f32 v236, 0x358637bd, v220
    v_add_f32 v238, 0x358637bd, v232
    v_rcp_f32 v236, v236
    v_rcp_f32 v238, v238
    v_pk_mul_f32 v[212:213], v[212:213], v[236:237] op_sel_hi:[1,0]
    v_pk_mul_f32 v[214:215], v[214:215], v[236:237] op_sel_hi:[1,0]
    v_pk_mul_f32 v[216:217], v[216:217], v[236:237] op_sel_hi:[1,0]
    v_pk_mul_f32 v[218:219], v[218:219], v[236:237] op_sel_hi:[1,0]
    v_cvt_pk_bf16_f32 v40, v212, v213
    v_cvt_pk_bf16_f32 v41, v214, v215
    v_cvt_pk_bf16_f32 v44, v216, v217
    v_cvt_pk_bf16_f32 v45, v218, v219
    v_pk_mul_f32 v[224:225], v[224:225], v[238:239] op_sel_hi:[1,0]
    v_pk_mul_f32 v[226:227], v[226:227], v[238:239] op_sel_hi:[1,0]
    v_pk_mul_f32 v[228:229], v[228:229], v[238:239] op_sel_hi:[1,0]
    v_pk_mul_f32 v[230:231], v[230:231], v[238:239] op_sel_hi:[1,0]
    v_cvt_pk_bf16_f32 v42, v224, v225
    v_cvt_pk_bf16_f32 v43, v226, v227
    v_cvt_pk_bf16_f32 v46, v228, v229
    v_cvt_pk_bf16_f32 v47, v230, v231
    v_min_u32 v40, -2, v40
    v_min_u32 v44, -2, v44
    buffer_store_dwordx4 v[40:43], v49, s[56:59], s44 offen offset:1024 sc1
    s_mov_b64 exec, 0xffff
    buffer_store_dwordx4 v[44:47], v15, s[56:59], s45 offen offset:1024 sc1
    s_mov_b64 exec, -1
    s_setprio 0
    s_mov_b64 exec, 0x1
    ds_add_u32 v4, v53 offset:14344
    s_mov_b64 exec, -1
    s_cmp_lg_u32 s3, 1
    s_cbranch_scc1 Lw_83
    s_lshr_b32 s97, s2, 3
    s_lshl_b32 s97, s97, 11
    v_lshl_add_u32 v54, v1, 5, s97
    v_min_u32 v54, CODE_BYTES-64, v54
    global_load_dword v54, v54, s[94:95]
Lw_83:
    s_mul_i32 s14, s89, 5120
    s_add_u32 s14, s14, s11
    s_add_u32 s14, s14, 12582912
    buffer_load_dwordx4 v[152:155], v15, s[56:59], s14 offen offset:1024 sc1
    s_mul_i32 s14, s89, 5120
    s_add_u32 s14, s14, s11
    s_add_u32 s14, s14, 12582912
    buffer_load_dwordx4 v[156:159], v15, s[56:59], s14 offen offset:2048 sc1
    s_mul_i32 s14, s89, 5120
    s_add_u32 s14, s14, s11
    s_add_u32 s14, s14, 12582912
    buffer_load_dwordx4 v[160:163], v15, s[56:59], s14 offen offset:3072 sc1
    s_mul_i32 s14, s89, 5120
    s_add_u32 s14, s14, s11
    s_add_u32 s14, s14, 12587008
    buffer_load_dwordx4 v[164:167], v15, s[56:59], s14 offen offset:0 sc1
    s_mul_i32 s14, s92, 5120
    s_add_u32 s14, s14, s11
    s_add_u32 s14, s14, 12582912
    buffer_load_dwordx4 v[168:171], v15, s[56:59], s14 offen offset:0 sc1
    s_mul_i32 s14, s92, 5120
    s_add_u32 s14, s14, s11
    s_add_u32 s14, s14, 12582912
    buffer_load_dwordx4 v[172:175], v15, s[56:59], s14 offen offset:1024 sc1
    s_mul_i32 s14, s92, 5120
    s_add_u32 s14, s14, s11
    s_add_u32 s14, s14, 12582912
    buffer_load_dwordx4 v[176:179], v15, s[56:59], s14 offen offset:2048 sc1
    s_mul_i32 s14, s92, 5120
    s_add_u32 s14, s14, s11
    s_add_u32 s14, s14, 12582912
    buffer_load_dwordx4 v[180:183], v15, s[56:59], s14 offen offset:3072 sc1
    s_mul_i32 s14, s92, 5120
    s_add_u32 s14, s14, s11
    s_add_u32 s14, s14, 12587008
    buffer_load_dwordx4 v[184:187], v15, s[56:59], s14 offen offset:0 sc1
L_abl_serve:
    s_mov_b32 s96, 4000000
Lsv_84:
    s_waitcnt vmcnt(0)
    s_cmp_eq_u32 s93, 0
    s_cbranch_scc1 Lpub_86
    s_call_b64 s[46:47], F_publish
Lpub_86:
    ds_read_b32 v253, v4 offset:14348
    s_waitcnt lgkmcnt(0)
    v_cmp_gt_u32 vcc, s48, v253
    s_cbranch_vccnz Lti_87
    s_call_b64 s[46:47], F_issue
Lti_87:
    s_sub_u32 s96, s96, 1
    s_cmp_eq_u32 s96, 0
    s_cbranch_scc1 Lsvo_85
    s_cmp_ge_u32 s55, 8
    s_cbranch_scc1 Lsvo_85
    s_sleep 2
    s_branch Lsv_84
Lsvo_85:
    s_mul_i32 s97, s4, 81920
    s_add_u32 s97, s97, 2097152
    s_lshl_b32 s85, s85, 12
    s_add_u32 s85, s85, s97
    s_lshl_b32 s86, s86, 12
    s_add_u32 s86, s86, s97
    s_lshl_b32 s87, s87, 12
    s_add_u32 s87, s87, s97
    s_lshl_b32 s89, s89, 12
    s_add_u32 s89, s89, s97
    s_lshl_b32 s92, s92, 12
    s_add_u32 s92, s92, s97
    s_add_u32 s97, s84, 3
    s_and_b32 s97, s97, 3
    s_lshl_b32 s90, s97, 10
    s_mul_i32 s97, s97, 5120
    s_add_u32 s97, s97, 121600
    v_add_u32 v48, s97, v15
    s_add_u32 s97, s84, 2
    s_and_b32 s97, s97, 3
    s_lshl_b32 s91, s97, 10
    s_mul_i32 s97, s97, 5120
    s_add_u32 s97, s97, 142080
    v_add_u32 v49, s97, v15
    s_add_u32 s97, s84, 1
    s_and_b32 s97, s97, 3
    s_lshl_b32 s88, s97, 10
    s_mul_i32 s97, s97, 5120
    s_add_u32 s97, s97, 14464
    v_add_u32 v50, s97, v15
    s_add_u32 s97, s84, 0
    s_and_b32 s97, s97, 3
    s_lshl_b32 s15, s97, 10
    s_mul_i32 s97, s84, 5120
    v_add_u32 v10, s97, v15
    v_add_u32 v51, 121600, v10
    s_add_u32 s99, s97, 121600
    v_mul_u32_u24 v6, 160, v2
    v_lshl_add_u32 v6, v3, 3, v6
    v_add_u32 v6, s99, v6
    v_add_u32 v9, s99, v15
    s_mov_b32 s12, 2400
    v_add_u32 v7, 0, v1
    v_mul_u32_u24 v8, 6554, v7
    v_lshrrev_b32 v8, 16, v8
    v_lshlrev_b32 v7, 4, v7
    v_mad_u32_u24 v11, v8, s12, v7
    v_add_u32 v7, 64, v1
    v_mul_u32_u24 v8, 6554, v7
    v_lshrrev_b32 v8, 16, v8
    v_lshlrev_b32 v7, 4, v7
    v_mad_u32_u24 v12, v8, s12, v7
    v_add_u32 v7, 128, v1
    v_mul_u32_u24 v8, 6554, v7
    v_lshrrev_b32 v8, 16, v8
    v_lshlrev_b32 v7, 4, v7
    v_mad_u32_u24 v13, v8, s12, v7
    s_lshl_b32 s10, s4, 2
    s_add_u32 s10, s10, s84
    s_mul_i32 s10, s10, 40960
    s_mul_i32 s98, s5, 160
    s_add_u32 s10, s10, s98
    s_mov_b32 s96, 4000000
Lw8_88:
    ds_read_b32 v252, v4 offset:14360
    s_sub_u32 s96, s96, 1
    s_cmp_eq_u32 s96, 0
    s_waitcnt lgkmcnt(0)
    s_cbranch_scc1 Lw8o_89
    v_cmp_gt_u32 vcc, 4, v252
    s_cbranch_vccz Lw8o_89
    s_sleep 1
    s_branch Lw8_88
Lw8o_89:
    s_setprio 3
    s_add_u32 s98, s85, s90
    buffer_load_dwordx4 v[188:191], v15, s[56:59], s98 offen sc1
    s_add_u32 s98, s86, s90
    buffer_load_dwordx4 v[192:195], v15, s[56:59], s98 offen sc1
    s_add_u32 s98, s87, s90
    buffer_load_dwordx4 v[196:199], v15, s[56:59], s98 offen sc1
    s_add_u32 s98, s89, s90
    buffer_load_dwordx4 v[200:203], v15, s[56:59], s98 offen sc1
    s_add_u32 s98, s92, s90
    buffer_load_dwordx4 v[204:207], v15, s[56:59], s98 offen sc1
    s_add_u32 s98, s85, s91
    buffer_load_dwordx4 v[208:211], v15, s[56:59], s98 offen sc1
    s_add_u32 s98, s86, s91
    buffer_load_dwordx4 v[212:215], v15, s[56:59], s98 offen sc1
    s_add_u32 s98, s87, s91
    buffer_load_dwordx4 v[216:219], v15, s[56:59], s98 offen sc1
    s_add_u32 s98, s89, s91
    buffer_load_dwordx4 v[220:223], v15, s[56:59], s98 offen sc1
    s_add_u32 s98, s92, s91
    buffer_load_dwordx4 v[224:227], v15, s[56:59], s98 offen sc1
    s_waitcnt vmcnt(5)
    v_max3_u32 v5, v188, v192, v196
    v_max3_u32 v5, v200, v204, v5
    v_cmp_eq_u32 vcc, -1, v5
    s_cbranch_vccnz Lxr_90
Lxb_91:
    s_add_u32 s98, s85, s88
    buffer_load_dwordx4 v[228:231], v15, s[56:59], s98 offen sc1
    v_mfma_f32_16x16x32_bf16 v[16:19], v[64:67], v[188:191], 0
    v_mfma_f32_16x16x32_bf16 v[20:23], v[68:71], v[188:191], 0
    v_mfma_f32_16x16x32_bf16 v[24:27], v[72:75], v[188:191], 0
    v_mfma_f32_16x16x32_bf16 v[28:31], v[76:79], v[188:191], 0
    v_mfma_f32_16x16x32_bf16 v[32:35], v[80:83], v[188:191], 0
    s_add_u32 s98, s86, s88
    buffer_load_dwordx4 v[232:235], v15, s[56:59], s98 offen sc1
    v_mfma_f32_16x16x32_bf16 v[16:19], v[84:87], v[192:195], v[16:19]
    v_mfma_f32_16x16x32_bf16 v[20:23], v[88:91], v[192:195], v[20:23]
    v_mfma_f32_16x16x32_bf16 v[24:27], v[92:95], v[192:195], v[24:27]
    v_mfma_f32_16x16x32_bf16 v[28:31], v[120:123], v[192:195], v[28:31]
    v_mfma_f32_16x16x32_bf16 v[32:35], v[124:127], v[192:195], v[32:35]
    s_add_u32 s98, s87, s88
    buffer_load_dwordx4 v[236:239], v15, s[56:59], s98 offen sc1
    v_mfma_f32_16x16x32_bf16 v[16:19], v[128:131], v[196:199], v[16:19]
    v_mfma_f32_16x16x32_bf16 v[20:23], v[132:135], v[196:199], v[20:23]
    v_mfma_f32_16x16x32_bf16 v[24:27], v[136:139], v[196:199], v[24:27]
    v_mfma_f32_16x16x32_bf16 v[28:31], v[140:143], v[196:199], v[28:31]
    v_mfma_f32_16x16x32_bf16 v[32:35], v[144:147], v[196:199], v[32:35]
    s_add_u32 s98, s89, s88
    buffer_load_dwordx4 v[240:243], v15, s[56:59], s98 offen sc1
    v_mfma_f32_16x16x32_bf16 v[16:19], v[148:151], v[200:203], v[16:19]
    v_mfma_f32_16x16x32_bf16 v[20:23], v[152:155], v[200:203], v[20:23]
    v_mfma_f32_16x16x32_bf16 v[24:27], v[156:159], v[200:203], v[24:27]
    v_mfma_f32_16x16x32_bf16 v[28:31], v[160:163], v[200:203], v[28:31]
    v_mfma_f32_16x16x32_bf16 v[32:35], v[164:167], v[200:203], v[32:35]
    s_add_u32 s98, s92, s88
    buffer_load_dwordx4 v[244:247], v15, s[56:59], s98 offen sc1
    v_mfma_f32_16x16x32_bf16 v[16:19], v[168:171], v[204:207], v[16:19]
    v_mfma_f32_16x16x32_bf16 v[20:23], v[172:175], v[204:207], v[20:23]
    v_mfma_f32_16x16x32_bf16 v[24:27], v[176:179], v[204:207], v[24:27]
    v_mfma_f32_16x16x32_bf16 v[28:31], v[180:183], v[204:207], v[28:31]
    v_mfma_f32_16x16x32_bf16 v[32:35], v[184:187], v[204:207], v[32:35]
    s_waitcnt vmcnt(5)
    v_max3_u32 v5, v208, v212, v216
    v_max3_u32 v5, v220, v224, v5
    v_cmp_eq_u32 vcc, -1, v5
    s_cbranch_vccnz Lxr_92
Lxb_93:
    s_add_u32 s98, s85, s15
    buffer_load_dwordx4 v[248:251], v15, s[56:59], s98 offen sc1
    v_mfma_f32_16x16x32_bf16 v[36:39], v[64:67], v[208:211], 0
    v_mfma_f32_16x16x32_bf16 v[40:43], v[68:71], v[208:211], 0
    v_mfma_f32_16x16x32_bf16 v[44:47], v[72:75], v[208:211], 0
    v_mfma_f32_16x16x32_bf16 v[56:59], v[76:79], v[208:211], 0
    v_mfma_f32_16x16x32_bf16 v[60:63], v[80:83], v[208:211], 0
    s_add_u32 s98, s86, s15
    buffer_load_dwordx4 v[96:99], v15, s[56:59], s98 offen sc1
    v_mfma_f32_16x16x32_bf16 v[36:39], v[84:87], v[212:215], v[36:39]
    ds_write_b128 v48, v[16:19] offset:0
    v_mfma_f32_16x16x32_bf16 v[40:43], v[88:91], v[212:215], v[40:43]
    ds_write_b128 v48, v[20:23] offset:1024
    v_mfma_f32_16x16x32_bf16 v[44:47], v[92:95], v[212:215], v[44:47]
    ds_write_b128 v48, v[24:27] offset:2048
    v_mfma_f32_16x16x32_bf16 v[56:59], v[120:123], v[212:215], v[56:59]
    ds_write_b128 v48, v[28:31] offset:3072
    v_mfma_f32_16x16x32_bf16 v[60:63], v[124:127], v[212:215], v[60:63]
    ds_write_b128 v48, v[32:35] offset:4096
    s_add_u32 s98, s87, s15
    buffer_load_dwordx4 v[100:103], v15, s[56:59], s98 offen sc1
    v_mfma_f32_16x16x32_bf16 v[36:39], v[128:131], v[216:219], v[36:39]
    v_mfma_f32_16x16x32_bf16 v[40:43], v[132:135], v[216:219], v[40:43]
    v_mfma_f32_16x16x32_bf16 v[44:47], v[136:139], v[216:219], v[44:47]
    v_mfma_f32_16x16x32_bf16 v[56:59], v[140:143], v[216:219], v[56:59]
    v_mfma_f32_16x16x32_bf16 v[60:63], v[144:147], v[216:219], v[60:63]
    s_add_u32 s98, s89, s15
    buffer_load_dwordx4 v[104:107], v15, s[56:59], s98 offen sc1
    v_mfma_f32_16x16x32_bf16 v[36:39], v[148:151], v[220:223], v[36:39]
    v_mfma_f32_16x16x32_bf16 v[40:43], v[152:155], v[220:223], v[40:43]
    v_mfma_f32_16x16x32_bf16 v[44:47], v[156:159], v[220:223], v[44:47]
    v_mfma_f32_16x16x32_bf16 v[56:59], v[160:163], v[220:223], v[56:59]
    v_mfma_f32_16x16x32_bf16 v[60:63], v[164:167], v[220:223], v[60:63]
    s_add_u32 s98, s92, s15
    buffer_load_dwordx4 v[108:111], v15, s[56:59], s98 offen sc1
    v_mfma_f32_16x16x32_bf16 v[36:39], v[168:171], v[224:227], v[36:39]
    v_mfma_f32_16x16x32_bf16 v[40:43], v[172:175], v[224:227], v[40:43]
    v_mfma_f32_16x16x32_bf16 v[44:47], v[176:179], v[224:227], v[44:47]
    v_mfma_f32_16x16x32_bf16 v[56:59], v[180:183], v[224:227], v[56:59]
    v_mfma_f32_16x16x32_bf16 v[60:63], v[184:187], v[224:227], v[60:63]
    s_waitcnt vmcnt(5)
    v_max3_u32 v5, v228, v232, v236
    v_max3_u32 v5, v240, v244, v5
    v_cmp_eq_u32 vcc, -1, v5
    s_cbranch_vccnz Lxr_94
Lxb_95:
    v_mfma_f32_16x16x32_bf16 v[16:19], v[64:67], v[228:231], 0
    v_mfma_f32_16x16x32_bf16 v[20:23], v[68:71], v[228:231], 0
    v_mfma_f32_16x16x32_bf16 v[24:27], v[72:75], v[228:231], 0
    v_mfma_f32_16x16x32_bf16 v[28:31], v[76:79], v[228:231], 0
    v_mfma_f32_16x16x32_bf16 v[32:35], v[80:83], v[228:231], 0
    v_mfma_f32_16x16x32_bf16 v[16:19], v[84:87], v[232:235], v[16:19]
    ds_write_b128 v49, v[36:39] offset:0
    v_mfma_f32_16x16x32_bf16 v[20:23], v[88:91], v[232:235], v[20:23]
    ds_write_b128 v49, v[40:43] offset:1024
    v_mfma_f32_16x16x32_bf16 v[24:27], v[92:95], v[232:235], v[24:27]
    ds_write_b128 v49, v[44:47] offset:2048
    v_mfma_f32_16x16x32_bf16 v[28:31], v[120:123], v[232:235], v[28:31]
    ds_write_b128 v49, v[56:59] offset:3072
    v_mfma_f32_16x16x32_bf16 v[32:35], v[124:127], v[232:235], v[32:35]
    ds_write_b128 v49, v[60:63] offset:4096
    v_mfma_f32_16x16x32_bf16 v[16:19], v[128:131], v[236:239], v[16:19]
    v_mfma_f32_16x16x32_bf16 v[20:23], v[132:135], v[236:239], v[20:23]
    v_mfma_f32_16x16x32_bf16 v[24:27], v[136:139], v[236:239], v[24:27]
    v_mfma_f32_16x16x32_bf16 v[28:31], v[140:143], v[236:239], v[28:31]
    v_mfma_f32_16x16x32_bf16 v[32:35], v[144:147], v[236:239], v[32:35]
    v_mfma_f32_16x16x32_bf16 v[16:19], v[148:151], v[240:243], v[16:19]
    v_mfma_f32_16x16x32_bf16 v[20:23], v[152:155], v[240:243], v[20:23]
    v_mfma_f32_16x16x32_bf16 v[24:27], v[156:159], v[240:243], v[24:27]
    v_mfma_f32_16x16x32_bf16 v[28:31], v[160:163], v[240:243], v[28:31]
    v_mfma_f32_16x16x32_bf16 v[32:35], v[164:167], v[240:243], v[32:35]
    v_mfma_f32_16x16x32_bf16 v[16:19], v[168:171], v[244:247], v[16:19]
    v_mfma_f32_16x16x32_bf16 v[20:23], v[172:175], v[244:247], v[20:23]
    v_mfma_f32_16x16x32_bf16 v[24:27], v[176:179], v[244:247], v[24:27]
    v_mfma_f32_16x16x32_bf16 v[28:31], v[180:183], v[244:247], v[28:31]
    v_mfma_f32_16x16x32_bf16 v[32:35], v[184:187], v[244:247], v[32:35]
    s_waitcnt vmcnt(0)
    v_max3_u32 v5, v248, v96, v100
    v_max3_u32 v5, v104, v108, v5
    v_cmp_eq_u32 vcc, -1, v5
    s_cbranch_vccnz Lxr_96
Lxb_97:
    v_mfma_f32_16x16x32_bf16 v[36:39], v[64:67], v[248:251], 0
    v_mfma_f32_16x16x32_bf16 v[40:43], v[68:71], v[248:251], 0
    v_mfma_f32_16x16x32_bf16 v[44:47], v[72:75], v[248:251], 0
    v_mfma_f32_16x16x32_bf16 v[56:59], v[76:79], v[248:251], 0
    v_mfma_f32_16x16x32_bf16 v[60:63], v[80:83], v[248:251], 0
    v_mfma_f32_16x16x32_bf16 v[36:39], v[84:87], v[96:99], v[36:39]
    s_mov_b32 s96, 4000000
Lw8_98:
    ds_read_b32 v252, v4 offset:14368
    s_sub_u32 s96, s96, 1
    s_cmp_eq_u32 s96, 0
    s_waitcnt lgkmcnt(0)
    s_cbranch_scc1 Lw8o_99
    v_cmp_gt_u32 vcc, 4, v252
    s_cbranch_vccz Lw8o_99
    s_sleep 1
    s_branch Lw8_98
Lw8o_99:
    ds_write_b128 v50, v[16:19] offset:0
    v_mfma_f32_16x16x32_bf16 v[40:43], v[88:91], v[96:99], v[40:43]
    ds_write_b128 v50, v[20:23] offset:1024
    v_mfma_f32_16x16x32_bf16 v[44:47], v[92:95], v[96:99], v[44:47]
    ds_write_b128 v50, v[24:27] offset:2048
    v_mfma_f32_16x16x32_bf16 v[56:59], v[120:123], v[96:99], v[56:59]
    ds_write_b128 v50, v[28:31] offset:3072
    v_mfma_f32_16x16x32_bf16 v[60:63], v[124:127], v[96:99], v[60:63]
    ds_write_b128 v50, v[32:35] offset:4096
    v_mfma_f32_16x16x32_bf16 v[36:39], v[128:131], v[100:103], v[36:39]
    v_mfma_f32_16x16x32_bf16 v[40:43], v[132:135], v[100:103], v[40:43]
    v_mfma_f32_16x16x32_bf16 v[44:47], v[136:139], v[100:103], v[44:47]
    v_mfma_f32_16x16x32_bf16 v[56:59], v[140:143], v[100:103], v[56:59]
    v_mfma_f32_16x16x32_bf16 v[60:63], v[144:147], v[100:103], v[60:63]
    s_waitcnt lgkmcnt(0)
    s_mov_b64 exec, 0x1
    ds_add_u32 v4, v53 offset:14372
    s_mov_b64 exec, -1
    v_mfma_f32_16x16x32_bf16 v[36:39], v[148:151], v[104:107], v[36:39]
    v_mfma_f32_16x16x32_bf16 v[40:43], v[152:155], v[104:107], v[40:43]
    v_mfma_f32_16x16x32_bf16 v[44:47], v[156:159], v[104:107], v[44:47]
    v_mfma_f32_16x16x32_bf16 v[56:59], v[160:163], v[104:107], v[56:59]
    v_mfma_f32_16x16x32_bf16 v[60:63], v[164:167], v[104:107], v[60:63]
    v_mfma_f32_16x16x32_bf16 v[36:39], v[168:171], v[108:111], v[36:39]
    v_mfma_f32_16x16x32_bf16 v[40:43], v[172:175], v[108:111], v[40:43]
    v_mfma_f32_16x16x32_bf16 v[44:47], v[176:179], v[108:111], v[44:47]
    v_mfma_f32_16x16x32_bf16 v[56:59], v[180:183], v[108:111], v[56:59]
    v_mfma_f32_16x16x32_bf16 v[60:63], v[184:187], v[108:111], v[60:63]
    s_mov_b32 s96, 4000000
Lw8_100:
    ds_read_b32 v252, v4 offset:14372
    s_sub_u32 s96, s96, 1
    s_cmp_eq_u32 s96, 0
    s_waitcnt lgkmcnt(0)
    s_cbranch_scc1 Lw8o_101
    v_cmp_gt_u32 vcc, 4, v252
    s_cbranch_vccz Lw8o_101
    s_sleep 0
    s_branch Lw8_100
Lw8o_101:
    ds_read_b128 v[64:67], v51 offset:0
    ds_read_b128 v[68:71], v51 offset:1024
    ds_read_b128 v[72:75], v51 offset:2048
    ds_read_b128 v[76:79], v51 offset:3072
    ds_read_b128 v[80:83], v51 offset:4096
    ds_read_b128 v[84:87], v51 offset:20480
    ds_read_b128 v[88:91], v51 offset:21504
    ds_read_b128 v[92:95], v51 offset:22528
    ds_read_b128 v[120:123], v51 offset:23552
    ds_read_b128 v[124:127], v51 offset:24576
    ds_read_b128 v[128:131], v10 offset:14464
    ds_read_b128 v[132:135], v10 offset:15488
    ds_read_b128 v[136:139], v10 offset:16512
    ds_read_b128 v[140:143], v10 offset:17536
    ds_read_b128 v[144:147], v10 offset:18560
    s_waitcnt lgkmcnt(10)
    v_pk_add_f32 v[36:37], v[36:37], v[64:65]
    v_pk_add_f32 v[38:39], v[38:39], v[66:67]
    v_pk_add_f32 v[40:41], v[40:41], v[68:69]
    v_pk_add_f32 v[42:43], v[42:43], v[70:71]
    v_pk_add_f32 v[44:45], v[44:45], v[72:73]
    v_pk_add_f32 v[46:47], v[46:47], v[74:75]
    v_pk_add_f32 v[56:57], v[56:57], v[76:77]
    v_pk_add_f32 v[58:59], v[58:59], v[78:79]
    v_pk_add_f32 v[60:61], v[60:61], v[80:81]
    v_pk_add_f32 v[62:63], v[62:63], v[82:83]
    s_waitcnt lgkmcnt(5)
    v_pk_add_f32 v[36:37], v[36:37], v[84:85]
    v_pk_add_f32 v[38:39], v[38:39], v[86:87]
    v_pk_add_f32 v[40:41], v[40:41], v[88:89]
    v_pk_add_f32 v[42:43], v[42:43], v[90:91]
    v_pk_add_f32 v[44:45], v[44:45], v[92:93]
    v_pk_add_f32 v[46:47], v[46:47], v[94:95]
    v_pk_add_f32 v[56:57], v[56:57], v[120:121]
    v_pk_add_f32 v[58:59], v[58:59], v[122:123]
    v_pk_add_f32 v[60:61], v[60:61], v[124:125]
    v_pk_add_f32 v[62:63], v[62:63], v[126:127]
    s_waitcnt lgkmcnt(0)
    v_pk_add_f32 v[36:37], v[36:37], v[128:129]
    v_pk_add_f32 v[38:39], v[38:39], v[130:131]
    v_pk_add_f32 v[40:41], v[40:41], v[132:133]
    v_pk_add_f32 v[42:43], v[42:43], v[134:135]
    v_pk_add_f32 v[44:45], v[44:45], v[136:137]
    v_pk_add_f32 v[46:47], v[46:47], v[138:139]
    v_pk_add_f32 v[56:57], v[56:57], v[140:141]
    v_pk_add_f32 v[58:59], v[58:59], v[142:143]
    v_pk_add_f32 v[60:61], v[60:61], v[144:145]
    v_pk_add_f32 v[62:63], v[62:63], v[146:147]
    v_cvt_pk_bf16_f32 v36, v36, v37
    v_cvt_pk_bf16_f32 v37, v38, v39
    ds_write_b64 v6, v[36:37] offset:0
    v_cvt_pk_bf16_f32 v40, v40, v41
    v_cvt_pk_bf16_f32 v41, v42, v43
    ds_write_b64 v6, v[40:41] offset:32
    v_cvt_pk_bf16_f32 v44, v44, v45
    v_cvt_pk_bf16_f32 v45, v46, v47
    ds_write_b64 v6, v[44:45] offset:64
    v_cvt_pk_bf16_f32 v56, v56, v57
    v_cvt_pk_bf16_f32 v57, v58, v59
    ds_write_b64 v6, v[56:57] offset:96
    v_cvt_pk_bf16_f32 v60, v60, v61
    v_cvt_pk_bf16_f32 v61, v62, v63
    ds_write_b64 v6, v[60:61] offset:128
    ds_read_b128 v[188:191], v9 offset:0
    ds_read_b128 v[192:195], v9 offset:1024
    s_mov_b32 exec_lo, 0xffffffff
    s_mov_b32 exec_hi, 0x0
    ds_read_b128 v[196:199], v9 offset:2048
    s_mov_b64 exec, -1
    s_waitcnt lgkmcnt(2)
    buffer_store_dwordx4 v[188:191], v11, s[64:67], s10 offen
    s_waitcnt lgkmcnt(1)
    buffer_store_dwordx4 v[192:195], v12, s[64:67], s10 offen
    s_waitcnt lgkmcnt(0)
    s_mov_b32 exec_lo, 0xffffffff
    s_mov_b32 exec_hi, 0x0
    buffer_store_dwordx4 v[196:199], v13, s[64:67], s10 offen
    s_mov_b64 exec, -1
L_abl_end:
L_end:
    s_endpgm
F_publish:
    s_and_b32 s98, s55, 1
    s_lshl_b32 s98, s98, 2
    v_mov_b32 v254, s98
    s_mov_b64 exec, 0x1
    ds_add_u32 v254, v53 offset:14352
    s_mov_b64 exec, -1
    s_lshl_b32 s48, s55, 2
    s_add_u32 s55, s55, 1
    s_cmp_ge_u32 s55, 8
    s_cselect_b32 s48, -1, s48
    s_mov_b32 s93, 0
    s_setpc_b64 s[46:47]
F_issue:
    s_add_u32 s99, s5, s55
    s_and_b32 s99, s99, 7
    s_mul_i32 s99, s99, 21120
    s_add_u32 s99, s99, s54
    s_add_u32 s99, s99, 1310720
    s_and_b32 s98, s55, 1
    s_mul_i32 s98, s98, 21120
    s_add_u32 s98, s98, s54
    s_add_u32 m0, s98, 121600
    s_nop 0
    buffer_load_dwordx4 v15, s[56:59], s99 offen sc1 lds
    buffer_load_dwordx4 v15, s[56:59], s99 offen offset:1024 sc1 lds
    buffer_load_dwordx4 v15, s[56:59], s99 offen offset:2048 sc1 lds
    buffer_load_dwordx4 v15, s[56:59], s99 offen offset:3072 sc1 lds
    s_add_u32 s99, s99, 4096
    s_add_u32 m0, s98, 125696
    s_nop 0
    buffer_load_dwordx4 v15, s[56:59], s99 offen sc1 lds
    s_mov_b64 exec, 0x3ff
    buffer_load_dwordx4 v15, s[56:59], s99 offen offset:1024 sc1 lds
    s_mov_b64 exec, -1
    s_mov_b32 s93, 1
    s_mov_b32 s48, -1
    s_setpc_b64 s[46:47]
F_swspin:
    s_mov_b32 s96, 4000000
F_swspin_l:
    s_sleep 1
    ds_read_b64 v[252:253], v4 offset:14344
    s_sub_u32 s96, s96, 1
    s_cmp_eq_u32 s96, 0
    s_waitcnt lgkmcnt(0)
    s_cbranch_scc1 F_swspin_o
    v_cmp_gt_u32 vcc, s97, v252
    s_cbranch_vccnz F_swspin_l
F_swspin_o:
    s_setpc_b64 s[46:47]
Lkw_108:
    s_mov_b32 s96, 4000000
Lkl_129:
    s_sleep 1
    ds_read_b32 v151, v4 offset:14356
    s_sub_u32 s96, s96, 1
    s_cmp_eq_u32 s96, 0
    s_waitcnt lgkmcnt(0)
    s_cbranch_scc1 Lkwo_109
    v_cmp_gt_u32 vcc, s9, v151
    s_cbranch_vccnz Lkl_129
    s_branch Lkwo_109
Lkw_110:
    s_mov_b32 s96, 4000000
Lkl_130:
    s_sleep 1
    ds_read_b32 v151, v4 offset:14352
    s_sub_u32 s96, s96, 1
    s_cmp_eq_u32 s96, 0
    s_waitcnt lgkmcnt(0)
    s_cbranch_scc1 Lkwo_111
    v_cmp_gt_u32 vcc, s9, v151
    s_cbranch_vccnz Lkl_130
    s_branch Lkwo_111
Lkw_112:
    s_mov_b32 s96, 4000000
Lkl_131:
    s_sleep 1
    ds_read_b32 v151, v4 offset:14344
    s_sub_u32 s96, s96, 1
    s_cmp_eq_u32 s96, 0
    s_waitcnt lgkmcnt(0)
    s_cbranch_scc1 Lkwo_113
    v_cmp_gt_u32 vcc, 44, v151
    s_cbranch_vccnz Lkl_131
    s_branch Lkwo_113
Lxr_90:
    s_mov_b32 s96, 400000
Lxl_132:
    s_add_u32 s98, s85, s90
    buffer_load_dwordx4 v[188:191], v15, s[56:59], s98 offen sc1
    s_add_u32 s98, s86, s90
    buffer_load_dwordx4 v[192:195], v15, s[56:59], s98 offen sc1
    s_add_u32 s98, s87, s90
    buffer_load_dwordx4 v[196:199], v15, s[56:59], s98 offen sc1
    s_add_u32 s98, s89, s90
    buffer_load_dwordx4 v[200:203], v15, s[56:59], s98 offen sc1
    s_add_u32 s98, s92, s90
    buffer_load_dwordx4 v[204:207], v15, s[56:59], s98 offen sc1
    s_add_u32 s98, s85, s91
    buffer_load_dwordx4 v[208:211], v15, s[56:59], s98 offen sc1
    s_add_u32 s98, s86, s91
    buffer_load_dwordx4 v[212:215], v15, s[56:59], s98 offen sc1
    s_add_u32 s98, s87, s91
    buffer_load_dwordx4 v[216:219], v15, s[56:59], s98 offen sc1
    s_add_u32 s98, s89, s91
    buffer_load_dwordx4 v[220:223], v15, s[56:59], s98 offen sc1
    s_add_u32 s98, s92, s91
    buffer_load_dwordx4 v[224:227], v15, s[56:59], s98 offen sc1
    s_waitcnt vmcnt(0)
    v_max3_u32 v5, v188, v192, v196
    v_max3_u32 v5, v200, v204, v5
    v_cmp_eq_u32 vcc, -1, v5
    s_sub_u32 s96, s96, 1
    s_cmp_eq_u32 s96, 0
    s_cbranch_scc1 Lxb_91
    s_cbranch_vccnz Lxl_132
    s_branch Lxb_91
Lxr_92:
    s_mov_b32 s96, 400000
Lxl_133:
    s_add_u32 s98, s85, s91
    buffer_load_dwordx4 v[208:211], v15, s[56:59], s98 offen sc1
    s_add_u32 s98, s86, s91
    buffer_load_dwordx4 v[212:215], v15, s[56:59], s98 offen sc1
    s_add_u32 s98, s87, s91
    buffer_load_dwordx4 v[216:219], v15, s[56:59], s98 offen sc1
    s_add_u32 s98, s89, s91
    buffer_load_dwordx4 v[220:223], v15, s[56:59], s98 offen sc1
    s_add_u32 s98, s92, s91
    buffer_load_dwordx4 v[224:227], v15, s[56:59], s98 offen sc1
    s_add_u32 s98, s85, s88
    buffer_load_dwordx4 v[228:231], v15, s[56:59], s98 offen sc1
    s_add_u32 s98, s86, s88
    buffer_load_dwordx4 v[232:235], v15, s[56:59], s98 offen sc1
    s_add_u32 s98, s87, s88
    buffer_load_dwordx4 v[236:239], v15, s[56:59], s98 offen sc1
    s_add_u32 s98, s89, s88
    buffer_load_dwordx4 v[240:243], v15, s[56:59], s98 offen sc1
    s_add_u32 s98, s92, s88
    buffer_load_dwordx4 v[244:247], v15, s[56:59], s98 offen sc1
    s_waitcnt vmcnt(0)
    v_max3_u32 v5, v208, v212, v216
    v_max3_u32 v5, v220, v224, v5
    v_cmp_eq_u32 vcc, -1, v5
    s_sub_u32 s96, s96, 1
    s_cmp_eq_u32 s96, 0
    s_cbranch_scc1 Lxb_93
    s_cbranch_vccnz Lxl_133
    s_branch Lxb_93
Lxr_94:
    s_mov_b32 s96, 400000
Lxl_134:
    s_add_u32 s98, s85, s88
    buffer_load_dwordx4 v[228:231], v15, s[56:59], s98 offen sc1
    s_add_u32 s98, s86, s88
    buffer_load_dwordx4 v[232:235], v15, s[56:59], s98 offen sc1
    s_add_u32 s98, s87, s88
    buffer_load_dwordx4 v[236:239], v15, s[56:59], s98 offen sc1
    s_add_u32 s98, s89, s88
    buffer_load_dwordx4 v[240:243], v15, s[56:59], s98 offen sc1
    s_add_u32 s98, s92, s88
    buffer_load_dwordx4 v[244:247], v15, s[56:59], s98 offen sc1
    s_add_u32 s98, s85, s15
    buffer_load_dwordx4 v[248:251], v15, s[56:59], s98 offen sc1
    s_add_u32 s98, s86, s15
    buffer_load_dwordx4 v[96:99], v15, s[56:59], s98 offen sc1
    s_add_u32 s98, s87, s15
    buffer_load_dwordx4 v[100:103], v15, s[56:59], s98 offen sc1
    s_add_u32 s98, s89, s15
    buffer_load_dwordx4 v[104:107], v15, s[56:59], s98 offen sc1
    s_add_u32 s98, s92, s15
    buffer_load_dwordx4 v[108:111], v15, s[56:59], s98 offen sc1
    s_waitcnt vmcnt(0)
    v_max3_u32 v5, v228, v232, v236
    v_max3_u32 v5, v240, v244, v5
    v_cmp_eq_u32 vcc, -1, v5
    s_sub_u32 s96, s96, 1
    s_cmp_eq_u32 s96, 0
    s_cbranch_scc1 Lxb_95
    s_cbranch_vccnz Lxl_134
    s_branch Lxb_95
Lxr_96:
    s_mov_b32 s96, 400000
Lxl_135:
    s_add_u32 s98, s85, s15
    buffer_load_dwordx4 v[248:251], v15, s[56:59], s98 offen sc1
    s_add_u32 s98, s86, s15
    buffer_load_dwordx4 v[96:99], v15, s[56:59], s98 offen sc1
    s_add_u32 s98, s87, s15
    buffer_load_dwordx4 v[100:103], v15, s[56:59], s98 offen sc1
    s_add_u32 s98, s89, s15
    buffer_load_dwordx4 v[104:107], v15, s[56:59], s98 offen sc1
    s_add_u32 s98, s92, s15
    buffer_load_dwordx4 v[108:111], v15, s[56:59], s98 offen sc1
    s_waitcnt vmcnt(0)
    v_max3_u32 v5, v248, v96, v100
    v_max3_u32 v5, v104, v108, v5
    v_cmp_eq_u32 vcc, -1, v5
    s_sub_u32 s96, s96, 1
    s_cmp_eq_u32 s96, 0
    s_cbranch_scc1 Lxb_97
    s_cbranch_vccnz Lxl_135
    s_branch Lxb_97
Lbr_119:
    s_mov_b32 s96, 400000
Lbl_136:
    s_add_u32 s98, s13, 0
    buffer_load_dwordx4 v[168:171], v15, s[56:59], s98 offen sc1
    s_add_u32 s98, s13, 4096
    buffer_load_dwordx4 v[172:175], v15, s[56:59], s98 offen sc1
    s_add_u32 s98, s13, 8192
    buffer_load_dwordx4 v[176:179], v15, s[56:59], s98 offen sc1
    s_add_u32 s98, s13, 12288
    buffer_load_dwordx4 v[180:183], v15, s[56:59], s98 offen sc1
    s_add_u32 s98, s13, 16384
    buffer_load_dwordx4 v[184:187], v15, s[56:59], s98 offen sc1
    s_add_u32 s98, s13, 20480
    buffer_load_dwordx4 v[188:191], v15, s[56:59], s98 offen sc1
    s_add_u32 s98, s13, 24576
    buffer_load_dwordx4 v[192:195], v15, s[56:59], s98 offen sc1
    s_add_u32 s98, s13, 28672
    buffer_load_dwordx4 v[196:199], v15, s[56:59], s98 offen sc1
    s_waitcnt vmcnt(0)
    v_max3_u32 v5, v168, v172, v176
    v_max_u32 v5, v5, v180
    v_cmp_eq_u32 vcc, -1, v5
    s_sub_u32 s96, s96, 1
    s_cmp_eq_u32 s96, 0
    s_cbranch_scc1 Lbb_120
    s_cbranch_vccnz Lbl_136
    s_branch Lbb_120
Lbr_121:
    s_mov_b32 s96, 400000
Lbl_137:
    s_add_u32 s98, s13, 16384
    buffer_load_dwordx4 v[184:187], v15, s[56:59], s98 offen sc1
    s_add_u32 s98, s13, 20480
    buffer_load_dwordx4 v[188:191], v15, s[56:59], s98 offen sc1
    s_add_u32 s98, s13, 24576
    buffer_load_dwordx4 v[192:195], v15, s[56:59], s98 offen sc1
    s_add_u32 s98, s13, 28672
    buffer_load_dwordx4 v[196:199], v15, s[56:59], s98 offen sc1
    s_add_u32 s98, s13, 32768
    buffer_load_dwordx4 v[200:203], v15, s[56:59], s98 offen sc1
    s_add_u32 s98, s13, 36864
    buffer_load_dwordx4 v[204:207], v15, s[56:59], s98 offen sc1
    s_add_u32 s98, s13, 40960
    buffer_load_dwordx4 v[208:211], v15, s[56:59], s98 offen sc1
    s_add_u32 s98, s13, 45056
    buffer_load_dwordx4 v[212:215], v15, s[56:59], s98 offen sc1
    s_waitcnt vmcnt(0)
    v_max3_u32 v5, v184, v188, v192
    v_max_u32 v5, v5, v196
    v_cmp_eq_u32 vcc, -1, v5
    s_sub_u32 s96, s96, 1
    s_cmp_eq_u32 s96, 0
    s_cbranch_scc1 Lbb_122
    s_cbranch_vccnz Lbl_137
    s_branch Lbb_122
Lbr_123:
    s_mov_b32 s96, 400000
Lbl_138:
    s_add_u32 s98, s13, 32768
    buffer_load_dwordx4 v[200:203], v15, s[56:59], s98 offen sc1
    s_add_u32 s98, s13, 36864
    buffer_load_dwordx4 v[204:207], v15, s[56:59], s98 offen sc1
    s_add_u32 s98, s13, 40960
    buffer_load_dwordx4 v[208:211], v15, s[56:59], s98 offen sc1
    s_add_u32 s98, s13, 45056
    buffer_load_dwordx4 v[212:215], v15, s[56:59], s98 offen sc1
    s_add_u32 s98, s13, 49152
    buffer_load_dwordx4 v[216:219], v15, s[56:59], s98 offen sc1
    s_add_u32 s98, s13, 53248
    buffer_load_dwordx4 v[220:223], v15, s[56:59], s98 offen sc1
    s_add_u32 s98, s13, 57344
    buffer_load_dwordx4 v[224:227], v15, s[56:59], s98 offen sc1
    s_add_u32 s98, s13, 61440
    buffer_load_dwordx4 v[228:231], v15, s[56:59], s98 offen sc1
    s_waitcnt vmcnt(0)
    v_max3_u32 v5, v200, v204, v208
    v_max_u32 v5, v5, v212
    v_cmp_eq_u32 vcc, -1, v5
    s_sub_u32 s96, s96, 1
    s_cmp_eq_u32 s96, 0
    s_cbranch_scc1 Lbb_124
    s_cbranch_vccnz Lbl_138
    s_branch Lbb_124
Lbr_125:
    s_mov_b32 s96, 400000
Lbl_139:
    s_add_u32 s98, s13, 49152
    buffer_load_dwordx4 v[216:219], v15, s[56:59], s98 offen sc1
    s_add_u32 s98, s13, 53248
    buffer_load_dwordx4 v[220:223], v15, s[56:59], s98 offen sc1
    s_add_u32 s98, s13, 57344
    buffer_load_dwordx4 v[224:227], v15, s[56:59], s98 offen sc1
    s_add_u32 s98, s13, 61440
    buffer_load_dwordx4 v[228:231], v15, s[56:59], s98 offen sc1
    s_add_u32 s98, s13, 65536
    buffer_load_dwordx4 v[232:235], v15, s[56:59], s98 offen sc1
    s_add_u32 s98, s13, 69632
    buffer_load_dwordx4 v[236:239], v15, s[56:59], s98 offen sc1
    s_add_u32 s98, s13, 73728
    buffer_load_dwordx4 v[240:243], v15, s[56:59], s98 offen sc1
    s_add_u32 s98, s13, 77824
    buffer_load_dwordx4 v[244:247], v15, s[56:59], s98 offen sc1
    s_waitcnt vmcnt(0)
    v_max3_u32 v5, v216, v220, v224
    v_max_u32 v5, v5, v228
    v_cmp_eq_u32 vcc, -1, v5
    s_sub_u32 s96, s96, 1
    s_cmp_eq_u32 s96, 0
    s_cbranch_scc1 Lbb_126
    s_cbranch_vccnz Lbl_139
    s_branch Lbb_126
Lbr_127:
    s_mov_b32 s96, 400000
Lbl_140:
    s_add_u32 s98, s13, 65536
    buffer_load_dwordx4 v[232:235], v15, s[56:59], s98 offen sc1
    s_add_u32 s98, s13, 69632
    buffer_load_dwordx4 v[236:239], v15, s[56:59], s98 offen sc1
    s_add_u32 s98, s13, 73728
    buffer_load_dwordx4 v[240:243], v15, s[56:59], s98 offen sc1
    s_add_u32 s98, s13, 77824
    buffer_load_dwordx4 v[244:247], v15, s[56:59], s98 offen sc1
    s_waitcnt vmcnt(0)
    v_max3_u32 v5, v232, v236, v240
    v_max_u32 v5, v5, v244
    v_cmp_eq_u32 vcc, -1, v5
    s_sub_u32 s96, s96, 1
    s_cmp_eq_u32 s96, 0
    s_cbranch_scc1 Lbb_128
    s_cbranch_vccnz Lbl_140
    s_branch Lbb_128
L_fallback:
    s_waitcnt lgkmcnt(0)
    s_nop 15
    v_mov_b32 v146, 0
    v_mov_b32 v147, 0
    v_mov_b32 v152, 0x3f803f80
    v_mov_b32 v153, 0x3f803f80
    v_mov_b32 v154, 0x3f803f80
    v_mov_b32 v155, 0x3f803f80
    v_mov_b32 v156, 0x3f803f80
    v_mov_b32 v157, 0x3f803f80
    v_mov_b32 v158, 0x3f803f80
    v_mov_b32 v159, 0x3f803f80
    v_lshlrev_b32 v5, 3, v1
    v_lshrrev_b32 v6, 5, v1
    v_mul_u32_u24 v6, 336, v6
    v_and_b32 v7, 31, v1
    v_lshl_add_u32 v6, v7, 4, v6
    s_mov_b32 exec_lo, 0x0
    s_mov_b32 exec_hi, 0xffffffff
    v_mov_b32 v20, 0
    s_mov_b64 exec, -1
    v_mov_b32 v104, 0
    v_mov_b32 v105, 0
    v_mov_b32 v106, 0
    v_mov_b32 v107, 0
    v_mov_b32 v108, 0
    v_mov_b32 v109, 0
    v_mov_b32 v110, 0
    v_mov_b32 v111, 0
    v_mov_b32 v112, 0
    v_mov_b32 v113, 0
    v_mov_b32 v114, 0
    v_mov_b32 v115, 0
    v_mov_b32 v116, 0
    v_mov_b32 v117, 0
    v_mov_b32 v118, 0
    v_mov_b32 v119, 0
    v_mov_b32 v8, 0xff800000
    s_mov_b32 s97, 1310720
L_fb1_0:
    buffer_load_dwordx4 v[142:145], v15, s[56:59], s97 offen sc1
    s_mov_b32 exec_lo, 0xffffffff
    s_mov_b32 exec_hi, 0x0
    buffer_load_dwordx2 v[146:147], v5, s[56:59], s97 offen offset:1024 sc1
    s_mov_b64 exec, -1
    s_waitcnt vmcnt(0)
    v_mfma_f32_32x32x16_bf16 v[80:95], v[142:145], v[16:19], 0
    v_mfma_f32_32x32x8_bf16 v[80:95], v[146:147], v[20:21], v[80:95]
    s_nop 11
    v_max3_f32 v8, v80, v81, v8
    v_max3_f32 v8, v82, v83, v8
    v_max3_f32 v8, v84, v85, v8
    v_max3_f32 v8, v86, v87, v8
    v_max3_f32 v8, v88, v89, v8
    v_max3_f32 v8, v90, v91, v8
    v_max3_f32 v8, v92, v93, v8
    v_max3_f32 v8, v94, v95, v8
    s_add_u32 s97, s97, 2640
    s_cmp_lt_u32 s97, 1479680
    s_cbranch_scc1 L_fb1_0
    v_mov_b32 v9, v8
    s_nop 1
    v_permlane32_swap_b32 v9, v8
    v_max_f32 v8, v8, v9
    s_mov_b32 s97, 1310720
L_fb2_0:
    buffer_load_dwordx4 v[142:145], v15, s[56:59], s97 offen sc1
    s_mov_b32 exec_lo, 0xffffffff
    s_mov_b32 exec_hi, 0x0
    buffer_load_dwordx2 v[146:147], v5, s[56:59], s97 offen offset:1024 sc1
    s_mov_b64 exec, -1
    s_mov_b32 exec_lo, 0xfffff
    s_mov_b32 exec_hi, 0xfffff
    buffer_load_dwordx4 v[152:155], v6, s[56:59], s97 offen offset:1296 sc1
    buffer_load_dwordx4 v[156:159], v6, s[56:59], s97 offen offset:1968 sc1
    s_mov_b64 exec, -1
    s_waitcnt vmcnt(0)
    v_mfma_f32_32x32x16_bf16 v[80:95], v[142:145], v[16:19], 0
    v_mfma_f32_32x32x8_bf16 v[80:95], v[146:147], v[20:21], v[80:95]
    s_nop 11
    v_sub_f32 v80, v80, v8
    v_sub_f32 v81, v81, v8
    v_sub_f32 v82, v82, v8
    v_sub_f32 v83, v83, v8
    v_sub_f32 v84, v84, v8
    v_sub_f32 v85, v85, v8
    v_sub_f32 v86, v86, v8
    v_sub_f32 v87, v87, v8
    v_sub_f32 v88, v88, v8
    v_sub_f32 v89, v89, v8
    v_sub_f32 v90, v90, v8
    v_sub_f32 v91, v91, v8
    v_sub_f32 v92, v92, v8
    v_sub_f32 v93, v93, v8
    v_sub_f32 v94, v94, v8
    v_sub_f32 v95, v95, v8
    v_exp_f32 v80, v80
    v_exp_f32 v81, v81
    v_exp_f32 v82, v82
    v_exp_f32 v83, v83
    v_exp_f32 v84, v84
    v_exp_f32 v85, v85
    v_exp_f32 v86, v86
    v_exp_f32 v87, v87
    v_exp_f32 v88, v88
    v_exp_f32 v89, v89
    v_exp_f32 v90, v90
    v_exp_f32 v91, v91
    v_exp_f32 v92, v92
    v_exp_f32 v93, v93
    v_exp_f32 v94, v94
    v_exp_f32 v95, v95
    v_cvt_pk_bf16_f32 v96, v80, v81
    v_cvt_pk_bf16_f32 v97, v82, v83
    v_cvt_pk_bf16_f32 v98, v84, v85
    v_cvt_pk_bf16_f32 v99, v86, v87
    v_cvt_pk_bf16_f32 v100, v88, v89
    v_cvt_pk_bf16_f32 v101, v90, v91
    v_cvt_pk_bf16_f32 v102, v92, v93
    v_cvt_pk_bf16_f32 v103, v94, v95
    v_mfma_f32_32x32x16_bf16 v[104:119], v[152:155], v[96:99], v[104:119]
    s_nop 0
    v_mfma_f32_32x32x16_bf16 v[104:119], v[156:159], v[100:103], v[104:119]
    s_nop 15
    s_add_u32 s97, s97, 2640
    s_cmp_lt_u32 s97, 1479680
    s_cbranch_scc1 L_fb2_0
    s_mov_b32 exec_lo, 0x0
    s_mov_b32 exec_hi, 0xffffffff
    v_mov_b32 v26, 0
    s_mov_b64 exec, -1
    v_mov_b32 v120, 0
    v_mov_b32 v121, 0
    v_mov_b32 v122, 0
    v_mov_b32 v123, 0
    v_mov_b32 v124, 0
    v_mov_b32 v125, 0
    v_mov_b32 v126, 0
    v_mov_b32 v127, 0
    v_mov_b32 v128, 0
    v_mov_b32 v129, 0
    v_mov_b32 v130, 0
    v_mov_b32 v131, 0
    v_mov_b32 v132, 0
    v_mov_b32 v133, 0
    v_mov_b32 v134, 0
    v_mov_b32 v135, 0
    v_mov_b32 v8, 0xff800000
    s_mov_b32 s97, 1310720
L_fb1_1:
    buffer_load_dwordx4 v[142:145], v15, s[56:59], s97 offen sc1
    s_mov_b32 exec_lo, 0xffffffff
    s_mov_b32 exec_hi, 0x0
    buffer_load_dwordx2 v[146:147], v5, s[56:59], s97 offen offset:1024 sc1
    s_mov_b64 exec, -1
    s_waitcnt vmcnt(0)
    v_mfma_f32_32x32x16_bf16 v[80:95], v[142:145], v[22:25], 0
    v_mfma_f32_32x32x8_bf16 v[80:95], v[146:147], v[26:27], v[80:95]
    s_nop 11
    v_max3_f32 v8, v80, v81, v8
    v_max3_f32 v8, v82, v83, v8
    v_max3_f32 v8, v84, v85, v8
    v_max3_f32 v8, v86, v87, v8
    v_max3_f32 v8, v88, v89, v8
    v_max3_f32 v8, v90, v91, v8
    v_max3_f32 v8, v92, v93, v8
    v_max3_f32 v8, v94, v95, v8
    s_add_u32 s97, s97, 2640
    s_cmp_lt_u32 s97, 1479680
    s_cbranch_scc1 L_fb1_1
    v_mov_b32 v9, v8
    s_nop 1
    v_permlane32_swap_b32 v9, v8
    v_max_f32 v8, v8, v9
    s_mov_b32 s97, 1310720
L_fb2_1:
    buffer_load_dwordx4 v[142:145], v15, s[56:59], s97 offen sc1
    s_mov_b32 exec_lo, 0xffffffff
    s_mov_b32 exec_hi, 0x0
    buffer_load_dwordx2 v[146:147], v5, s[56:59], s97 offen offset:1024 sc1
    s_mov_b64 exec, -1
    s_mov_b32 exec_lo, 0xfffff
    s_mov_b32 exec_hi, 0xfffff
    buffer_load_dwordx4 v[152:155], v6, s[56:59], s97 offen offset:1296 sc1
    buffer_load_dwordx4 v[156:159], v6, s[56:59], s97 offen offset:1968 sc1
    s_mov_b64 exec, -1
    s_waitcnt vmcnt(0)
    v_mfma_f32_32x32x16_bf16 v[80:95], v[142:145], v[22:25], 0
    v_mfma_f32_32x32x8_bf16 v[80:95], v[146:147], v[26:27], v[80:95]
    s_nop 11
    v_sub_f32 v80, v80, v8
    v_sub_f32 v81, v81, v8
    v_sub_f32 v82, v82, v8
    v_sub_f32 v83, v83, v8
    v_sub_f32 v84, v84, v8
    v_sub_f32 v85, v85, v8
    v_sub_f32 v86, v86, v8
    v_sub_f32 v87, v87, v8
    v_sub_f32 v88, v88, v8
    v_sub_f32 v89, v89, v8
    v_sub_f32 v90, v90, v8
    v_sub_f32 v91, v91, v8
    v_sub_f32 v92, v92, v8
    v_sub_f32 v93, v93, v8
    v_sub_f32 v94, v94, v8
    v_sub_f32 v95, v95, v8
    v_exp_f32 v80, v80
    v_exp_f32 v81, v81
    v_exp_f32 v82, v82
    v_exp_f32 v83, v83
    v_exp_f32 v84, v84
    v_exp_f32 v85, v85
    v_exp_f32 v86, v86
    v_exp_f32 v87, v87
    v_exp_f32 v88, v88
    v_exp_f32 v89, v89
    v_exp_f32 v90, v90
    v_exp_f32 v91, v91
    v_exp_f32 v92, v92
    v_exp_f32 v93, v93
    v_exp_f32 v94, v94
    v_exp_f32 v95, v95
    v_cvt_pk_bf16_f32 v96, v80, v81
    v_cvt_pk_bf16_f32 v97, v82, v83
    v_cvt_pk_bf16_f32 v98, v84, v85
    v_cvt_pk_bf16_f32 v99, v86, v87
    v_cvt_pk_bf16_f32 v100, v88, v89
    v_cvt_pk_bf16_f32 v101, v90, v91
    v_cvt_pk_bf16_f32 v102, v92, v93
    v_cvt_pk_bf16_f32 v103, v94, v95
    v_mfma_f32_32x32x16_bf16 v[120:135], v[152:155], v[96:99], v[120:135]
    s_nop 0
    v_mfma_f32_32x32x16_bf16 v[120:135], v[156:159], v[100:103], v[120:135]
    s_nop 15
    s_add_u32 s97, s97, 2640
    s_cmp_lt_u32 s97, 1479680
    s_cbranch_scc1 L_fb2_1
    s_mov_b64 s[94:95], 0
    s_branch L_finalize
L_code_end:
.section .rodata,"a"
.p2align 6
.amdhsa_kernel concat_heads__grouped_kv_mqa__linear_attn_block__prompt_kernel
  .amdhsa_next_free_vgpr 256
  .amdhsa_next_free_sgpr 102
  .amdhsa_accum_offset 256
  .amdhsa_group_segment_fixed_size 0
  .amdhsa_kernarg_size 88
  .amdhsa_user_sgpr_count 2
  .amdhsa_user_sgpr_kernarg_segment_ptr 1
  .amdhsa_system_sgpr_workgroup_id_x 1
.end_amdhsa_kernel
```
